```python
import torch

def _softmax(x, axis=-1):
    return torch.softmax(x, dim=axis)
def _gelu(x):
    return torch.nn.functional.gelu(x, approximate="tanh")
def _silu(x):
    return torch.nn.functional.silu(x)
def _sigmoid(x):
    return torch.sigmoid(x)
def _layernorm(x, axis=-1, eps=1e-5):
    m = x.mean(dim=axis, keepdim=True)
    v = x.var(dim=axis, keepdim=True, unbiased=False)
    return (x - m) / torch.sqrt(v + eps)
def _scatter_add(tgt, idx, src, axis=0):
    return tgt.clone().index_add_(axis, idx, src)
def _segment_sum(src, seg, n):
    out = torch.zeros((n,) + src.shape[1:], dtype=src.dtype)
    return out.index_add_(0, seg, src)
def _pad(x, pw):
    flat = tuple(v for pair in reversed(pw) for v in pair)
    return torch.nn.functional.pad(x, flat)

kernel_name = 'parallel_sum__linear_attn_block__glu_gated_swiglu__prompt'

def setup_inputs():

    _w = (lambda a: (lambda t: t.to(torch.bfloat16) if t.is_floating_point() else t)(torch.as_tensor(a)))
    def _A_setup():
        B, S, D = 1, 2048, 640
        return {
            "x": _w((lambda *s: torch.randn(*s, dtype=torch.bfloat16) * 0.05)(B, S, D)),
            "wqkv": _w((lambda *s: torch.randn(*s, dtype=torch.bfloat16) * 0.05)(D, 3 * D)),
            "wo": _w((lambda *s: torch.randn(*s, dtype=torch.bfloat16) * 0.05)(D, D)),
        }
    _A_in = _A_setup()

    def _B_setup():
        B, S, D, F = 1, 2048, 640, 1536
        return {
            "x": _w((lambda *s: torch.randn(*s, dtype=torch.bfloat16) * 0.05)(B, S, D)),
            "w1": _w((lambda *s: torch.randn(*s, dtype=torch.bfloat16) * 0.2)(D, F) * (2.0 / D) ** 0.5),
            "w3": _w((lambda *s: torch.randn(*s, dtype=torch.bfloat16) * 0.2)(D, F) * (2.0 / D) ** 0.5),
            "w2": _w((lambda *s: torch.randn(*s, dtype=torch.bfloat16) * 0.2)(F, D) * (2.0 / F) ** 0.5),
        }
    _B_in = _B_setup()

    return {
        "A_x": _A_in["x"],
        "A_wqkv": _A_in["wqkv"],
        "A_wo": _A_in["wo"],
        "B_x": _B_in["x"],
        "B_w1": _B_in["w1"],
        "B_w3": _B_in["w3"],
        "B_w2": _B_in["w2"],
    }

def reference(A_x, A_wqkv, A_wo, B_x, B_w1, B_w3, B_w2):
    def _A_ref(x, wqkv, wo):
        B, S, D = x.shape
        H = 32; Dh = D // H
        qkv = (lambda x, *d: x.permute(*d))((x @ wqkv).reshape(B, S, 3, H, Dh), 2, 0, 3, 1, 4)
        q, k, v = qkv[0], qkv[1], qkv[2]
        phi = lambda t: torch.where(t > 0, t + 1, torch.exp(t)) + 1e-6
        pq, pk = phi(q), phi(k)
        kv = torch.einsum("bhsd,bhse->bhde", pk, v)
        z = torch.einsum("bhsd->bhd", pk)
        num = torch.einsum("bhqd,bhde->bhqe", pq, kv)
        den = torch.einsum("bhqd,bhd->bhq", pq, z)[..., None] + 1e-6
        o = num / den
        return (lambda x, *d: x.permute(*d))(o, 0, 2, 1, 3).reshape(B, S, D) @ wo

    def _B_ref(x, w1, w3, w2):
        gate = torch.einsum("bsd,df->bsf", x, w1)
        up = torch.einsum("bsd,df->bsf", x, w3)
        h = _silu(gate) * up
        out = torch.einsum("bsf,fd->bsd", h, w2)
        return out

    x = A_x
    xn = _layernorm(x, axis=-1)
    return x + _A_ref(xn, A_wqkv, A_wo) + _B_ref(xn, B_w1, B_w3, B_w2)
```

```asm
; @launch kernel=k1_kernel grid=(256,1,1) block=(512,1,1) lds=163840
; @launch kernel=k2_kernel grid=(256,1,1) block=(512,1,1) lds=163840
.amdgcn_target "amdgcn-amd-amdhsa--gfx950"
.text
.globl k1_kernel
.p2align 8
.type k1_kernel,@function
k1_kernel:
  s_cmp_ge_u32 s2, 256
  s_cbranch_scc1 L_k1_end
  s_load_dwordx4 s[4:7], s[0:1], 0
  s_load_dwordx4 s[48:51], s[0:1], 32
  s_load_dwordx4 s[52:55], s[0:1], 64
  v_lshrrev_b32 v1, 6, v0
  v_and_b32 v8, 63, v0
  v_readfirstlane_b32 s28, v1
  s_and_b32 s37, s2, 7
  s_lshr_b32 s38, s2, 3
  s_and_b32 s26, s37, 1
  s_lshl_b32 s26, s26, 2
  s_and_b32 s39, s38, 3
  s_add_u32 s26, s26, s39
  s_lshr_b32 s37, s37, 1
  s_lshr_b32 s38, s38, 2
  s_lshl_b32 s27, s37, 3
  s_add_u32 s27, s27, s38
  s_mul_i32 s30, s37, 5
  s_add_u32 s30, s30, s38
  s_sub_u32 s30, s30, 3
  s_mov_b32 s29, 2
  s_cmp_eq_u32 s38, 2
  s_cselect_b32 s29, 0, s29
  s_cselect_b32 s30, s37, s30
  s_lshl_b32 s39, s37, 1
  s_add_u32 s39, s39, s38
  s_cmp_lt_u32 s38, 2
  s_cselect_b32 s29, 1, s29
  s_cselect_b32 s30, s39, s30
  s_mul_i32 s32, s30, 160
  s_mov_b32 s33, s32
  s_and_b32 s34, s30, 1
  s_lshl_b32 s34, s34, 1
  s_cmp_eq_u32 s29, 2
  s_cselect_b32 s34, s34, 0
  s_mov_b32 s31, 3840
  s_mov_b32 s14, 2457600
  s_cselect_b32 s31, 3072, s31
  s_cselect_b32 s14, 1966080, s14
  s_mov_b32 s18, s14
  s_cmp_eq_u32 s29, 1
  s_cselect_b32 s37, 1280, 0
  s_cselect_b32 s38, 2560, 0
  s_add_u32 s32, s32, s37
  s_add_u32 s33, s33, s38
  s_cmp_eq_u32 s29, 0
  s_cselect_b32 s37, s32, 0
  s_cselect_b32 s38, 160, 0
  s_add_u32 s32, s32, s37
  s_add_u32 s33, s33, s37
  s_add_u32 s33, s33, s38
  s_mov_b32 s10, 2621440
  s_mov_b32 s11, 0x20000
  s_mov_b32 s22, 12128256
  s_mov_b32 s23, 0x20000
  s_mov_b32 s15, 0x20000
  s_mov_b32 s19, 0x20000
  v_and_b32 v9, 15, v8
  v_lshrrev_b32 v10, 4, v8
  s_cmp_lt_u32 s28, 4
  s_cbranch_scc1 L_consumers
  s_cmp_ge_u32 s28, 6
  s_cbranch_scc1 L_helpers
  s_setprio 3
  s_sub_u32 s62, s28, 4
  s_lshl_b32 s58, s62, 14
  s_mul_i32 s59, s62, 10240
  s_add_u32 s59, s59, 32768
  v_lshrrev_b32 v12, 3, v8
  v_and_b32 v11, 7, v8
  v_xor_b32 v11, v11, v12
  v_lshlrev_b32 v11, 4, v11
  v_mul_u32_u24 v12, 1280, v12
  v_add_u32 v16, v11, v12
  s_lshl_b32 s56, s26, 1
  s_add_u32 s56, s56, s62
  s_mul_i32 s56, s56, 163840
  v_add_u32 v11, 0, v8
  v_mul_u32_u24 v12, 205, v11
  v_lshrrev_b32 v12, 11, v12
  v_mul_u32_u24 v13, 10, v12
  v_sub_u32 v13, v11, v13
  v_add_u32 v13, s34, v13
  v_cmp_le_u32 vcc, 10, v13
  v_subrev_u32 v14, 10, v13
  v_and_b32 v15, 0x13, v12
  v_cndmask_b32 v13, v13, v14, vcc
  v_and_b32 v14, 4, v12
  v_lshlrev_b32 v14, 1, v14
  v_or_b32 v15, v15, v14
  v_and_b32 v14, 8, v12
  v_lshrrev_b32 v14, 1, v14
  v_or_b32 v15, v15, v14
  v_mul_lo_u32 v15, v15, s31
  v_lshlrev_b32 v13, 4, v13
  v_add_u32 v20, v15, v13
  v_add_u32 v11, 64, v8
  v_mul_u32_u24 v12, 205, v11
  v_lshrrev_b32 v12, 11, v12
  v_mul_u32_u24 v13, 10, v12
  v_sub_u32 v13, v11, v13
  v_add_u32 v13, s34, v13
  v_cmp_le_u32 vcc, 10, v13
  v_subrev_u32 v14, 10, v13
  v_and_b32 v15, 0x13, v12
  v_cndmask_b32 v13, v13, v14, vcc
  v_and_b32 v14, 4, v12
  v_lshlrev_b32 v14, 1, v14
  v_or_b32 v15, v15, v14
  v_and_b32 v14, 8, v12
  v_lshrrev_b32 v14, 1, v14
  v_or_b32 v15, v15, v14
  v_mul_lo_u32 v15, v15, s31
  v_lshlrev_b32 v13, 4, v13
  v_add_u32 v21, v15, v13
  v_add_u32 v11, 128, v8
  v_mul_u32_u24 v12, 205, v11
  v_lshrrev_b32 v12, 11, v12
  v_mul_u32_u24 v13, 10, v12
  v_sub_u32 v13, v11, v13
  v_add_u32 v13, s34, v13
  v_cmp_le_u32 vcc, 10, v13
  v_subrev_u32 v14, 10, v13
  v_and_b32 v15, 0x13, v12
  v_cndmask_b32 v13, v13, v14, vcc
  v_and_b32 v14, 4, v12
  v_lshlrev_b32 v14, 1, v14
  v_or_b32 v15, v15, v14
  v_and_b32 v14, 8, v12
  v_lshrrev_b32 v14, 1, v14
  v_or_b32 v15, v15, v14
  v_mul_lo_u32 v15, v15, s31
  v_lshlrev_b32 v13, 4, v13
  v_add_u32 v22, v15, v13
  v_add_u32 v11, 192, v8
  v_mul_u32_u24 v12, 205, v11
  v_lshrrev_b32 v12, 11, v12
  v_mul_u32_u24 v13, 10, v12
  v_sub_u32 v13, v11, v13
  v_add_u32 v13, s34, v13
  v_cmp_le_u32 vcc, 10, v13
  v_subrev_u32 v14, 10, v13
  v_and_b32 v15, 0x13, v12
  v_cndmask_b32 v13, v13, v14, vcc
  v_and_b32 v14, 4, v12
  v_lshlrev_b32 v14, 1, v14
  v_or_b32 v15, v15, v14
  v_and_b32 v14, 8, v12
  v_lshrrev_b32 v14, 1, v14
  v_or_b32 v15, v15, v14
  v_mul_lo_u32 v15, v15, s31
  v_lshlrev_b32 v13, 4, v13
  v_add_u32 v23, v15, v13
  v_add_u32 v11, 256, v8
  v_mul_u32_u24 v12, 205, v11
  v_lshrrev_b32 v12, 11, v12
  v_mul_u32_u24 v13, 10, v12
  v_sub_u32 v13, v11, v13
  v_add_u32 v13, s34, v13
  v_cmp_le_u32 vcc, 10, v13
  v_subrev_u32 v14, 10, v13
  v_and_b32 v15, 0x13, v12
  v_cndmask_b32 v13, v13, v14, vcc
  v_and_b32 v14, 4, v12
  v_lshlrev_b32 v14, 1, v14
  v_or_b32 v15, v15, v14
  v_and_b32 v14, 8, v12
  v_lshrrev_b32 v14, 1, v14
  v_or_b32 v15, v15, v14
  v_mul_lo_u32 v15, v15, s31
  v_lshlrev_b32 v13, 4, v13
  v_add_u32 v24, v15, v13
  s_cmp_eq_u32 s62, 0
  s_cselect_b32 s57, s32, s33
  s_lshl_b32 s63, s31, 5
  s_lshl_b32 s46, s26, 1
  s_add_u32 s37, s26, 2
  s_cmp_lt_u32 s26, 2
  s_cselect_b32 s46, s46, s37
  s_mul_i32 s47, s31, 640
  s_lshl_b32 s37, s46, 7
  s_add_u32 s56, s56, s37
  s_mul_i32 s37, s46, s31
  s_lshl_b32 s37, s37, 6
  s_add_u32 s57, s57, s37
  s_waitcnt lgkmcnt(0)
  s_mov_b32 s8, s4
  s_mov_b32 s9, s5
  s_cmp_eq_u32 s29, 2
  s_cselect_b32 s12, s48, s6
  s_cselect_b32 s13, s49, s7
  s_cselect_b32 s16, s50, s6
  s_cselect_b32 s17, s51, s7
  s_mov_b32 s20, s54
  s_mov_b32 s21, s55
  s_mov_b32 s24, s52
  s_mov_b32 s25, s53
  s_cmp_eq_u32 s62, 0
  s_cselect_b32 s12, s12, s16
  s_cselect_b32 s13, s13, s17
  s_add_u32 s44, s58, 0
  s_add_u32 s45, s59, 0
  s_add_u32 m0, s44, 0
  s_add_u32 s37, s56, 0
  buffer_load_dwordx4 v16, s[8:11], s37 offen lds
  s_add_u32 m0, s44, 1024
  s_add_u32 s37, s56, 10240
  buffer_load_dwordx4 v16, s[8:11], s37 offen lds
  s_add_u32 m0, s44, 2048
  s_add_u32 s37, s56, 20480
  buffer_load_dwordx4 v16, s[8:11], s37 offen lds
  s_add_u32 m0, s44, 3072
  s_add_u32 s37, s56, 30720
  buffer_load_dwordx4 v16, s[8:11], s37 offen lds
  s_add_u32 m0, s44, 4096
  s_add_u32 s37, s56, 40960
  buffer_load_dwordx4 v16, s[8:11], s37 offen lds
  s_add_u32 m0, s44, 5120
  s_add_u32 s37, s56, 51200
  buffer_load_dwordx4 v16, s[8:11], s37 offen lds
  s_add_u32 m0, s44, 6144
  s_add_u32 s37, s56, 61440
  buffer_load_dwordx4 v16, s[8:11], s37 offen lds
  s_add_u32 m0, s44, 7168
  s_add_u32 s37, s56, 71680
  buffer_load_dwordx4 v16, s[8:11], s37 offen lds
  s_add_u32 m0, s44, 8192
  s_add_u32 s37, s56, 81920
  buffer_load_dwordx4 v16, s[8:11], s37 offen lds
  s_add_u32 m0, s44, 9216
  s_add_u32 s37, s56, 92160
  buffer_load_dwordx4 v16, s[8:11], s37 offen lds
  s_add_u32 m0, s44, 10240
  s_add_u32 s37, s56, 102400
  buffer_load_dwordx4 v16, s[8:11], s37 offen lds
  s_add_u32 m0, s44, 11264
  s_add_u32 s37, s56, 112640
  buffer_load_dwordx4 v16, s[8:11], s37 offen lds
  s_add_u32 m0, s44, 12288
  s_add_u32 s37, s56, 122880
  buffer_load_dwordx4 v16, s[8:11], s37 offen lds
  s_add_u32 m0, s44, 13312
  s_add_u32 s37, s56, 133120
  buffer_load_dwordx4 v16, s[8:11], s37 offen lds
  s_add_u32 m0, s44, 14336
  s_add_u32 s37, s56, 143360
  buffer_load_dwordx4 v16, s[8:11], s37 offen lds
  s_add_u32 m0, s44, 15360
  s_add_u32 s37, s56, 153600
  buffer_load_dwordx4 v16, s[8:11], s37 offen lds
  s_add_u32 s56, s56, 128
  s_add_u32 m0, s45, 0
  s_nop 0
  buffer_load_dwordx4 v20, s[12:15], s57 offen lds
  s_add_u32 m0, s45, 1024
  s_nop 0
  buffer_load_dwordx4 v21, s[12:15], s57 offen lds
  s_add_u32 m0, s45, 2048
  s_nop 0
  buffer_load_dwordx4 v22, s[12:15], s57 offen lds
  s_add_u32 m0, s45, 3072
  s_nop 0
  buffer_load_dwordx4 v23, s[12:15], s57 offen lds
  s_add_u32 m0, s45, 4096
  s_nop 0
  buffer_load_dwordx4 v24, s[12:15], s57 offen lds
  s_add_u32 s57, s57, s63
  s_add_u32 m0, s45, 5120
  s_nop 0
  buffer_load_dwordx4 v20, s[12:15], s57 offen lds
  s_add_u32 m0, s45, 6144
  s_nop 0
  buffer_load_dwordx4 v21, s[12:15], s57 offen lds
  s_add_u32 m0, s45, 7168
  s_nop 0
  buffer_load_dwordx4 v22, s[12:15], s57 offen lds
  s_add_u32 m0, s45, 8192
  s_nop 0
  buffer_load_dwordx4 v23, s[12:15], s57 offen lds
  s_add_u32 m0, s45, 9216
  s_nop 0
  buffer_load_dwordx4 v24, s[12:15], s57 offen lds
  s_add_u32 s57, s57, s63
  s_add_u32 s46, s46, 1
  s_cmp_eq_u32 s46, 10
  s_cselect_b32 s37, 1280, 0
  s_cselect_b32 s38, s47, 0
  s_cselect_b32 s46, 0, s46
  s_sub_u32 s56, s56, s37
  s_sub_u32 s57, s57, s38
  s_add_u32 s44, s58, 53248
  s_add_u32 s45, s59, 53248
  s_add_u32 m0, s44, 0
  s_add_u32 s37, s56, 0
  buffer_load_dwordx4 v16, s[8:11], s37 offen lds
  s_add_u32 m0, s44, 1024
  s_add_u32 s37, s56, 10240
  buffer_load_dwordx4 v16, s[8:11], s37 offen lds
  s_add_u32 m0, s44, 2048
  s_add_u32 s37, s56, 20480
  buffer_load_dwordx4 v16, s[8:11], s37 offen lds
  s_add_u32 m0, s44, 3072
  s_add_u32 s37, s56, 30720
  buffer_load_dwordx4 v16, s[8:11], s37 offen lds
  s_add_u32 m0, s44, 4096
  s_add_u32 s37, s56, 40960
  buffer_load_dwordx4 v16, s[8:11], s37 offen lds
  s_add_u32 m0, s44, 5120
  s_add_u32 s37, s56, 51200
  buffer_load_dwordx4 v16, s[8:11], s37 offen lds
  s_add_u32 m0, s44, 6144
  s_add_u32 s37, s56, 61440
  buffer_load_dwordx4 v16, s[8:11], s37 offen lds
  s_add_u32 m0, s44, 7168
  s_add_u32 s37, s56, 71680
  buffer_load_dwordx4 v16, s[8:11], s37 offen lds
  s_add_u32 m0, s44, 8192
  s_add_u32 s37, s56, 81920
  buffer_load_dwordx4 v16, s[8:11], s37 offen lds
  s_add_u32 m0, s44, 9216
  s_add_u32 s37, s56, 92160
  buffer_load_dwordx4 v16, s[8:11], s37 offen lds
  s_add_u32 m0, s44, 10240
  s_add_u32 s37, s56, 102400
  buffer_load_dwordx4 v16, s[8:11], s37 offen lds
  s_add_u32 m0, s44, 11264
  s_add_u32 s37, s56, 112640
  buffer_load_dwordx4 v16, s[8:11], s37 offen lds
  s_add_u32 m0, s44, 12288
  s_add_u32 s37, s56, 122880
  buffer_load_dwordx4 v16, s[8:11], s37 offen lds
  s_add_u32 m0, s44, 13312
  s_add_u32 s37, s56, 133120
  buffer_load_dwordx4 v16, s[8:11], s37 offen lds
  s_add_u32 m0, s44, 14336
  s_add_u32 s37, s56, 143360
  buffer_load_dwordx4 v16, s[8:11], s37 offen lds
  s_add_u32 m0, s44, 15360
  s_add_u32 s37, s56, 153600
  buffer_load_dwordx4 v16, s[8:11], s37 offen lds
  s_add_u32 s56, s56, 128
  s_add_u32 m0, s45, 0
  s_nop 0
  buffer_load_dwordx4 v20, s[12:15], s57 offen lds
  s_add_u32 m0, s45, 1024
  s_nop 0
  buffer_load_dwordx4 v21, s[12:15], s57 offen lds
  s_add_u32 m0, s45, 2048
  s_nop 0
  buffer_load_dwordx4 v22, s[12:15], s57 offen lds
  s_add_u32 m0, s45, 3072
  s_nop 0
  buffer_load_dwordx4 v23, s[12:15], s57 offen lds
  s_add_u32 m0, s45, 4096
  s_nop 0
  buffer_load_dwordx4 v24, s[12:15], s57 offen lds
  s_add_u32 s57, s57, s63
  s_add_u32 m0, s45, 5120
  s_nop 0
  buffer_load_dwordx4 v20, s[12:15], s57 offen lds
  s_add_u32 m0, s45, 6144
  s_nop 0
  buffer_load_dwordx4 v21, s[12:15], s57 offen lds
  s_add_u32 m0, s45, 7168
  s_nop 0
  buffer_load_dwordx4 v22, s[12:15], s57 offen lds
  s_add_u32 m0, s45, 8192
  s_nop 0
  buffer_load_dwordx4 v23, s[12:15], s57 offen lds
  s_add_u32 m0, s45, 9216
  s_nop 0
  buffer_load_dwordx4 v24, s[12:15], s57 offen lds
  s_add_u32 s57, s57, s63
  s_add_u32 s46, s46, 1
  s_cmp_eq_u32 s46, 10
  s_cselect_b32 s37, 1280, 0
  s_cselect_b32 s38, s47, 0
  s_cselect_b32 s46, 0, s46
  s_sub_u32 s56, s56, s37
  s_sub_u32 s57, s57, s38
  s_waitcnt vmcnt(26)
  s_barrier
  s_add_u32 s44, s58, 106496
  s_add_u32 s45, s59, 106496
  s_add_u32 m0, s44, 0
  s_add_u32 s37, s56, 0
  buffer_load_dwordx4 v16, s[8:11], s37 offen lds
  s_add_u32 m0, s44, 1024
  s_add_u32 s37, s56, 10240
  buffer_load_dwordx4 v16, s[8:11], s37 offen lds
  s_add_u32 m0, s44, 2048
  s_add_u32 s37, s56, 20480
  buffer_load_dwordx4 v16, s[8:11], s37 offen lds
  s_add_u32 m0, s44, 3072
  s_add_u32 s37, s56, 30720
  buffer_load_dwordx4 v16, s[8:11], s37 offen lds
  s_add_u32 m0, s44, 4096
  s_add_u32 s37, s56, 40960
  buffer_load_dwordx4 v16, s[8:11], s37 offen lds
  s_add_u32 m0, s44, 5120
  s_add_u32 s37, s56, 51200
  buffer_load_dwordx4 v16, s[8:11], s37 offen lds
  s_add_u32 m0, s44, 6144
  s_add_u32 s37, s56, 61440
  buffer_load_dwordx4 v16, s[8:11], s37 offen lds
  s_add_u32 m0, s44, 7168
  s_add_u32 s37, s56, 71680
  buffer_load_dwordx4 v16, s[8:11], s37 offen lds
  s_add_u32 m0, s44, 8192
  s_add_u32 s37, s56, 81920
  buffer_load_dwordx4 v16, s[8:11], s37 offen lds
  s_add_u32 m0, s44, 9216
  s_add_u32 s37, s56, 92160
  buffer_load_dwordx4 v16, s[8:11], s37 offen lds
  s_add_u32 m0, s44, 10240
  s_add_u32 s37, s56, 102400
  buffer_load_dwordx4 v16, s[8:11], s37 offen lds
  s_add_u32 m0, s44, 11264
  s_add_u32 s37, s56, 112640
  buffer_load_dwordx4 v16, s[8:11], s37 offen lds
  s_add_u32 m0, s44, 12288
  s_add_u32 s37, s56, 122880
  buffer_load_dwordx4 v16, s[8:11], s37 offen lds
  s_add_u32 m0, s44, 13312
  s_add_u32 s37, s56, 133120
  buffer_load_dwordx4 v16, s[8:11], s37 offen lds
  s_add_u32 m0, s44, 14336
  s_add_u32 s37, s56, 143360
  buffer_load_dwordx4 v16, s[8:11], s37 offen lds
  s_add_u32 m0, s44, 15360
  s_add_u32 s37, s56, 153600
  buffer_load_dwordx4 v16, s[8:11], s37 offen lds
  s_add_u32 s56, s56, 128
  s_add_u32 m0, s45, 0
  s_nop 0
  buffer_load_dwordx4 v20, s[12:15], s57 offen lds
  s_add_u32 m0, s45, 1024
  s_nop 0
  buffer_load_dwordx4 v21, s[12:15], s57 offen lds
  s_add_u32 m0, s45, 2048
  s_nop 0
  buffer_load_dwordx4 v22, s[12:15], s57 offen lds
  s_add_u32 m0, s45, 3072
  s_nop 0
  buffer_load_dwordx4 v23, s[12:15], s57 offen lds
  s_add_u32 m0, s45, 4096
  s_nop 0
  buffer_load_dwordx4 v24, s[12:15], s57 offen lds
  s_add_u32 s57, s57, s63
  s_add_u32 m0, s45, 5120
  s_nop 0
  buffer_load_dwordx4 v20, s[12:15], s57 offen lds
  s_add_u32 m0, s45, 6144
  s_nop 0
  buffer_load_dwordx4 v21, s[12:15], s57 offen lds
  s_add_u32 m0, s45, 7168
  s_nop 0
  buffer_load_dwordx4 v22, s[12:15], s57 offen lds
  s_add_u32 m0, s45, 8192
  s_nop 0
  buffer_load_dwordx4 v23, s[12:15], s57 offen lds
  s_add_u32 m0, s45, 9216
  s_nop 0
  buffer_load_dwordx4 v24, s[12:15], s57 offen lds
  s_add_u32 s57, s57, s63
  s_add_u32 s46, s46, 1
  s_cmp_eq_u32 s46, 10
  s_cselect_b32 s37, 1280, 0
  s_cselect_b32 s38, s47, 0
  s_cselect_b32 s46, 0, s46
  s_sub_u32 s56, s56, s37
  s_sub_u32 s57, s57, s38
  s_mov_b32 s60, 0
  s_mov_b32 s36, 7
L_dloop:
  s_waitcnt vmcnt(26)
  s_barrier
  s_add_u32 s44, s58, s60
  s_add_u32 s45, s59, s60
  s_add_u32 m0, s44, 0
  s_add_u32 s37, s56, 0
  buffer_load_dwordx4 v16, s[8:11], s37 offen lds
  s_add_u32 m0, s44, 1024
  s_add_u32 s37, s56, 10240
  buffer_load_dwordx4 v16, s[8:11], s37 offen lds
  s_add_u32 m0, s44, 2048
  s_add_u32 s37, s56, 20480
  buffer_load_dwordx4 v16, s[8:11], s37 offen lds
  s_add_u32 m0, s44, 3072
  s_add_u32 s37, s56, 30720
  buffer_load_dwordx4 v16, s[8:11], s37 offen lds
  s_add_u32 m0, s44, 4096
  s_add_u32 s37, s56, 40960
  buffer_load_dwordx4 v16, s[8:11], s37 offen lds
  s_add_u32 m0, s44, 5120
  s_add_u32 s37, s56, 51200
  buffer_load_dwordx4 v16, s[8:11], s37 offen lds
  s_add_u32 m0, s44, 6144
  s_add_u32 s37, s56, 61440
  buffer_load_dwordx4 v16, s[8:11], s37 offen lds
  s_add_u32 m0, s44, 7168
  s_add_u32 s37, s56, 71680
  buffer_load_dwordx4 v16, s[8:11], s37 offen lds
  s_add_u32 m0, s44, 8192
  s_add_u32 s37, s56, 81920
  buffer_load_dwordx4 v16, s[8:11], s37 offen lds
  s_add_u32 m0, s44, 9216
  s_add_u32 s37, s56, 92160
  buffer_load_dwordx4 v16, s[8:11], s37 offen lds
  s_add_u32 m0, s44, 10240
  s_add_u32 s37, s56, 102400
  buffer_load_dwordx4 v16, s[8:11], s37 offen lds
  s_add_u32 m0, s44, 11264
  s_add_u32 s37, s56, 112640
  buffer_load_dwordx4 v16, s[8:11], s37 offen lds
  s_add_u32 m0, s44, 12288
  s_add_u32 s37, s56, 122880
  buffer_load_dwordx4 v16, s[8:11], s37 offen lds
  s_add_u32 m0, s44, 13312
  s_add_u32 s37, s56, 133120
  buffer_load_dwordx4 v16, s[8:11], s37 offen lds
  s_add_u32 m0, s44, 14336
  s_add_u32 s37, s56, 143360
  buffer_load_dwordx4 v16, s[8:11], s37 offen lds
  s_add_u32 m0, s44, 15360
  s_add_u32 s37, s56, 153600
  buffer_load_dwordx4 v16, s[8:11], s37 offen lds
  s_add_u32 s56, s56, 128
  s_add_u32 m0, s45, 0
  s_nop 0
  buffer_load_dwordx4 v20, s[12:15], s57 offen lds
  s_add_u32 m0, s45, 1024
  s_nop 0
  buffer_load_dwordx4 v21, s[12:15], s57 offen lds
  s_add_u32 m0, s45, 2048
  s_nop 0
  buffer_load_dwordx4 v22, s[12:15], s57 offen lds
  s_add_u32 m0, s45, 3072
  s_nop 0
  buffer_load_dwordx4 v23, s[12:15], s57 offen lds
  s_add_u32 m0, s45, 4096
  s_nop 0
  buffer_load_dwordx4 v24, s[12:15], s57 offen lds
  s_add_u32 s57, s57, s63
  s_add_u32 m0, s45, 5120
  s_nop 0
  buffer_load_dwordx4 v20, s[12:15], s57 offen lds
  s_add_u32 m0, s45, 6144
  s_nop 0
  buffer_load_dwordx4 v21, s[12:15], s57 offen lds
  s_add_u32 m0, s45, 7168
  s_nop 0
  buffer_load_dwordx4 v22, s[12:15], s57 offen lds
  s_add_u32 m0, s45, 8192
  s_nop 0
  buffer_load_dwordx4 v23, s[12:15], s57 offen lds
  s_add_u32 m0, s45, 9216
  s_nop 0
  buffer_load_dwordx4 v24, s[12:15], s57 offen lds
  s_add_u32 s57, s57, s63
  s_add_u32 s46, s46, 1
  s_cmp_eq_u32 s46, 10
  s_cselect_b32 s37, 1280, 0
  s_cselect_b32 s38, s47, 0
  s_cselect_b32 s46, 0, s46
  s_sub_u32 s56, s56, s37
  s_sub_u32 s57, s57, s38
  s_add_u32 s60, s60, 53248
  s_cmp_eq_u32 s60, 159744
  s_cselect_b32 s60, 0, s60
  s_sub_u32 s36, s36, 1
  s_cmp_lg_u32 s36, 0
  s_cbranch_scc1 L_dloop
  s_waitcnt vmcnt(26)
  s_barrier
  s_waitcnt vmcnt(0)
  s_barrier
  s_barrier
  s_barrier
  s_cmp_eq_u32 s29, 1
  s_cbranch_scc1 L_kv_final
  s_endpgm
L_helpers:
  s_setprio 3
  s_waitcnt lgkmcnt(0)
  s_mov_b32 s8, s4
  s_mov_b32 s9, s5
  s_cmp_eq_u32 s29, 2
  s_cselect_b32 s12, s48, s6
  s_cselect_b32 s13, s49, s7
  s_cselect_b32 s16, s50, s6
  s_cselect_b32 s17, s51, s7
  s_mov_b32 s20, s54
  s_mov_b32 s21, s55
  s_mov_b32 s24, s52
  s_mov_b32 s25, s53
  s_cmp_eq_u32 s28, 7
  s_cbranch_scc1 L_prod3
  s_cmp_eq_u32 s2, 0
  s_cbranch_scc0 L_h0_nononce
  s_memrealtime s[92:93]
  s_waitcnt lgkmcnt(0)
  s_or_b32 s92, s92, 1
  v_mov_b32 v11, 0
  v_mov_b32 v12, s92
  v_cmp_eq_u32 vcc, 0, v8
  s_and_saveexec_b64 s[64:65], vcc
  global_store_dword v11, v12, s[24:25] offset:0 sc1
  s_mov_b64 exec, s[64:65]
L_h0_nononce:
  s_lshl_b32 s37, s26, 8
  s_lshl_b32 s38, s27, 3
  s_add_u32 s62, s37, s38
  v_add_u32 v11, s62, v10
  v_mul_u32_u24 v11, 1280, v11
  v_lshlrev_b32 v14, 4, v9
  v_add_u32 v11, v11, v14
  buffer_load_dwordx4 v[100:103], v11, s[8:11], 0 offen offset:0
  buffer_load_dwordx4 v[104:107], v11, s[8:11], 0 offen offset:256
  buffer_load_dwordx4 v[108:111], v11, s[8:11], 0 offen offset:512
  buffer_load_dwordx4 v[112:115], v11, s[8:11], 0 offen offset:768
  buffer_load_dwordx4 v[116:119], v11, s[8:11], 0 offen offset:1024
  v_add_u32 v11, 5120, v11
  buffer_load_dwordx4 v[132:135], v11, s[8:11], 0 offen offset:0
  buffer_load_dwordx4 v[136:139], v11, s[8:11], 0 offen offset:256
  buffer_load_dwordx4 v[140:143], v11, s[8:11], 0 offen offset:512
  buffer_load_dwordx4 v[144:147], v11, s[8:11], 0 offen offset:768
  buffer_load_dwordx4 v[148:151], v11, s[8:11], 0 offen offset:1024
  v_mov_b32 v26, 0x3f803f80
  s_mov_b32 s67, 0
  s_mov_b32 s68, 0
  s_waitcnt vmcnt(5)
  v_mov_b32 v120, 0
  v_mov_b32 v121, 0
  v_mov_b32 v122, 0
  v_mov_b32 v123, 0
  v_dot2c_f32_bf16 v120, v100, v26
  v_dot2c_f32_bf16 v122, v100, v100
  v_dot2c_f32_bf16 v121, v101, v26
  v_dot2c_f32_bf16 v123, v101, v101
  v_dot2c_f32_bf16 v120, v102, v26
  v_dot2c_f32_bf16 v122, v102, v102
  v_dot2c_f32_bf16 v121, v103, v26
  v_dot2c_f32_bf16 v123, v103, v103
  v_dot2c_f32_bf16 v120, v104, v26
  v_dot2c_f32_bf16 v122, v104, v104
  v_dot2c_f32_bf16 v121, v105, v26
  v_dot2c_f32_bf16 v123, v105, v105
  v_dot2c_f32_bf16 v120, v106, v26
  v_dot2c_f32_bf16 v122, v106, v106
  v_dot2c_f32_bf16 v121, v107, v26
  v_dot2c_f32_bf16 v123, v107, v107
  v_dot2c_f32_bf16 v120, v108, v26
  v_dot2c_f32_bf16 v122, v108, v108
  v_dot2c_f32_bf16 v121, v109, v26
  v_dot2c_f32_bf16 v123, v109, v109
  v_dot2c_f32_bf16 v120, v110, v26
  v_dot2c_f32_bf16 v122, v110, v110
  v_dot2c_f32_bf16 v121, v111, v26
  v_dot2c_f32_bf16 v123, v111, v111
  v_dot2c_f32_bf16 v120, v112, v26
  v_dot2c_f32_bf16 v122, v112, v112
  v_dot2c_f32_bf16 v121, v113, v26
  v_dot2c_f32_bf16 v123, v113, v113
  v_dot2c_f32_bf16 v120, v114, v26
  v_dot2c_f32_bf16 v122, v114, v114
  v_dot2c_f32_bf16 v121, v115, v26
  v_dot2c_f32_bf16 v123, v115, v115
  v_dot2c_f32_bf16 v120, v116, v26
  v_dot2c_f32_bf16 v122, v116, v116
  v_dot2c_f32_bf16 v121, v117, v26
  v_dot2c_f32_bf16 v123, v117, v117
  v_dot2c_f32_bf16 v120, v118, v26
  v_dot2c_f32_bf16 v122, v118, v118
  v_dot2c_f32_bf16 v121, v119, v26
  v_dot2c_f32_bf16 v123, v119, v119
  s_nop 2
  v_add_f32 v120, v120, v121
  v_add_f32 v122, v122, v123
  s_nop 0
  v_add_f32_dpp v120, v120, v120 quad_perm:[1,0,3,2] row_mask:0xf bank_mask:0xf
  v_add_f32_dpp v122, v122, v122 quad_perm:[1,0,3,2] row_mask:0xf bank_mask:0xf
  s_nop 0
  s_nop 0
  v_add_f32_dpp v120, v120, v120 quad_perm:[2,3,0,1] row_mask:0xf bank_mask:0xf
  v_add_f32_dpp v122, v122, v122 quad_perm:[2,3,0,1] row_mask:0xf bank_mask:0xf
  s_nop 0
  s_nop 0
  v_add_f32_dpp v120, v120, v120 row_half_mirror row_mask:0xf bank_mask:0xf
  v_add_f32_dpp v122, v122, v122 row_half_mirror row_mask:0xf bank_mask:0xf
  s_nop 0
  s_nop 0
  v_add_f32_dpp v120, v120, v120 row_mirror row_mask:0xf bank_mask:0xf
  v_add_f32_dpp v122, v122, v122 row_mirror row_mask:0xf bank_mask:0xf
  s_nop 0
  v_mul_f32 v126, 0x3acccccd, v120
  v_mul_f32 v121, v126, v126
  v_mul_f32 v122, 0x3acccccd, v122
  v_sub_f32 v122, v122, v121
  v_max_f32 v122, 0, v122
  v_add_f32 v122, 0x3727c5ac, v122
  v_rsq_f32 v127, v122
  s_nop 0
  v_mov_b32 v56, v126
  v_mov_b32 v57, v127
  s_waitcnt vmcnt(0)
  v_mov_b32 v11, 0
  global_load_dword v60, v11, s[24:25] offset:0 sc1
  v_mov_b32 v100, v132
  v_mov_b32 v101, v133
  v_mov_b32 v102, v134
  v_mov_b32 v103, v135
  v_mov_b32 v104, v136
  v_mov_b32 v105, v137
  v_mov_b32 v106, v138
  v_mov_b32 v107, v139
  v_mov_b32 v108, v140
  v_mov_b32 v109, v141
  v_mov_b32 v110, v142
  v_mov_b32 v111, v143
  v_mov_b32 v112, v144
  v_mov_b32 v113, v145
  v_mov_b32 v114, v146
  v_mov_b32 v115, v147
  v_mov_b32 v116, v148
  v_mov_b32 v117, v149
  v_mov_b32 v118, v150
  v_mov_b32 v119, v151
  v_mov_b32 v120, 0
  v_mov_b32 v121, 0
  v_mov_b32 v122, 0
  v_mov_b32 v123, 0
  v_dot2c_f32_bf16 v120, v100, v26
  v_dot2c_f32_bf16 v122, v100, v100
  v_dot2c_f32_bf16 v121, v101, v26
  v_dot2c_f32_bf16 v123, v101, v101
  v_dot2c_f32_bf16 v120, v102, v26
  v_dot2c_f32_bf16 v122, v102, v102
  v_dot2c_f32_bf16 v121, v103, v26
  v_dot2c_f32_bf16 v123, v103, v103
  v_dot2c_f32_bf16 v120, v104, v26
  v_dot2c_f32_bf16 v122, v104, v104
  v_dot2c_f32_bf16 v121, v105, v26
  v_dot2c_f32_bf16 v123, v105, v105
  v_dot2c_f32_bf16 v120, v106, v26
  v_dot2c_f32_bf16 v122, v106, v106
  v_dot2c_f32_bf16 v121, v107, v26
  v_dot2c_f32_bf16 v123, v107, v107
  v_dot2c_f32_bf16 v120, v108, v26
  v_dot2c_f32_bf16 v122, v108, v108
  v_dot2c_f32_bf16 v121, v109, v26
  v_dot2c_f32_bf16 v123, v109, v109
  v_dot2c_f32_bf16 v120, v110, v26
  v_dot2c_f32_bf16 v122, v110, v110
  v_dot2c_f32_bf16 v121, v111, v26
  v_dot2c_f32_bf16 v123, v111, v111
  v_dot2c_f32_bf16 v120, v112, v26
  v_dot2c_f32_bf16 v122, v112, v112
  v_dot2c_f32_bf16 v121, v113, v26
  v_dot2c_f32_bf16 v123, v113, v113
  v_dot2c_f32_bf16 v120, v114, v26
  v_dot2c_f32_bf16 v122, v114, v114
  v_dot2c_f32_bf16 v121, v115, v26
  v_dot2c_f32_bf16 v123, v115, v115
  v_dot2c_f32_bf16 v120, v116, v26
  v_dot2c_f32_bf16 v122, v116, v116
  v_dot2c_f32_bf16 v121, v117, v26
  v_dot2c_f32_bf16 v123, v117, v117
  v_dot2c_f32_bf16 v120, v118, v26
  v_dot2c_f32_bf16 v122, v118, v118
  v_dot2c_f32_bf16 v121, v119, v26
  v_dot2c_f32_bf16 v123, v119, v119
  s_nop 2
  v_add_f32 v120, v120, v121
  v_add_f32 v122, v122, v123
  s_nop 0
  v_add_f32_dpp v120, v120, v120 quad_perm:[1,0,3,2] row_mask:0xf bank_mask:0xf
  v_add_f32_dpp v122, v122, v122 quad_perm:[1,0,3,2] row_mask:0xf bank_mask:0xf
  s_nop 0
  s_nop 0
  v_add_f32_dpp v120, v120, v120 quad_perm:[2,3,0,1] row_mask:0xf bank_mask:0xf
  v_add_f32_dpp v122, v122, v122 quad_perm:[2,3,0,1] row_mask:0xf bank_mask:0xf
  s_nop 0
  s_nop 0
  v_add_f32_dpp v120, v120, v120 row_half_mirror row_mask:0xf bank_mask:0xf
  v_add_f32_dpp v122, v122, v122 row_half_mirror row_mask:0xf bank_mask:0xf
  s_nop 0
  s_nop 0
  v_add_f32_dpp v120, v120, v120 row_mirror row_mask:0xf bank_mask:0xf
  v_add_f32_dpp v122, v122, v122 row_mirror row_mask:0xf bank_mask:0xf
  s_nop 0
  v_mul_f32 v126, 0x3acccccd, v120
  v_mul_f32 v121, v126, v126
  v_mul_f32 v122, 0x3acccccd, v122
  v_sub_f32 v122, v122, v121
  v_max_f32 v122, 0, v122
  v_add_f32 v122, 0x3727c5ac, v122
  v_rsq_f32 v127, v122
  s_nop 0
  v_mov_b32 v58, v126
  v_mov_b32 v59, v127
  s_barrier
  s_barrier
  s_cmp_lg_u32 s68, 0
  s_cbranch_scc1 L_tp_l1
  s_waitcnt vmcnt(0)
  v_readfirstlane_b32 s68, v60
  s_nop 3
  s_cmp_eq_u32 s68, 0
  s_cbranch_scc1 L_tpr_l1
  v_lshlrev_b32 v13, 4, v10
  s_lshl_b32 s37, s62, 4
  s_add_u32 s37, s37, 8978432
  v_mov_b32 v29, s68
  v_mov_b32 v31, s68
  v_mov_b32 v33, s68
  v_mov_b32 v35, s68
  v_mov_b32 v28, v56
  v_mov_b32 v30, v57
  v_mov_b32 v32, v58
  v_mov_b32 v34, v59
  v_cmp_eq_u32 vcc, 0, v9
  s_and_saveexec_b64 s[64:65], vcc
  buffer_store_dwordx4 v[28:31], v13, s[20:23], s37 offen sc1
  buffer_store_dwordx4 v[32:35], v13, s[20:23], s37 offen offset:64 sc1
  s_mov_b64 exec, s[64:65]
  s_branch L_tp_l1
L_tpr_l1:
  v_mov_b32 v11, 0
  global_load_dword v60, v11, s[24:25] offset:0 sc1
L_tp_l1:
  s_barrier
  s_cmp_lg_u32 s68, 0
  s_cbranch_scc1 L_tp_l2
  s_waitcnt vmcnt(0)
  v_readfirstlane_b32 s68, v60
  s_nop 3
  s_cmp_eq_u32 s68, 0
  s_cbranch_scc1 L_tpr_l2
  v_lshlrev_b32 v13, 4, v10
  s_lshl_b32 s37, s62, 4
  s_add_u32 s37, s37, 8978432
  v_mov_b32 v29, s68
  v_mov_b32 v31, s68
  v_mov_b32 v33, s68
  v_mov_b32 v35, s68
  v_mov_b32 v28, v56
  v_mov_b32 v30, v57
  v_mov_b32 v32, v58
  v_mov_b32 v34, v59
  v_cmp_eq_u32 vcc, 0, v9
  s_and_saveexec_b64 s[64:65], vcc
  buffer_store_dwordx4 v[28:31], v13, s[20:23], s37 offen sc1
  buffer_store_dwordx4 v[32:35], v13, s[20:23], s37 offen offset:64 sc1
  s_mov_b64 exec, s[64:65]
  s_branch L_tp_l2
L_tpr_l2:
  v_mov_b32 v11, 0
  global_load_dword v60, v11, s[24:25] offset:0 sc1
L_tp_l2:
  s_barrier
  s_cmp_lg_u32 s68, 0
  s_cbranch_scc1 L_tp_l3
  s_waitcnt vmcnt(0)
  v_readfirstlane_b32 s68, v60
  s_nop 3
  s_cmp_eq_u32 s68, 0
  s_cbranch_scc1 L_tpr_l3
  v_lshlrev_b32 v13, 4, v10
  s_lshl_b32 s37, s62, 4
  s_add_u32 s37, s37, 8978432
  v_mov_b32 v29, s68
  v_mov_b32 v31, s68
  v_mov_b32 v33, s68
  v_mov_b32 v35, s68
  v_mov_b32 v28, v56
  v_mov_b32 v30, v57
  v_mov_b32 v32, v58
  v_mov_b32 v34, v59
  v_cmp_eq_u32 vcc, 0, v9
  s_and_saveexec_b64 s[64:65], vcc
  buffer_store_dwordx4 v[28:31], v13, s[20:23], s37 offen sc1
  buffer_store_dwordx4 v[32:35], v13, s[20:23], s37 offen offset:64 sc1
  s_mov_b64 exec, s[64:65]
  s_branch L_tp_l3
L_tpr_l3:
  v_mov_b32 v11, 0
  global_load_dword v60, v11, s[24:25] offset:0 sc1
L_tp_l3:
  s_barrier
  s_cmp_lg_u32 s68, 0
  s_cbranch_scc1 L_tp_l4
  s_waitcnt vmcnt(0)
  v_readfirstlane_b32 s68, v60
  s_nop 3
  s_cmp_eq_u32 s68, 0
  s_cbranch_scc1 L_tpr_l4
  v_lshlrev_b32 v13, 4, v10
  s_lshl_b32 s37, s62, 4
  s_add_u32 s37, s37, 8978432
  v_mov_b32 v29, s68
  v_mov_b32 v31, s68
  v_mov_b32 v33, s68
  v_mov_b32 v35, s68
  v_mov_b32 v28, v56
  v_mov_b32 v30, v57
  v_mov_b32 v32, v58
  v_mov_b32 v34, v59
  v_cmp_eq_u32 vcc, 0, v9
  s_and_saveexec_b64 s[64:65], vcc
  buffer_store_dwordx4 v[28:31], v13, s[20:23], s37 offen sc1
  buffer_store_dwordx4 v[32:35], v13, s[20:23], s37 offen offset:64 sc1
  s_mov_b64 exec, s[64:65]
  s_branch L_tp_l4
L_tpr_l4:
L_tp_l4:
  s_barrier
  s_lshl_b32 s37, s26, 12
  s_add_u32 s37, s37, 8978432
  v_lshlrev_b32 v11, 6, v8
  buffer_load_dwordx4 v[100:103], v11, s[20:23], s37 offen offset:0 sc1
  buffer_load_dwordx4 v[104:107], v11, s[20:23], s37 offen offset:16 sc1
  buffer_load_dwordx4 v[108:111], v11, s[20:23], s37 offen offset:32 sc1
  buffer_load_dwordx4 v[112:115], v11, s[20:23], s37 offen offset:48 sc1
  s_barrier
  s_barrier
  s_barrier
  s_waitcnt vmcnt(0)
  s_cmp_eq_u32 s68, 0
  s_cbranch_scc1 L_h0_okA
  v_cmp_eq_u32 vcc, s68, v101
  s_mov_b64 s[92:93], vcc
  v_cmp_eq_u32 vcc, s68, v103
  s_and_b64 s[92:93], s[92:93], vcc
  v_cmp_eq_u32 vcc, s68, v105
  s_and_b64 s[92:93], s[92:93], vcc
  v_cmp_eq_u32 vcc, s68, v107
  s_and_b64 s[92:93], s[92:93], vcc
  v_cmp_eq_u32 vcc, s68, v109
  s_and_b64 s[92:93], s[92:93], vcc
  v_cmp_eq_u32 vcc, s68, v111
  s_and_b64 s[92:93], s[92:93], vcc
  v_cmp_eq_u32 vcc, s68, v113
  s_and_b64 s[92:93], s[92:93], vcc
  v_cmp_eq_u32 vcc, s68, v115
  s_and_b64 s[92:93], s[92:93], vcc
  s_cmp_eq_u64 s[92:93], -1
  s_cbranch_scc0 L_chk_no_a
  v_mov_b32 v116, v100
  v_mov_b32 v117, v102
  v_mov_b32 v118, v104
  v_mov_b32 v119, v106
  v_mov_b32 v120, v108
  v_mov_b32 v121, v110
  v_mov_b32 v122, v112
  v_mov_b32 v123, v114
  s_cmp_eq_u32 s29, 1
  s_cbranch_scc1 L_wsk_a
  v_lshlrev_b32 v13, 5, v8
  v_add_u32 v13, 159744, v13
  ds_write_b128 v13, v[116:119]
  ds_write_b128 v13, v[120:123] offset:16
  s_branch L_wsd_a
L_wsk_a:
  v_mov_b32 v124, v116
  v_mov_b32 v128, v117
  v_mov_b32 v125, v118
  v_mov_b32 v129, v119
  v_mov_b32 v126, v120
  v_mov_b32 v130, v121
  v_mov_b32 v127, v122
  v_mov_b32 v131, v123
  v_lshlrev_b32 v13, 4, v8
  v_add_u32 v13, 159744, v13
  ds_write_b128 v13, v[124:127]
  ds_write_b128 v13, v[128:131] offset:1024
L_wsd_a:
  s_mov_b32 s67, 1
L_chk_no_a:
  s_cmp_eq_u32 s67, 1
  s_cbranch_scc1 L_h0_okA
  s_lshl_b32 s37, s26, 12
  s_add_u32 s37, s37, 8978432
  v_lshlrev_b32 v11, 6, v8
  buffer_load_dwordx4 v[100:103], v11, s[20:23], s37 offen offset:0 sc1
  buffer_load_dwordx4 v[104:107], v11, s[20:23], s37 offen offset:16 sc1
  buffer_load_dwordx4 v[108:111], v11, s[20:23], s37 offen offset:32 sc1
  buffer_load_dwordx4 v[112:115], v11, s[20:23], s37 offen offset:48 sc1
L_h0_okA:
  s_barrier
  s_barrier
  s_cmp_eq_u32 s67, 1
  s_cbranch_scc1 L_h0_okB
  s_cmp_eq_u32 s68, 0
  s_cbranch_scc1 L_h0_okB
  s_waitcnt vmcnt(0)
  v_cmp_eq_u32 vcc, s68, v101
  s_mov_b64 s[92:93], vcc
  v_cmp_eq_u32 vcc, s68, v103
  s_and_b64 s[92:93], s[92:93], vcc
  v_cmp_eq_u32 vcc, s68, v105
  s_and_b64 s[92:93], s[92:93], vcc
  v_cmp_eq_u32 vcc, s68, v107
  s_and_b64 s[92:93], s[92:93], vcc
  v_cmp_eq_u32 vcc, s68, v109
  s_and_b64 s[92:93], s[92:93], vcc
  v_cmp_eq_u32 vcc, s68, v111
  s_and_b64 s[92:93], s[92:93], vcc
  v_cmp_eq_u32 vcc, s68, v113
  s_and_b64 s[92:93], s[92:93], vcc
  v_cmp_eq_u32 vcc, s68, v115
  s_and_b64 s[92:93], s[92:93], vcc
  s_cmp_eq_u64 s[92:93], -1
  s_cbranch_scc0 L_chk_no_b
  v_mov_b32 v116, v100
  v_mov_b32 v117, v102
  v_mov_b32 v118, v104
  v_mov_b32 v119, v106
  v_mov_b32 v120, v108
  v_mov_b32 v121, v110
  v_mov_b32 v122, v112
  v_mov_b32 v123, v114
  s_cmp_eq_u32 s29, 1
  s_cbranch_scc1 L_wsk_b
  v_lshlrev_b32 v13, 5, v8
  v_add_u32 v13, 159744, v13
  ds_write_b128 v13, v[116:119]
  ds_write_b128 v13, v[120:123] offset:16
  s_branch L_wsd_b
L_wsk_b:
  v_mov_b32 v124, v116
  v_mov_b32 v128, v117
  v_mov_b32 v125, v118
  v_mov_b32 v129, v119
  v_mov_b32 v126, v120
  v_mov_b32 v130, v121
  v_mov_b32 v127, v122
  v_mov_b32 v131, v123
  v_lshlrev_b32 v13, 4, v8
  v_add_u32 v13, 159744, v13
  ds_write_b128 v13, v[124:127]
  ds_write_b128 v13, v[128:131] offset:1024
L_wsd_b:
  s_mov_b32 s67, 1
L_chk_no_b:
L_h0_okB:
  s_cmp_eq_u32 s67, 1
  s_cbranch_scc1 L_h0_done
  s_cmp_eq_u32 s68, 0
  s_cbranch_scc1 L_h0_fb
  s_mov_b32 s36, 200
L_h0_spin:
  s_cmp_eq_u32 s36, 0
  s_cbranch_scc1 L_h0_fb
  s_lshl_b32 s37, s26, 12
  s_add_u32 s37, s37, 8978432
  v_lshlrev_b32 v11, 6, v8
  buffer_load_dwordx4 v[100:103], v11, s[20:23], s37 offen offset:0 sc1
  buffer_load_dwordx4 v[104:107], v11, s[20:23], s37 offen offset:16 sc1
  buffer_load_dwordx4 v[108:111], v11, s[20:23], s37 offen offset:32 sc1
  buffer_load_dwordx4 v[112:115], v11, s[20:23], s37 offen offset:48 sc1
  s_waitcnt vmcnt(0)
  v_cmp_eq_u32 vcc, s68, v101
  s_mov_b64 s[92:93], vcc
  v_cmp_eq_u32 vcc, s68, v103
  s_and_b64 s[92:93], s[92:93], vcc
  v_cmp_eq_u32 vcc, s68, v105
  s_and_b64 s[92:93], s[92:93], vcc
  v_cmp_eq_u32 vcc, s68, v107
  s_and_b64 s[92:93], s[92:93], vcc
  v_cmp_eq_u32 vcc, s68, v109
  s_and_b64 s[92:93], s[92:93], vcc
  v_cmp_eq_u32 vcc, s68, v111
  s_and_b64 s[92:93], s[92:93], vcc
  v_cmp_eq_u32 vcc, s68, v113
  s_and_b64 s[92:93], s[92:93], vcc
  v_cmp_eq_u32 vcc, s68, v115
  s_and_b64 s[92:93], s[92:93], vcc
  s_cmp_eq_u64 s[92:93], -1
  s_cbranch_scc0 L_chk_no_c
  v_mov_b32 v116, v100
  v_mov_b32 v117, v102
  v_mov_b32 v118, v104
  v_mov_b32 v119, v106
  v_mov_b32 v120, v108
  v_mov_b32 v121, v110
  v_mov_b32 v122, v112
  v_mov_b32 v123, v114
  s_cmp_eq_u32 s29, 1
  s_cbranch_scc1 L_wsk_c
  v_lshlrev_b32 v13, 5, v8
  v_add_u32 v13, 159744, v13
  ds_write_b128 v13, v[116:119]
  ds_write_b128 v13, v[120:123] offset:16
  s_branch L_wsd_c
L_wsk_c:
  v_mov_b32 v124, v116
  v_mov_b32 v128, v117
  v_mov_b32 v125, v118
  v_mov_b32 v129, v119
  v_mov_b32 v126, v120
  v_mov_b32 v130, v121
  v_mov_b32 v127, v122
  v_mov_b32 v131, v123
  v_lshlrev_b32 v13, 4, v8
  v_add_u32 v13, 159744, v13
  ds_write_b128 v13, v[124:127]
  ds_write_b128 v13, v[128:131] offset:1024
L_wsd_c:
  s_mov_b32 s67, 1
L_chk_no_c:
  s_sub_u32 s36, s36, 1
  s_cmp_eq_u32 s67, 1
  s_cbranch_scc1 L_h0_done
  s_sleep 4
  s_branch L_h0_spin
L_h0_fb:
  s_mov_b32 s36, 0
L_fb_loop:
  s_lshl_b32 s37, s26, 8
  s_lshl_b32 s38, s36, 2
  s_add_u32 s37, s37, s38
  v_add_u32 v11, s37, v10
  v_mul_u32_u24 v11, 1280, v11
  v_lshlrev_b32 v14, 4, v9
  v_add_u32 v11, v11, v14
  buffer_load_dwordx4 v[100:103], v11, s[8:11], 0 offen offset:0
  buffer_load_dwordx4 v[104:107], v11, s[8:11], 0 offen offset:256
  buffer_load_dwordx4 v[108:111], v11, s[8:11], 0 offen offset:512
  buffer_load_dwordx4 v[112:115], v11, s[8:11], 0 offen offset:768
  buffer_load_dwordx4 v[116:119], v11, s[8:11], 0 offen offset:1024
  s_waitcnt vmcnt(0)
  v_mov_b32 v120, 0
  v_mov_b32 v121, 0
  v_mov_b32 v122, 0
  v_mov_b32 v123, 0
  v_dot2c_f32_bf16 v120, v100, v26
  v_dot2c_f32_bf16 v122, v100, v100
  v_dot2c_f32_bf16 v121, v101, v26
  v_dot2c_f32_bf16 v123, v101, v101
  v_dot2c_f32_bf16 v120, v102, v26
  v_dot2c_f32_bf16 v122, v102, v102
  v_dot2c_f32_bf16 v121, v103, v26
  v_dot2c_f32_bf16 v123, v103, v103
  v_dot2c_f32_bf16 v120, v104, v26
  v_dot2c_f32_bf16 v122, v104, v104
  v_dot2c_f32_bf16 v121, v105, v26
  v_dot2c_f32_bf16 v123, v105, v105
  v_dot2c_f32_bf16 v120, v106, v26
  v_dot2c_f32_bf16 v122, v106, v106
  v_dot2c_f32_bf16 v121, v107, v26
  v_dot2c_f32_bf16 v123, v107, v107
  v_dot2c_f32_bf16 v120, v108, v26
  v_dot2c_f32_bf16 v122, v108, v108
  v_dot2c_f32_bf16 v121, v109, v26
  v_dot2c_f32_bf16 v123, v109, v109
  v_dot2c_f32_bf16 v120, v110, v26
  v_dot2c_f32_bf16 v122, v110, v110
  v_dot2c_f32_bf16 v121, v111, v26
  v_dot2c_f32_bf16 v123, v111, v111
  v_dot2c_f32_bf16 v120, v112, v26
  v_dot2c_f32_bf16 v122, v112, v112
  v_dot2c_f32_bf16 v121, v113, v26
  v_dot2c_f32_bf16 v123, v113, v113
  v_dot2c_f32_bf16 v120, v114, v26
  v_dot2c_f32_bf16 v122, v114, v114
  v_dot2c_f32_bf16 v121, v115, v26
  v_dot2c_f32_bf16 v123, v115, v115
  v_dot2c_f32_bf16 v120, v116, v26
  v_dot2c_f32_bf16 v122, v116, v116
  v_dot2c_f32_bf16 v121, v117, v26
  v_dot2c_f32_bf16 v123, v117, v117
  v_dot2c_f32_bf16 v120, v118, v26
  v_dot2c_f32_bf16 v122, v118, v118
  v_dot2c_f32_bf16 v121, v119, v26
  v_dot2c_f32_bf16 v123, v119, v119
  s_nop 2
  v_add_f32 v120, v120, v121
  v_add_f32 v122, v122, v123
  s_nop 0
  v_add_f32_dpp v120, v120, v120 quad_perm:[1,0,3,2] row_mask:0xf bank_mask:0xf
  v_add_f32_dpp v122, v122, v122 quad_perm:[1,0,3,2] row_mask:0xf bank_mask:0xf
  s_nop 0
  s_nop 0
  v_add_f32_dpp v120, v120, v120 quad_perm:[2,3,0,1] row_mask:0xf bank_mask:0xf
  v_add_f32_dpp v122, v122, v122 quad_perm:[2,3,0,1] row_mask:0xf bank_mask:0xf
  s_nop 0
  s_nop 0
  v_add_f32_dpp v120, v120, v120 row_half_mirror row_mask:0xf bank_mask:0xf
  v_add_f32_dpp v122, v122, v122 row_half_mirror row_mask:0xf bank_mask:0xf
  s_nop 0
  s_nop 0
  v_add_f32_dpp v120, v120, v120 row_mirror row_mask:0xf bank_mask:0xf
  v_add_f32_dpp v122, v122, v122 row_mirror row_mask:0xf bank_mask:0xf
  s_nop 0
  v_mul_f32 v126, 0x3acccccd, v120
  v_mul_f32 v121, v126, v126
  v_mul_f32 v122, 0x3acccccd, v122
  v_sub_f32 v122, v122, v121
  v_max_f32 v122, 0, v122
  v_add_f32 v122, 0x3727c5ac, v122
  v_rsq_f32 v127, v122
  s_nop 0
  v_add_u32 v15, s38, v10
  v_cmp_eq_u32 vcc, 0, v9
  s_and_saveexec_b64 s[64:65], vcc
  s_cmp_eq_u32 s29, 1
  s_cbranch_scc1 L_fb_kv
  v_lshlrev_b32 v13, 3, v15
  v_add_u32 v13, 159744, v13
  ds_write_b64 v13, v[126:127]
  s_branch L_fb_n
L_fb_kv:
  v_lshlrev_b32 v13, 2, v15
  v_add_u32 v13, 159744, v13
  ds_write_b32 v13, v126
  ds_write_b32 v13, v127 offset:1024
L_fb_n:
  s_mov_b64 exec, s[64:65]
  s_add_u32 s36, s36, 1
  s_cmp_lt_u32 s36, 64
  s_cbranch_scc1 L_fb_loop
L_h0_done:
  s_waitcnt lgkmcnt(0)
  s_barrier
  s_cmp_eq_u32 s29, 1
  s_cbranch_scc1 L_kv_final
  s_endpgm
L_prod3:
  s_load_dwordx2 s[44:45], s[0:1], 48
  s_load_dwordx2 s[48:49], s[0:1], 16
  s_mov_b32 s68, 0
  s_mov_b32 s67, 0
  v_mov_b32 v11, 0
  global_load_dword v61, v11, s[24:25] offset:0 sc1
  v_add_u32 v11, 0, v8
  v_mul_u32_u24 v12, 205, v11
  v_lshrrev_b32 v12, 11, v12
  v_mul_u32_u24 v13, 10, v12
  v_sub_u32 v13, v11, v13
  v_mul_u32_u24 v12, 1280, v12
  v_lshlrev_b32 v13, 4, v13
  v_add_u32 v40, v12, v13
  v_add_u32 v11, 64, v8
  v_mul_u32_u24 v12, 205, v11
  v_lshrrev_b32 v12, 11, v12
  v_mul_u32_u24 v13, 10, v12
  v_sub_u32 v13, v11, v13
  v_mul_u32_u24 v12, 1280, v12
  v_lshlrev_b32 v13, 4, v13
  v_add_u32 v41, v12, v13
  v_add_u32 v11, 128, v8
  v_mul_u32_u24 v12, 205, v11
  v_lshrrev_b32 v12, 11, v12
  v_mul_u32_u24 v13, 10, v12
  v_sub_u32 v13, v11, v13
  v_mul_u32_u24 v12, 1280, v12
  v_lshlrev_b32 v13, 4, v13
  v_add_u32 v42, v12, v13
  v_add_u32 v11, 192, v8
  v_mul_u32_u24 v12, 205, v11
  v_lshrrev_b32 v12, 11, v12
  v_mul_u32_u24 v13, 10, v12
  v_sub_u32 v13, v11, v13
  v_mul_u32_u24 v12, 1280, v12
  v_lshlrev_b32 v13, 4, v13
  v_add_u32 v43, v12, v13
  v_add_u32 v11, 256, v8
  v_mul_u32_u24 v12, 205, v11
  v_lshrrev_b32 v12, 11, v12
  v_mul_u32_u24 v13, 10, v12
  v_sub_u32 v13, v11, v13
  v_mul_u32_u24 v12, 1280, v12
  v_lshlrev_b32 v13, 4, v13
  v_add_u32 v44, v12, v13
  v_lshlrev_b32 v11, 2, v10
  v_lshrrev_b32 v12, 2, v9
  v_add_u32 v11, v11, v12
  v_mul_u32_u24 v11, 160, v11
  v_and_b32 v12, 3, v9
  v_lshlrev_b32 v12, 3, v12
  v_add_u32 v11, v11, v12
  v_add_u32 v45, 77824, v11
  v_lshlrev_b32 v46, 4, v8
  s_waitcnt lgkmcnt(0)
  s_mov_b32 s46, 1966080
  s_mov_b32 s47, 0x20000
  s_mov_b32 s50, 819200
  s_mov_b32 s51, 0x20000
  s_cmp_eq_u32 s29, 1
  s_cbranch_scc0 L_nozero
  s_cmp_eq_u32 s26, 0
  s_cbranch_scc0 L_nozero
  v_mov_b32 v28, 0
  v_mov_b32 v29, 0
  v_mov_b32 v30, 0
  v_mov_b32 v31, 0
  s_mul_i32 s37, s30, 6720
  s_add_u32 s37, s37, 8912896
  s_add_u32 s61, s37, 4096
  v_lshlrev_b32 v11, 4, v8
  buffer_store_dwordx4 v[28:31], v11, s[20:23], s37 offen offset:0 sc1
  buffer_store_dwordx4 v[28:31], v11, s[20:23], s37 offen offset:1024 sc1
  buffer_store_dwordx4 v[28:31], v11, s[20:23], s37 offen offset:2048 sc1
  buffer_store_dwordx4 v[28:31], v11, s[20:23], s37 offen offset:3072 sc1
  buffer_store_dwordx4 v[28:31], v11, s[20:23], s61 offen offset:0 sc1
  buffer_store_dwordx4 v[28:31], v11, s[20:23], s61 offen offset:1024 sc1
  v_cmp_gt_u32 vcc, 36, v8
  s_and_saveexec_b64 s[64:65], vcc
  buffer_store_dwordx4 v[28:31], v11, s[20:23], s61 offen offset:2048 sc1
  s_mov_b64 exec, s[64:65]
L_nozero:
  s_barrier
  s_barrier
  s_waitcnt vmcnt(0)
  v_readfirstlane_b32 s37, v61
  s_nop 3
  s_cmp_eq_u32 s37, 0
  s_cbranch_scc0 L_h1_haven
  v_mov_b32 v11, 0
  global_load_dword v61, v11, s[24:25] offset:0 sc1
L_h1_haven:
  s_barrier
  s_barrier
  s_cmp_lg_u32 s68, 0
  s_cbranch_scc1 L_ctp_p3
  s_waitcnt vmcnt(0)
  v_readfirstlane_b32 s68, v61
  s_nop 3
  s_cmp_eq_u32 s68, 0
  s_cbranch_scc1 L_ctr_p3
  v_lshlrev_b32 v11, 3, v8
  v_add_u32 v11, 161792, v11
  ds_read_b64 v[28:29], v11
  ds_read_b64 v[32:33], v11 offset:512
  s_lshl_b32 s37, s27, 3
  s_add_u32 s37, s37, s26
  s_mul_i32 s37, s37, 1280
  s_add_u32 s37, s37, 11800576
  v_lshlrev_b32 v12, 4, v8
  s_waitcnt lgkmcnt(0)
  v_mov_b32 v30, v29
  v_mov_b32 v29, s68
  v_mov_b32 v31, s68
  v_mov_b32 v34, v33
  v_mov_b32 v33, s68
  v_mov_b32 v35, s68
  buffer_store_dwordx4 v[28:31], v12, s[20:23], s37 offen sc1
  v_cmp_gt_u32 vcc, 16, v8
  s_and_saveexec_b64 s[64:65], vcc
  buffer_store_dwordx4 v[32:35], v12, s[20:23], s37 offen offset:1024 sc1
  s_mov_b64 exec, s[64:65]
  s_branch L_ctp_p3
L_ctr_p3:
  v_mov_b32 v11, 0
  global_load_dword v61, v11, s[24:25] offset:0 sc1
L_ctp_p3:
  s_barrier
  s_cmp_lg_u32 s68, 0
  s_cbranch_scc1 L_ctp_p4
  s_waitcnt vmcnt(0)
  v_readfirstlane_b32 s68, v61
  s_nop 3
  s_cmp_eq_u32 s68, 0
  s_cbranch_scc1 L_ctr_p4
  v_lshlrev_b32 v11, 3, v8
  v_add_u32 v11, 161792, v11
  ds_read_b64 v[28:29], v11
  ds_read_b64 v[32:33], v11 offset:512
  s_lshl_b32 s37, s27, 3
  s_add_u32 s37, s37, s26
  s_mul_i32 s37, s37, 1280
  s_add_u32 s37, s37, 11800576
  v_lshlrev_b32 v12, 4, v8
  s_waitcnt lgkmcnt(0)
  v_mov_b32 v30, v29
  v_mov_b32 v29, s68
  v_mov_b32 v31, s68
  v_mov_b32 v34, v33
  v_mov_b32 v33, s68
  v_mov_b32 v35, s68
  buffer_store_dwordx4 v[28:31], v12, s[20:23], s37 offen sc1
  v_cmp_gt_u32 vcc, 16, v8
  s_and_saveexec_b64 s[64:65], vcc
  buffer_store_dwordx4 v[32:35], v12, s[20:23], s37 offen offset:1024 sc1
  s_mov_b64 exec, s[64:65]
  s_branch L_ctp_p4
L_ctr_p4:
L_ctp_p4:
  s_barrier
  s_mul_i32 s37, s27, 10240
  s_add_u32 s37, s37, 11800576
  v_lshlrev_b32 v12, 4, v8
  s_add_u32 s38, s37, 0
  buffer_load_dwordx4 v[64:67], v12, s[20:23], s38 offen sc1
  s_add_u32 s38, s37, 1280
  buffer_load_dwordx4 v[68:71], v12, s[20:23], s38 offen sc1
  s_add_u32 s38, s37, 2560
  buffer_load_dwordx4 v[72:75], v12, s[20:23], s38 offen sc1
  s_add_u32 s38, s37, 3840
  buffer_load_dwordx4 v[76:79], v12, s[20:23], s38 offen sc1
  s_add_u32 s38, s37, 5120
  buffer_load_dwordx4 v[80:83], v12, s[20:23], s38 offen sc1
  s_add_u32 s38, s37, 6400
  buffer_load_dwordx4 v[84:87], v12, s[20:23], s38 offen sc1
  s_add_u32 s38, s37, 7680
  buffer_load_dwordx4 v[88:91], v12, s[20:23], s38 offen sc1
  s_add_u32 s38, s37, 8960
  buffer_load_dwordx4 v[92:95], v12, s[20:23], s38 offen sc1
  v_cmp_gt_u32 vcc, 16, v8
  s_and_saveexec_b64 s[64:65], vcc
  s_add_u32 s38, s37, 0
  buffer_load_dwordx4 v[96:99], v12, s[20:23], s38 offen offset:1024 sc1
  s_add_u32 s38, s37, 1280
  buffer_load_dwordx4 v[100:103], v12, s[20:23], s38 offen offset:1024 sc1
  s_add_u32 s38, s37, 2560
  buffer_load_dwordx4 v[104:107], v12, s[20:23], s38 offen offset:1024 sc1
  s_add_u32 s38, s37, 3840
  buffer_load_dwordx4 v[108:111], v12, s[20:23], s38 offen offset:1024 sc1
  s_add_u32 s38, s37, 5120
  buffer_load_dwordx4 v[112:115], v12, s[20:23], s38 offen offset:1024 sc1
  s_add_u32 s38, s37, 6400
  buffer_load_dwordx4 v[116:119], v12, s[20:23], s38 offen offset:1024 sc1
  s_add_u32 s38, s37, 7680
  buffer_load_dwordx4 v[120:123], v12, s[20:23], s38 offen offset:1024 sc1
  s_add_u32 s38, s37, 8960
  buffer_load_dwordx4 v[124:127], v12, s[20:23], s38 offen offset:1024 sc1
  s_mov_b64 exec, s[64:65]
  s_barrier
  s_cmp_eq_u32 s29, 1
  s_cbranch_scc0 L_h1_nosig
  s_cmp_eq_u32 s26, 0
  s_cbranch_scc0 L_h1_nosig
  s_waitcnt vmcnt(0)
  s_lshl_b32 s37, s30, 2
  v_mov_b32 v11, s37
  v_mov_b32 v12, 1
  v_cmp_eq_u32 vcc, 0, v8
  s_and_saveexec_b64 s[64:65], vcc
  global_store_dword v11, v12, s[24:25] offset:64 sc1
  s_mov_b64 exec, s[64:65]
L_h1_nosig:
  s_barrier
  s_mov_b32 s66, 0
  s_waitcnt vmcnt(0)
  s_cmp_eq_u32 s68, 0
  s_cbranch_scc1 L_h1_cA
  s_mov_b32 s66, 0
  s_mov_b64 s[92:93], -1
  v_cmp_eq_u32 vcc, s68, v65
  s_and_b64 s[92:93], s[92:93], vcc
  v_cmp_eq_u32 vcc, s68, v67
  s_and_b64 s[92:93], s[92:93], vcc
  v_cmp_eq_u32 vcc, s68, v69
  s_and_b64 s[92:93], s[92:93], vcc
  v_cmp_eq_u32 vcc, s68, v71
  s_and_b64 s[92:93], s[92:93], vcc
  v_cmp_eq_u32 vcc, s68, v73
  s_and_b64 s[92:93], s[92:93], vcc
  v_cmp_eq_u32 vcc, s68, v75
  s_and_b64 s[92:93], s[92:93], vcc
  v_cmp_eq_u32 vcc, s68, v77
  s_and_b64 s[92:93], s[92:93], vcc
  v_cmp_eq_u32 vcc, s68, v79
  s_and_b64 s[92:93], s[92:93], vcc
  v_cmp_eq_u32 vcc, s68, v81
  s_and_b64 s[92:93], s[92:93], vcc
  v_cmp_eq_u32 vcc, s68, v83
  s_and_b64 s[92:93], s[92:93], vcc
  v_cmp_eq_u32 vcc, s68, v85
  s_and_b64 s[92:93], s[92:93], vcc
  v_cmp_eq_u32 vcc, s68, v87
  s_and_b64 s[92:93], s[92:93], vcc
  v_cmp_eq_u32 vcc, s68, v89
  s_and_b64 s[92:93], s[92:93], vcc
  v_cmp_eq_u32 vcc, s68, v91
  s_and_b64 s[92:93], s[92:93], vcc
  v_cmp_eq_u32 vcc, s68, v93
  s_and_b64 s[92:93], s[92:93], vcc
  v_cmp_eq_u32 vcc, s68, v95
  s_and_b64 s[92:93], s[92:93], vcc
  s_mov_b64 s[90:91], 0xffff
  v_cmp_eq_u32 vcc, s68, v97
  s_and_b64 s[90:91], s[90:91], vcc
  v_cmp_eq_u32 vcc, s68, v99
  s_and_b64 s[90:91], s[90:91], vcc
  v_cmp_eq_u32 vcc, s68, v101
  s_and_b64 s[90:91], s[90:91], vcc
  v_cmp_eq_u32 vcc, s68, v103
  s_and_b64 s[90:91], s[90:91], vcc
  v_cmp_eq_u32 vcc, s68, v105
  s_and_b64 s[90:91], s[90:91], vcc
  v_cmp_eq_u32 vcc, s68, v107
  s_and_b64 s[90:91], s[90:91], vcc
  v_cmp_eq_u32 vcc, s68, v109
  s_and_b64 s[90:91], s[90:91], vcc
  v_cmp_eq_u32 vcc, s68, v111
  s_and_b64 s[90:91], s[90:91], vcc
  v_cmp_eq_u32 vcc, s68, v113
  s_and_b64 s[90:91], s[90:91], vcc
  v_cmp_eq_u32 vcc, s68, v115
  s_and_b64 s[90:91], s[90:91], vcc
  v_cmp_eq_u32 vcc, s68, v117
  s_and_b64 s[90:91], s[90:91], vcc
  v_cmp_eq_u32 vcc, s68, v119
  s_and_b64 s[90:91], s[90:91], vcc
  v_cmp_eq_u32 vcc, s68, v121
  s_and_b64 s[90:91], s[90:91], vcc
  v_cmp_eq_u32 vcc, s68, v123
  s_and_b64 s[90:91], s[90:91], vcc
  v_cmp_eq_u32 vcc, s68, v125
  s_and_b64 s[90:91], s[90:91], vcc
  v_cmp_eq_u32 vcc, s68, v127
  s_and_b64 s[90:91], s[90:91], vcc
  s_cmp_eq_u64 s[92:93], -1
  s_cbranch_scc0 L_cct_no_a
  s_cmp_eq_u64 s[90:91], 0xffff
  s_cbranch_scc0 L_cct_no_a
  s_mov_b32 s66, 1
L_cct_no_a:
  s_cmp_eq_u32 s66, 1
  s_cbranch_scc1 L_h1_cA
  s_mul_i32 s37, s27, 10240
  s_add_u32 s37, s37, 11800576
  v_lshlrev_b32 v12, 4, v8
  s_add_u32 s38, s37, 0
  buffer_load_dwordx4 v[64:67], v12, s[20:23], s38 offen sc1
  s_add_u32 s38, s37, 1280
  buffer_load_dwordx4 v[68:71], v12, s[20:23], s38 offen sc1
  s_add_u32 s38, s37, 2560
  buffer_load_dwordx4 v[72:75], v12, s[20:23], s38 offen sc1
  s_add_u32 s38, s37, 3840
  buffer_load_dwordx4 v[76:79], v12, s[20:23], s38 offen sc1
  s_add_u32 s38, s37, 5120
  buffer_load_dwordx4 v[80:83], v12, s[20:23], s38 offen sc1
  s_add_u32 s38, s37, 6400
  buffer_load_dwordx4 v[84:87], v12, s[20:23], s38 offen sc1
  s_add_u32 s38, s37, 7680
  buffer_load_dwordx4 v[88:91], v12, s[20:23], s38 offen sc1
  s_add_u32 s38, s37, 8960
  buffer_load_dwordx4 v[92:95], v12, s[20:23], s38 offen sc1
  v_cmp_gt_u32 vcc, 16, v8
  s_and_saveexec_b64 s[64:65], vcc
  s_add_u32 s38, s37, 0
  buffer_load_dwordx4 v[96:99], v12, s[20:23], s38 offen offset:1024 sc1
  s_add_u32 s38, s37, 1280
  buffer_load_dwordx4 v[100:103], v12, s[20:23], s38 offen offset:1024 sc1
  s_add_u32 s38, s37, 2560
  buffer_load_dwordx4 v[104:107], v12, s[20:23], s38 offen offset:1024 sc1
  s_add_u32 s38, s37, 3840
  buffer_load_dwordx4 v[108:111], v12, s[20:23], s38 offen offset:1024 sc1
  s_add_u32 s38, s37, 5120
  buffer_load_dwordx4 v[112:115], v12, s[20:23], s38 offen offset:1024 sc1
  s_add_u32 s38, s37, 6400
  buffer_load_dwordx4 v[116:119], v12, s[20:23], s38 offen offset:1024 sc1
  s_add_u32 s38, s37, 7680
  buffer_load_dwordx4 v[120:123], v12, s[20:23], s38 offen offset:1024 sc1
  s_add_u32 s38, s37, 8960
  buffer_load_dwordx4 v[124:127], v12, s[20:23], s38 offen offset:1024 sc1
  s_mov_b64 exec, s[64:65]
L_h1_cA:
  s_barrier
  s_cmp_eq_u32 s66, 1
  s_cbranch_scc0 L_cck_no_a2
  v_add_f32 v64, v64, v68
  v_add_f32 v66, v66, v70
  v_add_f32 v64, v64, v72
  v_add_f32 v66, v66, v74
  v_add_f32 v64, v64, v76
  v_add_f32 v66, v66, v78
  v_add_f32 v64, v64, v80
  v_add_f32 v66, v66, v82
  v_add_f32 v64, v64, v84
  v_add_f32 v66, v66, v86
  v_add_f32 v64, v64, v88
  v_add_f32 v66, v66, v90
  v_add_f32 v64, v64, v92
  v_add_f32 v66, v66, v94
  v_mov_b32 v65, v66
  v_add_f32 v96, v96, v100
  v_add_f32 v98, v98, v102
  v_add_f32 v96, v96, v104
  v_add_f32 v98, v98, v106
  v_add_f32 v96, v96, v108
  v_add_f32 v98, v98, v110
  v_add_f32 v96, v96, v112
  v_add_f32 v98, v98, v114
  v_add_f32 v96, v96, v116
  v_add_f32 v98, v98, v118
  v_add_f32 v96, v96, v120
  v_add_f32 v98, v98, v122
  v_add_f32 v96, v96, v124
  v_add_f32 v98, v98, v126
  v_mov_b32 v97, v98
  v_lshlrev_b32 v11, 3, v8
  v_add_u32 v11, 161792, v11
  ds_write_b64 v11, v[64:65]
  v_cmp_gt_u32 vcc, 16, v8
  s_and_saveexec_b64 s[64:65], vcc
  ds_write_b64 v11, v[96:97] offset:512
  s_mov_b64 exec, s[64:65]
  s_mov_b32 s67, 1
L_cck_no_a2:
  s_add_u32 s37, s2, 0
  s_lshr_b32 s38, s37, 3
  s_and_b32 s39, s37, 7
  s_mul_i32 s39, s39, 160
  s_cmp_ge_u32 s38, 48
  s_cbranch_scc1 L_rp_wo0
  s_mul_i32 s38, s38, 40960
  s_add_u32 s38, s38, s39
  s_mov_b32 m0, 77824
  s_nop 0
  buffer_load_dwordx4 v40, s[44:47], s38 offen lds
  s_mov_b32 m0, 78848
  s_nop 0
  buffer_load_dwordx4 v41, s[44:47], s38 offen lds
  s_mov_b32 m0, 79872
  s_nop 0
  buffer_load_dwordx4 v42, s[44:47], s38 offen lds
  s_mov_b32 m0, 80896
  s_nop 0
  buffer_load_dwordx4 v43, s[44:47], s38 offen lds
  s_mov_b32 m0, 81920
  s_nop 0
  buffer_load_dwordx4 v44, s[44:47], s38 offen lds
  s_branch L_rp_n0
L_rp_wo0:
  s_sub_u32 s38, s38, 48
  s_mul_i32 s38, s38, 40960
  s_add_u32 s38, s38, s39
  s_mov_b32 m0, 77824
  s_nop 0
  buffer_load_dwordx4 v40, s[48:51], s38 offen lds
  s_mov_b32 m0, 78848
  s_nop 0
  buffer_load_dwordx4 v41, s[48:51], s38 offen lds
  s_mov_b32 m0, 79872
  s_nop 0
  buffer_load_dwordx4 v42, s[48:51], s38 offen lds
  s_mov_b32 m0, 80896
  s_nop 0
  buffer_load_dwordx4 v43, s[48:51], s38 offen lds
  s_mov_b32 m0, 81920
  s_nop 0
  buffer_load_dwordx4 v44, s[48:51], s38 offen lds
L_rp_n0:
  s_add_u32 s37, s2, 256
  s_lshr_b32 s38, s37, 3
  s_and_b32 s39, s37, 7
  s_mul_i32 s39, s39, 160
  s_cmp_ge_u32 s38, 48
  s_cbranch_scc1 L_rp_wo1
  s_mul_i32 s38, s38, 40960
  s_add_u32 s38, s38, s39
  s_mov_b32 m0, 82944
  s_nop 0
  buffer_load_dwordx4 v40, s[44:47], s38 offen lds
  s_mov_b32 m0, 83968
  s_nop 0
  buffer_load_dwordx4 v41, s[44:47], s38 offen lds
  s_mov_b32 m0, 84992
  s_nop 0
  buffer_load_dwordx4 v42, s[44:47], s38 offen lds
  s_mov_b32 m0, 86016
  s_nop 0
  buffer_load_dwordx4 v43, s[44:47], s38 offen lds
  s_mov_b32 m0, 87040
  s_nop 0
  buffer_load_dwordx4 v44, s[44:47], s38 offen lds
  s_branch L_rp_n1
L_rp_wo1:
  s_sub_u32 s38, s38, 48
  s_mul_i32 s38, s38, 40960
  s_add_u32 s38, s38, s39
  s_mov_b32 m0, 82944
  s_nop 0
  buffer_load_dwordx4 v40, s[48:51], s38 offen lds
  s_mov_b32 m0, 83968
  s_nop 0
  buffer_load_dwordx4 v41, s[48:51], s38 offen lds
  s_mov_b32 m0, 84992
  s_nop 0
  buffer_load_dwordx4 v42, s[48:51], s38 offen lds
  s_mov_b32 m0, 86016
  s_nop 0
  buffer_load_dwordx4 v43, s[48:51], s38 offen lds
  s_mov_b32 m0, 87040
  s_nop 0
  buffer_load_dwordx4 v44, s[48:51], s38 offen lds
L_rp_n1:
  s_add_u32 s37, s2, 512
  s_cmp_ge_u32 s37, 544
  s_cbranch_scc1 L_rp_i_done
  s_lshr_b32 s38, s37, 3
  s_and_b32 s39, s37, 7
  s_mul_i32 s39, s39, 160
  s_cmp_ge_u32 s38, 48
  s_cbranch_scc1 L_rp_wo2
  s_mul_i32 s38, s38, 40960
  s_add_u32 s38, s38, s39
  s_mov_b32 m0, 88064
  s_nop 0
  buffer_load_dwordx4 v40, s[44:47], s38 offen lds
  s_mov_b32 m0, 89088
  s_nop 0
  buffer_load_dwordx4 v41, s[44:47], s38 offen lds
  s_mov_b32 m0, 90112
  s_nop 0
  buffer_load_dwordx4 v42, s[44:47], s38 offen lds
  s_mov_b32 m0, 91136
  s_nop 0
  buffer_load_dwordx4 v43, s[44:47], s38 offen lds
  s_mov_b32 m0, 92160
  s_nop 0
  buffer_load_dwordx4 v44, s[44:47], s38 offen lds
  s_branch L_rp_n2
L_rp_wo2:
  s_sub_u32 s38, s38, 48
  s_mul_i32 s38, s38, 40960
  s_add_u32 s38, s38, s39
  s_mov_b32 m0, 88064
  s_nop 0
  buffer_load_dwordx4 v40, s[48:51], s38 offen lds
  s_mov_b32 m0, 89088
  s_nop 0
  buffer_load_dwordx4 v41, s[48:51], s38 offen lds
  s_mov_b32 m0, 90112
  s_nop 0
  buffer_load_dwordx4 v42, s[48:51], s38 offen lds
  s_mov_b32 m0, 91136
  s_nop 0
  buffer_load_dwordx4 v43, s[48:51], s38 offen lds
  s_mov_b32 m0, 92160
  s_nop 0
  buffer_load_dwordx4 v44, s[48:51], s38 offen lds
L_rp_n2:
L_rp_i_done:
  s_barrier
  s_cmp_eq_u32 s29, 1
  s_cbranch_scc0 L_h1_np
  s_lshl_b32 s37, s30, 2
  v_mov_b32 v11, s37
  global_load_dword v60, v11, s[24:25] offset:64 sc1
L_h1_np:
  s_barrier
  s_cmp_eq_u32 s67, 1
  s_cbranch_scc1 L_h1_cB
  s_cmp_eq_u32 s68, 0
  s_cbranch_scc1 L_h1_cB
  s_waitcnt vmcnt(0)
  s_mov_b32 s66, 0
  s_mov_b64 s[92:93], -1
  v_cmp_eq_u32 vcc, s68, v65
  s_and_b64 s[92:93], s[92:93], vcc
  v_cmp_eq_u32 vcc, s68, v67
  s_and_b64 s[92:93], s[92:93], vcc
  v_cmp_eq_u32 vcc, s68, v69
  s_and_b64 s[92:93], s[92:93], vcc
  v_cmp_eq_u32 vcc, s68, v71
  s_and_b64 s[92:93], s[92:93], vcc
  v_cmp_eq_u32 vcc, s68, v73
  s_and_b64 s[92:93], s[92:93], vcc
  v_cmp_eq_u32 vcc, s68, v75
  s_and_b64 s[92:93], s[92:93], vcc
  v_cmp_eq_u32 vcc, s68, v77
  s_and_b64 s[92:93], s[92:93], vcc
  v_cmp_eq_u32 vcc, s68, v79
  s_and_b64 s[92:93], s[92:93], vcc
  v_cmp_eq_u32 vcc, s68, v81
  s_and_b64 s[92:93], s[92:93], vcc
  v_cmp_eq_u32 vcc, s68, v83
  s_and_b64 s[92:93], s[92:93], vcc
  v_cmp_eq_u32 vcc, s68, v85
  s_and_b64 s[92:93], s[92:93], vcc
  v_cmp_eq_u32 vcc, s68, v87
  s_and_b64 s[92:93], s[92:93], vcc
  v_cmp_eq_u32 vcc, s68, v89
  s_and_b64 s[92:93], s[92:93], vcc
  v_cmp_eq_u32 vcc, s68, v91
  s_and_b64 s[92:93], s[92:93], vcc
  v_cmp_eq_u32 vcc, s68, v93
  s_and_b64 s[92:93], s[92:93], vcc
  v_cmp_eq_u32 vcc, s68, v95
  s_and_b64 s[92:93], s[92:93], vcc
  s_mov_b64 s[90:91], 0xffff
  v_cmp_eq_u32 vcc, s68, v97
  s_and_b64 s[90:91], s[90:91], vcc
  v_cmp_eq_u32 vcc, s68, v99
  s_and_b64 s[90:91], s[90:91], vcc
  v_cmp_eq_u32 vcc, s68, v101
  s_and_b64 s[90:91], s[90:91], vcc
  v_cmp_eq_u32 vcc, s68, v103
  s_and_b64 s[90:91], s[90:91], vcc
  v_cmp_eq_u32 vcc, s68, v105
  s_and_b64 s[90:91], s[90:91], vcc
  v_cmp_eq_u32 vcc, s68, v107
  s_and_b64 s[90:91], s[90:91], vcc
  v_cmp_eq_u32 vcc, s68, v109
  s_and_b64 s[90:91], s[90:91], vcc
  v_cmp_eq_u32 vcc, s68, v111
  s_and_b64 s[90:91], s[90:91], vcc
  v_cmp_eq_u32 vcc, s68, v113
  s_and_b64 s[90:91], s[90:91], vcc
  v_cmp_eq_u32 vcc, s68, v115
  s_and_b64 s[90:91], s[90:91], vcc
  v_cmp_eq_u32 vcc, s68, v117
  s_and_b64 s[90:91], s[90:91], vcc
  v_cmp_eq_u32 vcc, s68, v119
  s_and_b64 s[90:91], s[90:91], vcc
  v_cmp_eq_u32 vcc, s68, v121
  s_and_b64 s[90:91], s[90:91], vcc
  v_cmp_eq_u32 vcc, s68, v123
  s_and_b64 s[90:91], s[90:91], vcc
  v_cmp_eq_u32 vcc, s68, v125
  s_and_b64 s[90:91], s[90:91], vcc
  v_cmp_eq_u32 vcc, s68, v127
  s_and_b64 s[90:91], s[90:91], vcc
  s_cmp_eq_u64 s[92:93], -1
  s_cbranch_scc0 L_cct_no_b
  s_cmp_eq_u64 s[90:91], 0xffff
  s_cbranch_scc0 L_cct_no_b
  s_mov_b32 s66, 1
L_cct_no_b:
  s_cmp_eq_u32 s66, 1
  s_cbranch_scc0 L_cck_no_b
  v_add_f32 v64, v64, v68
  v_add_f32 v66, v66, v70
  v_add_f32 v64, v64, v72
  v_add_f32 v66, v66, v74
  v_add_f32 v64, v64, v76
  v_add_f32 v66, v66, v78
  v_add_f32 v64, v64, v80
  v_add_f32 v66, v66, v82
  v_add_f32 v64, v64, v84
  v_add_f32 v66, v66, v86
  v_add_f32 v64, v64, v88
  v_add_f32 v66, v66, v90
  v_add_f32 v64, v64, v92
  v_add_f32 v66, v66, v94
  v_mov_b32 v65, v66
  v_add_f32 v96, v96, v100
  v_add_f32 v98, v98, v102
  v_add_f32 v96, v96, v104
  v_add_f32 v98, v98, v106
  v_add_f32 v96, v96, v108
  v_add_f32 v98, v98, v110
  v_add_f32 v96, v96, v112
  v_add_f32 v98, v98, v114
  v_add_f32 v96, v96, v116
  v_add_f32 v98, v98, v118
  v_add_f32 v96, v96, v120
  v_add_f32 v98, v98, v122
  v_add_f32 v96, v96, v124
  v_add_f32 v98, v98, v126
  v_mov_b32 v97, v98
  v_lshlrev_b32 v11, 3, v8
  v_add_u32 v11, 161792, v11
  ds_write_b64 v11, v[64:65]
  v_cmp_gt_u32 vcc, 16, v8
  s_and_saveexec_b64 s[64:65], vcc
  ds_write_b64 v11, v[96:97] offset:512
  s_mov_b64 exec, s[64:65]
  s_mov_b32 s67, 1
L_cck_no_b:
L_h1_cB:
  s_cmp_eq_u32 s67, 1
  s_cbranch_scc1 L_h1_csdone
  s_cmp_eq_u32 s68, 0
  s_cbranch_scc1 L_h1_csfb
  s_mov_b32 s36, 200
L_h1_csspin:
  s_cmp_eq_u32 s36, 0
  s_cbranch_scc1 L_h1_csfb
  s_mul_i32 s37, s27, 10240
  s_add_u32 s37, s37, 11800576
  v_lshlrev_b32 v12, 4, v8
  s_add_u32 s38, s37, 0
  buffer_load_dwordx4 v[64:67], v12, s[20:23], s38 offen sc1
  s_add_u32 s38, s37, 1280
  buffer_load_dwordx4 v[68:71], v12, s[20:23], s38 offen sc1
  s_add_u32 s38, s37, 2560
  buffer_load_dwordx4 v[72:75], v12, s[20:23], s38 offen sc1
  s_add_u32 s38, s37, 3840
  buffer_load_dwordx4 v[76:79], v12, s[20:23], s38 offen sc1
  s_add_u32 s38, s37, 5120
  buffer_load_dwordx4 v[80:83], v12, s[20:23], s38 offen sc1
  s_add_u32 s38, s37, 6400
  buffer_load_dwordx4 v[84:87], v12, s[20:23], s38 offen sc1
  s_add_u32 s38, s37, 7680
  buffer_load_dwordx4 v[88:91], v12, s[20:23], s38 offen sc1
  s_add_u32 s38, s37, 8960
  buffer_load_dwordx4 v[92:95], v12, s[20:23], s38 offen sc1
  v_cmp_gt_u32 vcc, 16, v8
  s_and_saveexec_b64 s[64:65], vcc
  s_add_u32 s38, s37, 0
  buffer_load_dwordx4 v[96:99], v12, s[20:23], s38 offen offset:1024 sc1
  s_add_u32 s38, s37, 1280
  buffer_load_dwordx4 v[100:103], v12, s[20:23], s38 offen offset:1024 sc1
  s_add_u32 s38, s37, 2560
  buffer_load_dwordx4 v[104:107], v12, s[20:23], s38 offen offset:1024 sc1
  s_add_u32 s38, s37, 3840
  buffer_load_dwordx4 v[108:111], v12, s[20:23], s38 offen offset:1024 sc1
  s_add_u32 s38, s37, 5120
  buffer_load_dwordx4 v[112:115], v12, s[20:23], s38 offen offset:1024 sc1
  s_add_u32 s38, s37, 6400
  buffer_load_dwordx4 v[116:119], v12, s[20:23], s38 offen offset:1024 sc1
  s_add_u32 s38, s37, 7680
  buffer_load_dwordx4 v[120:123], v12, s[20:23], s38 offen offset:1024 sc1
  s_add_u32 s38, s37, 8960
  buffer_load_dwordx4 v[124:127], v12, s[20:23], s38 offen offset:1024 sc1
  s_mov_b64 exec, s[64:65]
  s_waitcnt vmcnt(0)
  s_mov_b32 s66, 0
  s_mov_b64 s[92:93], -1
  v_cmp_eq_u32 vcc, s68, v65
  s_and_b64 s[92:93], s[92:93], vcc
  v_cmp_eq_u32 vcc, s68, v67
  s_and_b64 s[92:93], s[92:93], vcc
  v_cmp_eq_u32 vcc, s68, v69
  s_and_b64 s[92:93], s[92:93], vcc
  v_cmp_eq_u32 vcc, s68, v71
  s_and_b64 s[92:93], s[92:93], vcc
  v_cmp_eq_u32 vcc, s68, v73
  s_and_b64 s[92:93], s[92:93], vcc
  v_cmp_eq_u32 vcc, s68, v75
  s_and_b64 s[92:93], s[92:93], vcc
  v_cmp_eq_u32 vcc, s68, v77
  s_and_b64 s[92:93], s[92:93], vcc
  v_cmp_eq_u32 vcc, s68, v79
  s_and_b64 s[92:93], s[92:93], vcc
  v_cmp_eq_u32 vcc, s68, v81
  s_and_b64 s[92:93], s[92:93], vcc
  v_cmp_eq_u32 vcc, s68, v83
  s_and_b64 s[92:93], s[92:93], vcc
  v_cmp_eq_u32 vcc, s68, v85
  s_and_b64 s[92:93], s[92:93], vcc
  v_cmp_eq_u32 vcc, s68, v87
  s_and_b64 s[92:93], s[92:93], vcc
  v_cmp_eq_u32 vcc, s68, v89
  s_and_b64 s[92:93], s[92:93], vcc
  v_cmp_eq_u32 vcc, s68, v91
  s_and_b64 s[92:93], s[92:93], vcc
  v_cmp_eq_u32 vcc, s68, v93
  s_and_b64 s[92:93], s[92:93], vcc
  v_cmp_eq_u32 vcc, s68, v95
  s_and_b64 s[92:93], s[92:93], vcc
  s_mov_b64 s[90:91], 0xffff
  v_cmp_eq_u32 vcc, s68, v97
  s_and_b64 s[90:91], s[90:91], vcc
  v_cmp_eq_u32 vcc, s68, v99
  s_and_b64 s[90:91], s[90:91], vcc
  v_cmp_eq_u32 vcc, s68, v101
  s_and_b64 s[90:91], s[90:91], vcc
  v_cmp_eq_u32 vcc, s68, v103
  s_and_b64 s[90:91], s[90:91], vcc
  v_cmp_eq_u32 vcc, s68, v105
  s_and_b64 s[90:91], s[90:91], vcc
  v_cmp_eq_u32 vcc, s68, v107
  s_and_b64 s[90:91], s[90:91], vcc
  v_cmp_eq_u32 vcc, s68, v109
  s_and_b64 s[90:91], s[90:91], vcc
  v_cmp_eq_u32 vcc, s68, v111
  s_and_b64 s[90:91], s[90:91], vcc
  v_cmp_eq_u32 vcc, s68, v113
  s_and_b64 s[90:91], s[90:91], vcc
  v_cmp_eq_u32 vcc, s68, v115
  s_and_b64 s[90:91], s[90:91], vcc
  v_cmp_eq_u32 vcc, s68, v117
  s_and_b64 s[90:91], s[90:91], vcc
  v_cmp_eq_u32 vcc, s68, v119
  s_and_b64 s[90:91], s[90:91], vcc
  v_cmp_eq_u32 vcc, s68, v121
  s_and_b64 s[90:91], s[90:91], vcc
  v_cmp_eq_u32 vcc, s68, v123
  s_and_b64 s[90:91], s[90:91], vcc
  v_cmp_eq_u32 vcc, s68, v125
  s_and_b64 s[90:91], s[90:91], vcc
  v_cmp_eq_u32 vcc, s68, v127
  s_and_b64 s[90:91], s[90:91], vcc
  s_cmp_eq_u64 s[92:93], -1
  s_cbranch_scc0 L_cct_no_c
  s_cmp_eq_u64 s[90:91], 0xffff
  s_cbranch_scc0 L_cct_no_c
  s_mov_b32 s66, 1
L_cct_no_c:
  s_cmp_eq_u32 s66, 1
  s_cbranch_scc0 L_cck_no_c
  v_add_f32 v64, v64, v68
  v_add_f32 v66, v66, v70
  v_add_f32 v64, v64, v72
  v_add_f32 v66, v66, v74
  v_add_f32 v64, v64, v76
  v_add_f32 v66, v66, v78
  v_add_f32 v64, v64, v80
  v_add_f32 v66, v66, v82
  v_add_f32 v64, v64, v84
  v_add_f32 v66, v66, v86
  v_add_f32 v64, v64, v88
  v_add_f32 v66, v66, v90
  v_add_f32 v64, v64, v92
  v_add_f32 v66, v66, v94
  v_mov_b32 v65, v66
  v_add_f32 v96, v96, v100
  v_add_f32 v98, v98, v102
  v_add_f32 v96, v96, v104
  v_add_f32 v98, v98, v106
  v_add_f32 v96, v96, v108
  v_add_f32 v98, v98, v110
  v_add_f32 v96, v96, v112
  v_add_f32 v98, v98, v114
  v_add_f32 v96, v96, v116
  v_add_f32 v98, v98, v118
  v_add_f32 v96, v96, v120
  v_add_f32 v98, v98, v122
  v_add_f32 v96, v96, v124
  v_add_f32 v98, v98, v126
  v_mov_b32 v97, v98
  v_lshlrev_b32 v11, 3, v8
  v_add_u32 v11, 161792, v11
  ds_write_b64 v11, v[64:65]
  v_cmp_gt_u32 vcc, 16, v8
  s_and_saveexec_b64 s[64:65], vcc
  ds_write_b64 v11, v[96:97] offset:512
  s_mov_b64 exec, s[64:65]
  s_mov_b32 s67, 1
L_cck_no_c:
  s_sub_u32 s36, s36, 1
  s_cmp_eq_u32 s67, 1
  s_cbranch_scc1 L_h1_csdone
  s_sleep 4
  s_branch L_h1_csspin
L_h1_csfb:
  v_add_u32 v13, s34, v8
  v_cmp_le_u32 vcc, 10, v13
  v_subrev_u32 v14, 10, v13
  s_nop 0
  v_cndmask_b32 v13, v13, v14, vcc
  v_lshlrev_b32 v13, 4, v13
  v_cmp_gt_u32 vcc, 10, v8
  s_and_saveexec_b64 s[64:65], vcc
  v_mov_b32 v16, 0
  v_mov_b32 v17, 0
  v_mov_b32 v18, 0
  v_mov_b32 v19, 0
  v_mov_b32 v20, 0
  v_mov_b32 v21, 0
  v_mov_b32 v22, 0
  v_mov_b32 v23, 0
  s_mov_b32 s37, s32
  s_mov_b32 s36, 80
L_csfb_0:
  buffer_load_dwordx4 v[64:67], v13, s[12:15], s37 offen
  s_add_u32 s37, s37, s31
  buffer_load_dwordx4 v[68:71], v13, s[12:15], s37 offen
  s_add_u32 s37, s37, s31
  buffer_load_dwordx4 v[72:75], v13, s[12:15], s37 offen
  s_add_u32 s37, s37, s31
  buffer_load_dwordx4 v[76:79], v13, s[12:15], s37 offen
  s_add_u32 s37, s37, s31
  buffer_load_dwordx4 v[80:83], v13, s[12:15], s37 offen
  s_add_u32 s37, s37, s31
  buffer_load_dwordx4 v[84:87], v13, s[12:15], s37 offen
  s_add_u32 s37, s37, s31
  buffer_load_dwordx4 v[88:91], v13, s[12:15], s37 offen
  s_add_u32 s37, s37, s31
  buffer_load_dwordx4 v[92:95], v13, s[12:15], s37 offen
  s_add_u32 s37, s37, s31
  s_waitcnt vmcnt(0)
  v_lshlrev_b32 v24, 16, v64
  v_and_b32 v25, 0xffff0000, v64
  v_add_f32 v16, v16, v24
  v_add_f32 v17, v17, v25
  v_lshlrev_b32 v24, 16, v65
  v_and_b32 v25, 0xffff0000, v65
  v_add_f32 v18, v18, v24
  v_add_f32 v19, v19, v25
  v_lshlrev_b32 v24, 16, v66
  v_and_b32 v25, 0xffff0000, v66
  v_add_f32 v20, v20, v24
  v_add_f32 v21, v21, v25
  v_lshlrev_b32 v24, 16, v67
  v_and_b32 v25, 0xffff0000, v67
  v_add_f32 v22, v22, v24
  v_add_f32 v23, v23, v25
  v_lshlrev_b32 v24, 16, v68
  v_and_b32 v25, 0xffff0000, v68
  v_add_f32 v16, v16, v24
  v_add_f32 v17, v17, v25
  v_lshlrev_b32 v24, 16, v69
  v_and_b32 v25, 0xffff0000, v69
  v_add_f32 v18, v18, v24
  v_add_f32 v19, v19, v25
  v_lshlrev_b32 v24, 16, v70
  v_and_b32 v25, 0xffff0000, v70
  v_add_f32 v20, v20, v24
  v_add_f32 v21, v21, v25
  v_lshlrev_b32 v24, 16, v71
  v_and_b32 v25, 0xffff0000, v71
  v_add_f32 v22, v22, v24
  v_add_f32 v23, v23, v25
  v_lshlrev_b32 v24, 16, v72
  v_and_b32 v25, 0xffff0000, v72
  v_add_f32 v16, v16, v24
  v_add_f32 v17, v17, v25
  v_lshlrev_b32 v24, 16, v73
  v_and_b32 v25, 0xffff0000, v73
  v_add_f32 v18, v18, v24
  v_add_f32 v19, v19, v25
  v_lshlrev_b32 v24, 16, v74
  v_and_b32 v25, 0xffff0000, v74
  v_add_f32 v20, v20, v24
  v_add_f32 v21, v21, v25
  v_lshlrev_b32 v24, 16, v75
  v_and_b32 v25, 0xffff0000, v75
  v_add_f32 v22, v22, v24
  v_add_f32 v23, v23, v25
  v_lshlrev_b32 v24, 16, v76
  v_and_b32 v25, 0xffff0000, v76
  v_add_f32 v16, v16, v24
  v_add_f32 v17, v17, v25
  v_lshlrev_b32 v24, 16, v77
  v_and_b32 v25, 0xffff0000, v77
  v_add_f32 v18, v18, v24
  v_add_f32 v19, v19, v25
  v_lshlrev_b32 v24, 16, v78
  v_and_b32 v25, 0xffff0000, v78
  v_add_f32 v20, v20, v24
  v_add_f32 v21, v21, v25
  v_lshlrev_b32 v24, 16, v79
  v_and_b32 v25, 0xffff0000, v79
  v_add_f32 v22, v22, v24
  v_add_f32 v23, v23, v25
  v_lshlrev_b32 v24, 16, v80
  v_and_b32 v25, 0xffff0000, v80
  v_add_f32 v16, v16, v24
  v_add_f32 v17, v17, v25
  v_lshlrev_b32 v24, 16, v81
  v_and_b32 v25, 0xffff0000, v81
  v_add_f32 v18, v18, v24
  v_add_f32 v19, v19, v25
  v_lshlrev_b32 v24, 16, v82
  v_and_b32 v25, 0xffff0000, v82
  v_add_f32 v20, v20, v24
  v_add_f32 v21, v21, v25
  v_lshlrev_b32 v24, 16, v83
  v_and_b32 v25, 0xffff0000, v83
  v_add_f32 v22, v22, v24
  v_add_f32 v23, v23, v25
  v_lshlrev_b32 v24, 16, v84
  v_and_b32 v25, 0xffff0000, v84
  v_add_f32 v16, v16, v24
  v_add_f32 v17, v17, v25
  v_lshlrev_b32 v24, 16, v85
  v_and_b32 v25, 0xffff0000, v85
  v_add_f32 v18, v18, v24
  v_add_f32 v19, v19, v25
  v_lshlrev_b32 v24, 16, v86
  v_and_b32 v25, 0xffff0000, v86
  v_add_f32 v20, v20, v24
  v_add_f32 v21, v21, v25
  v_lshlrev_b32 v24, 16, v87
  v_and_b32 v25, 0xffff0000, v87
  v_add_f32 v22, v22, v24
  v_add_f32 v23, v23, v25
  v_lshlrev_b32 v24, 16, v88
  v_and_b32 v25, 0xffff0000, v88
  v_add_f32 v16, v16, v24
  v_add_f32 v17, v17, v25
  v_lshlrev_b32 v24, 16, v89
  v_and_b32 v25, 0xffff0000, v89
  v_add_f32 v18, v18, v24
  v_add_f32 v19, v19, v25
  v_lshlrev_b32 v24, 16, v90
  v_and_b32 v25, 0xffff0000, v90
  v_add_f32 v20, v20, v24
  v_add_f32 v21, v21, v25
  v_lshlrev_b32 v24, 16, v91
  v_and_b32 v25, 0xffff0000, v91
  v_add_f32 v22, v22, v24
  v_add_f32 v23, v23, v25
  v_lshlrev_b32 v24, 16, v92
  v_and_b32 v25, 0xffff0000, v92
  v_add_f32 v16, v16, v24
  v_add_f32 v17, v17, v25
  v_lshlrev_b32 v24, 16, v93
  v_and_b32 v25, 0xffff0000, v93
  v_add_f32 v18, v18, v24
  v_add_f32 v19, v19, v25
  v_lshlrev_b32 v24, 16, v94
  v_and_b32 v25, 0xffff0000, v94
  v_add_f32 v20, v20, v24
  v_add_f32 v21, v21, v25
  v_lshlrev_b32 v24, 16, v95
  v_and_b32 v25, 0xffff0000, v95
  v_add_f32 v22, v22, v24
  v_add_f32 v23, v23, v25
  s_sub_u32 s36, s36, 1
  s_cmp_lg_u32 s36, 0
  s_cbranch_scc1 L_csfb_0
  v_lshlrev_b32 v11, 5, v8
  v_add_u32 v11, 161792, v11
  ds_write_b128 v11, v[16:19]
  ds_write_b128 v11, v[20:23] offset:16
  v_mov_b32 v16, 0
  v_mov_b32 v17, 0
  v_mov_b32 v18, 0
  v_mov_b32 v19, 0
  v_mov_b32 v20, 0
  v_mov_b32 v21, 0
  v_mov_b32 v22, 0
  v_mov_b32 v23, 0
  s_mov_b32 s37, s33
  s_mov_b32 s36, 80
L_csfb_1:
  buffer_load_dwordx4 v[64:67], v13, s[16:19], s37 offen
  s_add_u32 s37, s37, s31
  buffer_load_dwordx4 v[68:71], v13, s[16:19], s37 offen
  s_add_u32 s37, s37, s31
  buffer_load_dwordx4 v[72:75], v13, s[16:19], s37 offen
  s_add_u32 s37, s37, s31
  buffer_load_dwordx4 v[76:79], v13, s[16:19], s37 offen
  s_add_u32 s37, s37, s31
  buffer_load_dwordx4 v[80:83], v13, s[16:19], s37 offen
  s_add_u32 s37, s37, s31
  buffer_load_dwordx4 v[84:87], v13, s[16:19], s37 offen
  s_add_u32 s37, s37, s31
  buffer_load_dwordx4 v[88:91], v13, s[16:19], s37 offen
  s_add_u32 s37, s37, s31
  buffer_load_dwordx4 v[92:95], v13, s[16:19], s37 offen
  s_add_u32 s37, s37, s31
  s_waitcnt vmcnt(0)
  v_lshlrev_b32 v24, 16, v64
  v_and_b32 v25, 0xffff0000, v64
  v_add_f32 v16, v16, v24
  v_add_f32 v17, v17, v25
  v_lshlrev_b32 v24, 16, v65
  v_and_b32 v25, 0xffff0000, v65
  v_add_f32 v18, v18, v24
  v_add_f32 v19, v19, v25
  v_lshlrev_b32 v24, 16, v66
  v_and_b32 v25, 0xffff0000, v66
  v_add_f32 v20, v20, v24
  v_add_f32 v21, v21, v25
  v_lshlrev_b32 v24, 16, v67
  v_and_b32 v25, 0xffff0000, v67
  v_add_f32 v22, v22, v24
  v_add_f32 v23, v23, v25
  v_lshlrev_b32 v24, 16, v68
  v_and_b32 v25, 0xffff0000, v68
  v_add_f32 v16, v16, v24
  v_add_f32 v17, v17, v25
  v_lshlrev_b32 v24, 16, v69
  v_and_b32 v25, 0xffff0000, v69
  v_add_f32 v18, v18, v24
  v_add_f32 v19, v19, v25
  v_lshlrev_b32 v24, 16, v70
  v_and_b32 v25, 0xffff0000, v70
  v_add_f32 v20, v20, v24
  v_add_f32 v21, v21, v25
  v_lshlrev_b32 v24, 16, v71
  v_and_b32 v25, 0xffff0000, v71
  v_add_f32 v22, v22, v24
  v_add_f32 v23, v23, v25
  v_lshlrev_b32 v24, 16, v72
  v_and_b32 v25, 0xffff0000, v72
  v_add_f32 v16, v16, v24
  v_add_f32 v17, v17, v25
  v_lshlrev_b32 v24, 16, v73
  v_and_b32 v25, 0xffff0000, v73
  v_add_f32 v18, v18, v24
  v_add_f32 v19, v19, v25
  v_lshlrev_b32 v24, 16, v74
  v_and_b32 v25, 0xffff0000, v74
  v_add_f32 v20, v20, v24
  v_add_f32 v21, v21, v25
  v_lshlrev_b32 v24, 16, v75
  v_and_b32 v25, 0xffff0000, v75
  v_add_f32 v22, v22, v24
  v_add_f32 v23, v23, v25
  v_lshlrev_b32 v24, 16, v76
  v_and_b32 v25, 0xffff0000, v76
  v_add_f32 v16, v16, v24
  v_add_f32 v17, v17, v25
  v_lshlrev_b32 v24, 16, v77
  v_and_b32 v25, 0xffff0000, v77
  v_add_f32 v18, v18, v24
  v_add_f32 v19, v19, v25
  v_lshlrev_b32 v24, 16, v78
  v_and_b32 v25, 0xffff0000, v78
  v_add_f32 v20, v20, v24
  v_add_f32 v21, v21, v25
  v_lshlrev_b32 v24, 16, v79
  v_and_b32 v25, 0xffff0000, v79
  v_add_f32 v22, v22, v24
  v_add_f32 v23, v23, v25
  v_lshlrev_b32 v24, 16, v80
  v_and_b32 v25, 0xffff0000, v80
  v_add_f32 v16, v16, v24
  v_add_f32 v17, v17, v25
  v_lshlrev_b32 v24, 16, v81
  v_and_b32 v25, 0xffff0000, v81
  v_add_f32 v18, v18, v24
  v_add_f32 v19, v19, v25
  v_lshlrev_b32 v24, 16, v82
  v_and_b32 v25, 0xffff0000, v82
  v_add_f32 v20, v20, v24
  v_add_f32 v21, v21, v25
  v_lshlrev_b32 v24, 16, v83
  v_and_b32 v25, 0xffff0000, v83
  v_add_f32 v22, v22, v24
  v_add_f32 v23, v23, v25
  v_lshlrev_b32 v24, 16, v84
  v_and_b32 v25, 0xffff0000, v84
  v_add_f32 v16, v16, v24
  v_add_f32 v17, v17, v25
  v_lshlrev_b32 v24, 16, v85
  v_and_b32 v25, 0xffff0000, v85
  v_add_f32 v18, v18, v24
  v_add_f32 v19, v19, v25
  v_lshlrev_b32 v24, 16, v86
  v_and_b32 v25, 0xffff0000, v86
  v_add_f32 v20, v20, v24
  v_add_f32 v21, v21, v25
  v_lshlrev_b32 v24, 16, v87
  v_and_b32 v25, 0xffff0000, v87
  v_add_f32 v22, v22, v24
  v_add_f32 v23, v23, v25
  v_lshlrev_b32 v24, 16, v88
  v_and_b32 v25, 0xffff0000, v88
  v_add_f32 v16, v16, v24
  v_add_f32 v17, v17, v25
  v_lshlrev_b32 v24, 16, v89
  v_and_b32 v25, 0xffff0000, v89
  v_add_f32 v18, v18, v24
  v_add_f32 v19, v19, v25
  v_lshlrev_b32 v24, 16, v90
  v_and_b32 v25, 0xffff0000, v90
  v_add_f32 v20, v20, v24
  v_add_f32 v21, v21, v25
  v_lshlrev_b32 v24, 16, v91
  v_and_b32 v25, 0xffff0000, v91
  v_add_f32 v22, v22, v24
  v_add_f32 v23, v23, v25
  v_lshlrev_b32 v24, 16, v92
  v_and_b32 v25, 0xffff0000, v92
  v_add_f32 v16, v16, v24
  v_add_f32 v17, v17, v25
  v_lshlrev_b32 v24, 16, v93
  v_and_b32 v25, 0xffff0000, v93
  v_add_f32 v18, v18, v24
  v_add_f32 v19, v19, v25
  v_lshlrev_b32 v24, 16, v94
  v_and_b32 v25, 0xffff0000, v94
  v_add_f32 v20, v20, v24
  v_add_f32 v21, v21, v25
  v_lshlrev_b32 v24, 16, v95
  v_and_b32 v25, 0xffff0000, v95
  v_add_f32 v22, v22, v24
  v_add_f32 v23, v23, v25
  s_sub_u32 s36, s36, 1
  s_cmp_lg_u32 s36, 0
  s_cbranch_scc1 L_csfb_1
  v_lshlrev_b32 v11, 5, v8
  v_add_u32 v11, 162112, v11
  ds_write_b128 v11, v[16:19]
  ds_write_b128 v11, v[20:23] offset:16
  s_mov_b64 exec, s[64:65]
L_h1_csdone:
  s_waitcnt lgkmcnt(0)
  s_barrier
  s_waitcnt vmcnt(0)
  s_add_u32 s37, s2, 0
  ds_read_b64_tr_b16 v[64:65], v45 offset:0
  ds_read_b64_tr_b16 v[66:67], v45 offset:2560
  ds_read_b64_tr_b16 v[68:69], v45 offset:32
  ds_read_b64_tr_b16 v[70:71], v45 offset:2592
  ds_read_b64_tr_b16 v[72:73], v45 offset:64
  ds_read_b64_tr_b16 v[74:75], v45 offset:2624
  ds_read_b64_tr_b16 v[76:77], v45 offset:96
  ds_read_b64_tr_b16 v[78:79], v45 offset:2656
  ds_read_b64_tr_b16 v[80:81], v45 offset:128
  ds_read_b64_tr_b16 v[82:83], v45 offset:2688
  s_mul_i32 s37, s37, 5120
  s_add_u32 s37, s37, 9011200
  s_add_u32 s38, s37, 4096
  s_waitcnt lgkmcnt(8)
  buffer_store_dwordx4 v[64:67], v46, s[20:23], s37 offen offset:0 sc1
  s_waitcnt lgkmcnt(6)
  buffer_store_dwordx4 v[68:71], v46, s[20:23], s37 offen offset:1024 sc1
  s_waitcnt lgkmcnt(4)
  buffer_store_dwordx4 v[72:75], v46, s[20:23], s37 offen offset:2048 sc1
  s_waitcnt lgkmcnt(2)
  buffer_store_dwordx4 v[76:79], v46, s[20:23], s37 offen offset:3072 sc1
  s_waitcnt lgkmcnt(0)
  buffer_store_dwordx4 v[80:83], v46, s[20:23], s38 offen sc1
  s_add_u32 s37, s2, 256
  ds_read_b64_tr_b16 v[84:85], v45 offset:5120
  ds_read_b64_tr_b16 v[86:87], v45 offset:7680
  ds_read_b64_tr_b16 v[88:89], v45 offset:5152
  ds_read_b64_tr_b16 v[90:91], v45 offset:7712
  ds_read_b64_tr_b16 v[92:93], v45 offset:5184
  ds_read_b64_tr_b16 v[94:95], v45 offset:7744
  ds_read_b64_tr_b16 v[96:97], v45 offset:5216
  ds_read_b64_tr_b16 v[98:99], v45 offset:7776
  ds_read_b64_tr_b16 v[100:101], v45 offset:5248
  ds_read_b64_tr_b16 v[102:103], v45 offset:7808
  s_mul_i32 s37, s37, 5120
  s_add_u32 s37, s37, 9011200
  s_add_u32 s38, s37, 4096
  s_waitcnt lgkmcnt(8)
  buffer_store_dwordx4 v[84:87], v46, s[20:23], s37 offen offset:0 sc1
  s_waitcnt lgkmcnt(6)
  buffer_store_dwordx4 v[88:91], v46, s[20:23], s37 offen offset:1024 sc1
  s_waitcnt lgkmcnt(4)
  buffer_store_dwordx4 v[92:95], v46, s[20:23], s37 offen offset:2048 sc1
  s_waitcnt lgkmcnt(2)
  buffer_store_dwordx4 v[96:99], v46, s[20:23], s37 offen offset:3072 sc1
  s_waitcnt lgkmcnt(0)
  buffer_store_dwordx4 v[100:103], v46, s[20:23], s38 offen sc1
  s_add_u32 s37, s2, 512
  s_cmp_ge_u32 s37, 544
  s_cbranch_scc1 L_rp_f_done
  ds_read_b64_tr_b16 v[104:105], v45 offset:10240
  ds_read_b64_tr_b16 v[106:107], v45 offset:12800
  ds_read_b64_tr_b16 v[108:109], v45 offset:10272
  ds_read_b64_tr_b16 v[110:111], v45 offset:12832
  ds_read_b64_tr_b16 v[112:113], v45 offset:10304
  ds_read_b64_tr_b16 v[114:115], v45 offset:12864
  ds_read_b64_tr_b16 v[116:117], v45 offset:10336
  ds_read_b64_tr_b16 v[118:119], v45 offset:12896
  ds_read_b64_tr_b16 v[120:121], v45 offset:10368
  ds_read_b64_tr_b16 v[122:123], v45 offset:12928
  s_mul_i32 s37, s37, 5120
  s_add_u32 s37, s37, 9011200
  s_add_u32 s38, s37, 4096
  s_waitcnt lgkmcnt(8)
  buffer_store_dwordx4 v[104:107], v46, s[20:23], s37 offen offset:0 sc1
  s_waitcnt lgkmcnt(6)
  buffer_store_dwordx4 v[108:111], v46, s[20:23], s37 offen offset:1024 sc1
  s_waitcnt lgkmcnt(4)
  buffer_store_dwordx4 v[112:115], v46, s[20:23], s37 offen offset:2048 sc1
  s_waitcnt lgkmcnt(2)
  buffer_store_dwordx4 v[116:119], v46, s[20:23], s37 offen offset:3072 sc1
  s_waitcnt lgkmcnt(0)
  buffer_store_dwordx4 v[120:123], v46, s[20:23], s38 offen sc1
L_rp_f_done:
  s_cmp_eq_u32 s29, 1
  s_cbranch_scc0 L_h1_end
  s_waitcnt vmcnt(0)
  s_lshl_b32 s37, s30, 2
  v_mov_b32 v11, s37
L_poll_flag:
  v_readfirstlane_b32 s37, v60
  s_nop 3
  s_cmp_eq_u32 s37, 0
  s_cbranch_scc0 L_kv_final
  s_sleep 2
  global_load_dword v60, v11, s[24:25] offset:64 sc1
  s_waitcnt vmcnt(0)
  s_branch L_poll_flag
L_h1_end:
  s_endpgm
L_consumers:
  v_and_b32 v11, 7, v9
  v_xor_b32 v11, v10, v11
  v_lshlrev_b32 v11, 4, v11
  s_lshl_b32 s37, s28, 13
  v_lshlrev_b32 v12, 7, v9
  v_add3_u32 v2, v11, v12, s37
  v_lshrrev_b32 v11, 1, v10
  v_lshlrev_b32 v11, 4, v11
  v_and_b32 v12, 1, v10
  v_lshlrev_b32 v12, 2, v12
  v_lshrrev_b32 v13, 2, v9
  v_add3_u32 v11, v11, v12, v13
  v_mul_u32_u24 v11, 160, v11
  v_and_b32 v12, 3, v9
  v_lshlrev_b32 v12, 3, v12
  v_add_u32 v11, v11, v12
  v_add_u32 v3, 32768, v11
  s_mov_b64 exec, 0
  s_cmp_eq_u32 s29, 2
  s_cbranch_scc0 L_dry_ngu
  s_cmp_eq_u32 s28, 0
  s_cbranch_scc1 L_gu_b0
  s_cmp_eq_u32 s28, 1
  s_cbranch_scc1 L_gu_b1
  s_cmp_eq_u32 s28, 2
  s_cbranch_scc1 L_gu_b2
  s_branch L_gu_b3
L_dry_ngu:
  s_cmp_eq_u32 s29, 0
  s_cbranch_scc0 L_dry_nq
  s_cmp_eq_u32 s28, 0
  s_cbranch_scc1 L_q_b0
  s_cmp_eq_u32 s28, 1
  s_cbranch_scc1 L_q_b1
  s_cmp_eq_u32 s28, 2
  s_cbranch_scc1 L_q_b2
  s_branch L_q_b3
L_dry_nq:
  s_cmp_eq_u32 s28, 0
  s_cbranch_scc1 L_kv_b0
  s_cmp_eq_u32 s28, 1
  s_cbranch_scc1 L_kv_b1
  s_cmp_eq_u32 s28, 2
  s_cbranch_scc1 L_kv_b2
  s_branch L_kv_b3
L_dry_ret:
  s_mov_b64 exec, -1
  s_nop 3
  v_mov_b32 v80, 0
  v_mov_b32 v81, 0
  v_mov_b32 v82, 0
  v_mov_b32 v83, 0
  v_mov_b32 v84, 0
  v_mov_b32 v85, 0
  v_mov_b32 v86, 0
  v_mov_b32 v87, 0
  v_mov_b32 v88, 0
  v_mov_b32 v89, 0
  v_mov_b32 v90, 0
  v_mov_b32 v91, 0
  v_mov_b32 v92, 0x3f803f80
  v_mov_b32 v93, 0x3f803f80
  v_mov_b32 v94, 0x3f803f80
  v_mov_b32 v95, 0x3f803f80
  v_mov_b32 v96, 0
  v_mov_b32 v97, 0
  v_mov_b32 v98, 0
  v_mov_b32 v99, 0
  v_mov_b32 v100, 0
  v_mov_b32 v101, 0
  v_mov_b32 v102, 0
  v_mov_b32 v103, 0
  v_mov_b32 v104, 0
  v_mov_b32 v105, 0
  v_mov_b32 v106, 0
  v_mov_b32 v107, 0
  v_mov_b32 v108, 0
  v_mov_b32 v109, 0
  v_mov_b32 v110, 0
  v_mov_b32 v111, 0
  v_mov_b32 v112, 0
  v_mov_b32 v113, 0
  v_mov_b32 v114, 0
  v_mov_b32 v115, 0
  v_mov_b32 v116, 0
  v_mov_b32 v117, 0
  v_mov_b32 v118, 0
  v_mov_b32 v119, 0
  v_mov_b32 v120, 0
  v_mov_b32 v121, 0
  v_mov_b32 v122, 0
  v_mov_b32 v123, 0
  v_mov_b32 v124, 0
  v_mov_b32 v125, 0
  v_mov_b32 v126, 0
  v_mov_b32 v127, 0
  v_mov_b32 v128, 0
  v_mov_b32 v129, 0
  v_mov_b32 v130, 0
  v_mov_b32 v131, 0
  v_mov_b32 v132, 0
  v_mov_b32 v133, 0
  v_mov_b32 v134, 0
  v_mov_b32 v135, 0
  v_mov_b32 v136, 0
  v_mov_b32 v137, 0
  v_mov_b32 v138, 0
  v_mov_b32 v139, 0
  v_mov_b32 v140, 0
  v_mov_b32 v141, 0
  v_mov_b32 v142, 0
  v_mov_b32 v143, 0
  v_mov_b32 v144, 0
  v_mov_b32 v145, 0
  v_mov_b32 v146, 0
  v_mov_b32 v147, 0
  v_mov_b32 v148, 0
  v_mov_b32 v149, 0
  v_mov_b32 v150, 0
  v_mov_b32 v151, 0
  v_mov_b32 v152, 0
  v_mov_b32 v153, 0
  v_mov_b32 v154, 0
  v_mov_b32 v155, 0
  v_mov_b32 v156, 0
  v_mov_b32 v157, 0
  v_mov_b32 v158, 0
  v_mov_b32 v159, 0
  v_mov_b32 v160, 0
  v_mov_b32 v161, 0
  v_mov_b32 v162, 0
  v_mov_b32 v163, 0
  v_mov_b32 v164, 0
  v_mov_b32 v165, 0
  v_mov_b32 v166, 0
  v_mov_b32 v167, 0
  v_mov_b32 v168, 0
  v_mov_b32 v169, 0
  v_mov_b32 v170, 0
  v_mov_b32 v171, 0
  v_mov_b32 v172, 0
  v_mov_b32 v173, 0
  v_mov_b32 v174, 0
  v_mov_b32 v175, 0
  v_mov_b32 v176, 0
  v_mov_b32 v177, 0
  v_mov_b32 v178, 0
  v_mov_b32 v179, 0
  v_mov_b32 v180, 0
  v_mov_b32 v181, 0
  v_mov_b32 v182, 0
  v_mov_b32 v183, 0
  v_mov_b32 v184, 0
  v_mov_b32 v185, 0
  v_mov_b32 v186, 0
  v_mov_b32 v187, 0
  v_mov_b32 v188, 0
  v_mov_b32 v189, 0
  v_mov_b32 v190, 0
  v_mov_b32 v191, 0
  v_mov_b32 v192, 0
  v_mov_b32 v193, 0
  v_mov_b32 v194, 0
  v_mov_b32 v195, 0
  v_mov_b32 v196, 0
  v_mov_b32 v197, 0
  v_mov_b32 v198, 0
  v_mov_b32 v199, 0
  v_mov_b32 v200, 0
  v_mov_b32 v201, 0
  v_mov_b32 v202, 0
  v_mov_b32 v203, 0
  v_mov_b32 v204, 0
  v_mov_b32 v205, 0
  v_mov_b32 v206, 0
  v_mov_b32 v207, 0
  v_mov_b32 v208, 0
  v_mov_b32 v209, 0
  v_mov_b32 v210, 0
  v_mov_b32 v211, 0
  v_mov_b32 v212, 0
  v_mov_b32 v213, 0
  v_mov_b32 v214, 0
  v_mov_b32 v215, 0
  v_mov_b32 v216, 0
  v_mov_b32 v217, 0
  v_mov_b32 v218, 0
  v_mov_b32 v219, 0
  v_mov_b32 v220, 0
  v_mov_b32 v221, 0
  v_mov_b32 v222, 0
  v_mov_b32 v223, 0
  v_mov_b32 v224, 0
  v_mov_b32 v225, 0
  v_mov_b32 v226, 0
  v_mov_b32 v227, 0
  v_mov_b32 v228, 0
  v_mov_b32 v229, 0
  v_mov_b32 v230, 0
  v_mov_b32 v231, 0
  v_mov_b32 v232, 0
  v_mov_b32 v233, 0
  v_mov_b32 v234, 0
  v_mov_b32 v235, 0
  v_mov_b32 v236, 0
  v_mov_b32 v237, 0
  v_mov_b32 v238, 0
  v_mov_b32 v239, 0
  v_mov_b32 v240, 0
  v_mov_b32 v241, 0
  v_mov_b32 v242, 0
  v_mov_b32 v243, 0
  v_mov_b32 v244, 0
  v_mov_b32 v245, 0
  v_mov_b32 v246, 0
  v_mov_b32 v247, 0
  v_mov_b32 v248, 0
  v_mov_b32 v249, 0
  v_mov_b32 v250, 0
  v_mov_b32 v251, 0
  v_mov_b32 v252, 0
  v_mov_b32 v253, 0
  v_mov_b32 v254, 0
  v_mov_b32 v255, 0
  s_mov_b32 s40, 0x358637bd
  s_mov_b32 s41, 0x358637bd
  s_mov_b32 s42, 0x3fb8aa3b
  s_mov_b32 s43, 0x3fb8aa3b
  s_waitcnt lgkmcnt(0)
  s_mov_b32 s8, s4
  s_mov_b32 s9, s5
  s_cmp_eq_u32 s29, 2
  s_cselect_b32 s12, s48, s6
  s_cselect_b32 s13, s49, s7
  s_cselect_b32 s16, s50, s6
  s_cselect_b32 s17, s51, s7
  s_mov_b32 s20, s54
  s_mov_b32 s21, s55
  s_mov_b32 s24, s52
  s_mov_b32 s25, s53
  s_setprio 2
  s_cmp_eq_u32 s29, 1
  s_cbranch_scc1 L_cons_kv
  s_cmp_eq_u32 s29, 2
  s_cbranch_scc0 L_not_light
  s_cmp_eq_u32 s30, 19
  s_cbranch_scc0 L_not_light
  s_cmp_eq_u32 s28, 0
  s_cbranch_scc0 L_lt_n0
  s_mov_b32 s35, 0
  s_barrier
  v_add_u32 v4, s35, v2
  v_add_u32 v6, s35, v3
  v_xor_b32 v5, 64, v4
  s_add_u32 s35, s35, 53248
  s_cmp_eq_u32 s35, 159744
  s_cselect_b32 s35, 0, s35
  ds_read_b128 v[32:35], v4 offset:0
  ds_read_b128 v[36:39], v4 offset:2048
  ds_read_b128 v[40:43], v4 offset:4096
  ds_read_b128 v[44:47], v4 offset:6144
  s_cmp_lt_u32 s26, 2
  s_cselect_b32 s36, 2, 1
  s_sub_u32 s62, 10, s36
.p2align 6
L_cloop_lt0:
  s_waitcnt lgkmcnt(3)
  s_waitcnt lgkmcnt(2)
  s_waitcnt lgkmcnt(1)
  s_waitcnt lgkmcnt(0)
  ds_read_b64_tr_b16 v[64:65], v6 offset:128
  ds_read_b64_tr_b16 v[66:67], v6 offset:1408
  s_waitcnt lgkmcnt(0)
  v_mfma_f32_16x16x32_bf16 v[160:163], v[64:67], v[32:35], v[160:163]
  v_mfma_f32_16x16x32_bf16 v[164:167], v[64:67], v[36:39], v[164:167]
  v_mfma_f32_16x16x32_bf16 v[168:171], v[64:67], v[40:43], v[168:171]
  ds_read_b128 v[48:51], v5 offset:0
  v_mfma_f32_16x16x32_bf16 v[172:175], v[64:67], v[44:47], v[172:175]
  v_mfma_f32_16x16x32_bf16 v[80:83], v[64:67], v[92:95], v[80:83]
  ds_read_b128 v[52:55], v5 offset:2048
  ds_read_b64_tr_b16 v[68:69], v6 offset:10368
  ds_read_b64_tr_b16 v[70:71], v6 offset:11648
  ds_read_b128 v[56:59], v5 offset:4096
  ds_read_b128 v[60:63], v5 offset:6144
  s_waitcnt lgkmcnt(2)
  v_mfma_f32_16x16x32_bf16 v[252:255], v[68:71], v[44:47], v[252:255]
  v_mfma_f32_16x16x32_bf16 v[248:251], v[68:71], v[40:43], v[248:251]
  v_mfma_f32_16x16x32_bf16 v[244:247], v[68:71], v[36:39], v[244:247]
  v_mfma_f32_16x16x32_bf16 v[240:243], v[68:71], v[32:35], v[240:243]
  s_waitcnt lgkmcnt(1)
  s_waitcnt lgkmcnt(0)
  ds_read_b64_tr_b16 v[72:73], v6 offset:5248
  ds_read_b64_tr_b16 v[74:75], v6 offset:6528
  s_waitcnt lgkmcnt(0)
  v_mfma_f32_16x16x32_bf16 v[160:163], v[72:75], v[48:51], v[160:163]
  v_mfma_f32_16x16x32_bf16 v[164:167], v[72:75], v[52:55], v[164:167]
  v_mfma_f32_16x16x32_bf16 v[168:171], v[72:75], v[56:59], v[168:171]
  v_mfma_f32_16x16x32_bf16 v[172:175], v[72:75], v[60:63], v[172:175]
  v_mfma_f32_16x16x32_bf16 v[80:83], v[72:75], v[92:95], v[80:83]
  ds_read_b64_tr_b16 v[76:77], v6 offset:15488
  ds_read_b64_tr_b16 v[78:79], v6 offset:16768
  s_waitcnt lgkmcnt(0)
  s_barrier
  v_add_u32 v4, s35, v2
  v_add_u32 v6, s35, v3
  v_xor_b32 v5, 64, v4
  s_add_u32 s35, s35, 53248
  s_cmp_eq_u32 s35, 159744
  s_cselect_b32 s35, 0, s35
  ds_read_b128 v[32:35], v4 offset:0
  ds_read_b128 v[36:39], v4 offset:2048
  v_mfma_f32_16x16x32_bf16 v[252:255], v[76:79], v[60:63], v[252:255]
  ds_read_b128 v[40:43], v4 offset:4096
  v_mfma_f32_16x16x32_bf16 v[248:251], v[76:79], v[56:59], v[248:251]
  ds_read_b128 v[44:47], v4 offset:6144
  v_mfma_f32_16x16x32_bf16 v[244:247], v[76:79], v[52:55], v[244:247]
  v_mfma_f32_16x16x32_bf16 v[240:243], v[76:79], v[48:51], v[240:243]
  s_sub_u32 s36, s36, 1
  s_cmp_lg_u32 s36, 0
  s_cbranch_scc1 L_cloop_lt0
  v_lshlrev_b32 v11, 4, v10
  v_add_u32 v11, 161792, v11
  v_cmp_eq_u32 vcc, 0, v9
  s_nop 5
  s_and_saveexec_b64 s[64:65], vcc
  ds_write_b128 v11, v[80:83] offset:256
  s_mov_b64 exec, s[64:65]
  s_nop 3
  s_mov_b32 s36, s62
  s_branch L_cloopN_lt
L_lt_n0:
  s_cmp_eq_u32 s28, 1
  s_cbranch_scc0 L_lt_n1
  s_mov_b32 s35, 0
  s_barrier
  v_add_u32 v4, s35, v2
  v_add_u32 v6, s35, v3
  v_xor_b32 v5, 64, v4
  s_add_u32 s35, s35, 53248
  s_cmp_eq_u32 s35, 159744
  s_cselect_b32 s35, 0, s35
  ds_read_b128 v[32:35], v4 offset:0
  ds_read_b128 v[36:39], v4 offset:2048
  ds_read_b128 v[40:43], v4 offset:4096
  ds_read_b128 v[44:47], v4 offset:6144
  s_cmp_lt_u32 s26, 2
  s_cselect_b32 s36, 2, 1
  s_sub_u32 s62, 10, s36
.p2align 6
L_cloop_lt1:
  s_waitcnt lgkmcnt(3)
  s_waitcnt lgkmcnt(2)
  s_waitcnt lgkmcnt(1)
  s_waitcnt lgkmcnt(0)
  ds_read_b64_tr_b16 v[64:65], v6 offset:128
  ds_read_b64_tr_b16 v[66:67], v6 offset:1408
  s_waitcnt lgkmcnt(0)
  v_mfma_f32_16x16x32_bf16 v[160:163], v[64:67], v[32:35], v[160:163]
  v_mfma_f32_16x16x32_bf16 v[164:167], v[64:67], v[36:39], v[164:167]
  v_mfma_f32_16x16x32_bf16 v[168:171], v[64:67], v[40:43], v[168:171]
  ds_read_b128 v[48:51], v5 offset:0
  v_mfma_f32_16x16x32_bf16 v[172:175], v[64:67], v[44:47], v[172:175]
  ds_read_b128 v[52:55], v5 offset:2048
  ds_read_b64_tr_b16 v[68:69], v6 offset:10368
  ds_read_b64_tr_b16 v[70:71], v6 offset:11648
  ds_read_b128 v[56:59], v5 offset:4096
  ds_read_b128 v[60:63], v5 offset:6144
  s_waitcnt lgkmcnt(2)
  v_mfma_f32_16x16x32_bf16 v[252:255], v[68:71], v[44:47], v[252:255]
  v_mfma_f32_16x16x32_bf16 v[248:251], v[68:71], v[40:43], v[248:251]
  v_mfma_f32_16x16x32_bf16 v[244:247], v[68:71], v[36:39], v[244:247]
  v_mfma_f32_16x16x32_bf16 v[240:243], v[68:71], v[32:35], v[240:243]
  v_mfma_f32_16x16x32_bf16 v[80:83], v[68:71], v[92:95], v[80:83]
  s_waitcnt lgkmcnt(1)
  s_waitcnt lgkmcnt(0)
  ds_read_b64_tr_b16 v[72:73], v6 offset:5248
  ds_read_b64_tr_b16 v[74:75], v6 offset:6528
  s_waitcnt lgkmcnt(0)
  v_mfma_f32_16x16x32_bf16 v[160:163], v[72:75], v[48:51], v[160:163]
  v_mfma_f32_16x16x32_bf16 v[164:167], v[72:75], v[52:55], v[164:167]
  v_mfma_f32_16x16x32_bf16 v[168:171], v[72:75], v[56:59], v[168:171]
  v_mfma_f32_16x16x32_bf16 v[172:175], v[72:75], v[60:63], v[172:175]
  ds_read_b64_tr_b16 v[76:77], v6 offset:15488
  ds_read_b64_tr_b16 v[78:79], v6 offset:16768
  s_waitcnt lgkmcnt(0)
  s_barrier
  v_add_u32 v4, s35, v2
  v_add_u32 v6, s35, v3
  v_xor_b32 v5, 64, v4
  s_add_u32 s35, s35, 53248
  s_cmp_eq_u32 s35, 159744
  s_cselect_b32 s35, 0, s35
  ds_read_b128 v[32:35], v4 offset:0
  ds_read_b128 v[36:39], v4 offset:2048
  v_mfma_f32_16x16x32_bf16 v[252:255], v[76:79], v[60:63], v[252:255]
  ds_read_b128 v[40:43], v4 offset:4096
  v_mfma_f32_16x16x32_bf16 v[248:251], v[76:79], v[56:59], v[248:251]
  ds_read_b128 v[44:47], v4 offset:6144
  v_mfma_f32_16x16x32_bf16 v[244:247], v[76:79], v[52:55], v[244:247]
  v_mfma_f32_16x16x32_bf16 v[240:243], v[76:79], v[48:51], v[240:243]
  v_mfma_f32_16x16x32_bf16 v[80:83], v[76:79], v[92:95], v[80:83]
  s_sub_u32 s36, s36, 1
  s_cmp_lg_u32 s36, 0
  s_cbranch_scc1 L_cloop_lt1
  v_lshlrev_b32 v11, 4, v10
  v_add_u32 v11, 161792, v11
  v_cmp_eq_u32 vcc, 0, v9
  s_nop 5
  s_and_saveexec_b64 s[64:65], vcc
  ds_write_b128 v11, v[80:83] offset:576
  s_mov_b64 exec, s[64:65]
  s_nop 3
  s_mov_b32 s36, s62
  s_branch L_cloopN_lt
L_lt_n1:
  s_cmp_eq_u32 s28, 2
  s_cbranch_scc0 L_lt_n2
  s_mov_b32 s35, 0
  s_barrier
  v_add_u32 v4, s35, v2
  v_add_u32 v6, s35, v3
  v_xor_b32 v5, 64, v4
  s_add_u32 s35, s35, 53248
  s_cmp_eq_u32 s35, 159744
  s_cselect_b32 s35, 0, s35
  ds_read_b128 v[32:35], v4 offset:0
  ds_read_b128 v[36:39], v4 offset:2048
  ds_read_b128 v[40:43], v4 offset:4096
  ds_read_b128 v[44:47], v4 offset:6144
  s_cmp_lt_u32 s26, 2
  s_cselect_b32 s36, 2, 1
  s_sub_u32 s62, 10, s36
.p2align 6
L_cloop_lt2:
  s_waitcnt lgkmcnt(3)
  s_waitcnt lgkmcnt(2)
  s_waitcnt lgkmcnt(1)
  s_waitcnt lgkmcnt(0)
  ds_read_b64_tr_b16 v[64:65], v6 offset:128
  ds_read_b64_tr_b16 v[66:67], v6 offset:1408
  s_waitcnt lgkmcnt(0)
  v_mfma_f32_16x16x32_bf16 v[160:163], v[64:67], v[32:35], v[160:163]
  v_mfma_f32_16x16x32_bf16 v[164:167], v[64:67], v[36:39], v[164:167]
  v_mfma_f32_16x16x32_bf16 v[168:171], v[64:67], v[40:43], v[168:171]
  ds_read_b128 v[48:51], v5 offset:0
  v_mfma_f32_16x16x32_bf16 v[172:175], v[64:67], v[44:47], v[172:175]
  ds_read_b128 v[52:55], v5 offset:2048
  ds_read_b64_tr_b16 v[68:69], v6 offset:10368
  ds_read_b64_tr_b16 v[70:71], v6 offset:11648
  ds_read_b128 v[56:59], v5 offset:4096
  ds_read_b128 v[60:63], v5 offset:6144
  s_waitcnt lgkmcnt(2)
  v_mfma_f32_16x16x32_bf16 v[252:255], v[68:71], v[44:47], v[252:255]
  v_mfma_f32_16x16x32_bf16 v[248:251], v[68:71], v[40:43], v[248:251]
  v_mfma_f32_16x16x32_bf16 v[244:247], v[68:71], v[36:39], v[244:247]
  v_mfma_f32_16x16x32_bf16 v[240:243], v[68:71], v[32:35], v[240:243]
  s_waitcnt lgkmcnt(1)
  s_waitcnt lgkmcnt(0)
  ds_read_b64_tr_b16 v[72:73], v6 offset:5248
  ds_read_b64_tr_b16 v[74:75], v6 offset:6528
  s_waitcnt lgkmcnt(0)
  v_mfma_f32_16x16x32_bf16 v[160:163], v[72:75], v[48:51], v[160:163]
  v_mfma_f32_16x16x32_bf16 v[164:167], v[72:75], v[52:55], v[164:167]
  v_mfma_f32_16x16x32_bf16 v[168:171], v[72:75], v[56:59], v[168:171]
  v_mfma_f32_16x16x32_bf16 v[172:175], v[72:75], v[60:63], v[172:175]
  ds_read_b64_tr_b16 v[76:77], v6 offset:15488
  ds_read_b64_tr_b16 v[78:79], v6 offset:16768
  s_waitcnt lgkmcnt(0)
  s_barrier
  v_add_u32 v4, s35, v2
  v_add_u32 v6, s35, v3
  v_xor_b32 v5, 64, v4
  s_add_u32 s35, s35, 53248
  s_cmp_eq_u32 s35, 159744
  s_cselect_b32 s35, 0, s35
  ds_read_b128 v[32:35], v4 offset:0
  ds_read_b128 v[36:39], v4 offset:2048
  v_mfma_f32_16x16x32_bf16 v[252:255], v[76:79], v[60:63], v[252:255]
  ds_read_b128 v[40:43], v4 offset:4096
  v_mfma_f32_16x16x32_bf16 v[248:251], v[76:79], v[56:59], v[248:251]
  ds_read_b128 v[44:47], v4 offset:6144
  v_mfma_f32_16x16x32_bf16 v[244:247], v[76:79], v[52:55], v[244:247]
  v_mfma_f32_16x16x32_bf16 v[240:243], v[76:79], v[48:51], v[240:243]
  s_sub_u32 s36, s36, 1
  s_cmp_lg_u32 s36, 0
  s_cbranch_scc1 L_cloop_lt2
  s_mov_b32 s36, s62
  s_branch L_cloopN_lt
L_lt_n2:
  s_mov_b32 s35, 0
  s_barrier
  v_add_u32 v4, s35, v2
  v_add_u32 v6, s35, v3
  v_xor_b32 v5, 64, v4
  s_add_u32 s35, s35, 53248
  s_cmp_eq_u32 s35, 159744
  s_cselect_b32 s35, 0, s35
  ds_read_b128 v[32:35], v4 offset:0
  ds_read_b128 v[36:39], v4 offset:2048
  ds_read_b128 v[40:43], v4 offset:4096
  ds_read_b128 v[44:47], v4 offset:6144
  s_cmp_lt_u32 s26, 2
  s_cselect_b32 s36, 2, 1
  s_sub_u32 s62, 10, s36
.p2align 6
L_cloop_lt3:
  s_waitcnt lgkmcnt(3)
  s_waitcnt lgkmcnt(2)
  s_waitcnt lgkmcnt(1)
  s_waitcnt lgkmcnt(0)
  ds_read_b64_tr_b16 v[64:65], v6 offset:128
  ds_read_b64_tr_b16 v[66:67], v6 offset:1408
  s_waitcnt lgkmcnt(0)
  v_mfma_f32_16x16x32_bf16 v[160:163], v[64:67], v[32:35], v[160:163]
  v_mfma_f32_16x16x32_bf16 v[164:167], v[64:67], v[36:39], v[164:167]
  v_mfma_f32_16x16x32_bf16 v[168:171], v[64:67], v[40:43], v[168:171]
  ds_read_b128 v[48:51], v5 offset:0
  v_mfma_f32_16x16x32_bf16 v[172:175], v[64:67], v[44:47], v[172:175]
  ds_read_b128 v[52:55], v5 offset:2048
  ds_read_b64_tr_b16 v[68:69], v6 offset:10368
  ds_read_b64_tr_b16 v[70:71], v6 offset:11648
  ds_read_b128 v[56:59], v5 offset:4096
  ds_read_b128 v[60:63], v5 offset:6144
  s_waitcnt lgkmcnt(2)
  v_mfma_f32_16x16x32_bf16 v[252:255], v[68:71], v[44:47], v[252:255]
  v_mfma_f32_16x16x32_bf16 v[248:251], v[68:71], v[40:43], v[248:251]
  v_mfma_f32_16x16x32_bf16 v[244:247], v[68:71], v[36:39], v[244:247]
  v_mfma_f32_16x16x32_bf16 v[240:243], v[68:71], v[32:35], v[240:243]
  s_waitcnt lgkmcnt(1)
  s_waitcnt lgkmcnt(0)
  ds_read_b64_tr_b16 v[72:73], v6 offset:5248
  ds_read_b64_tr_b16 v[74:75], v6 offset:6528
  s_waitcnt lgkmcnt(0)
  v_mfma_f32_16x16x32_bf16 v[160:163], v[72:75], v[48:51], v[160:163]
  v_mfma_f32_16x16x32_bf16 v[164:167], v[72:75], v[52:55], v[164:167]
  v_mfma_f32_16x16x32_bf16 v[168:171], v[72:75], v[56:59], v[168:171]
  v_mfma_f32_16x16x32_bf16 v[172:175], v[72:75], v[60:63], v[172:175]
  ds_read_b64_tr_b16 v[76:77], v6 offset:15488
  ds_read_b64_tr_b16 v[78:79], v6 offset:16768
  s_waitcnt lgkmcnt(0)
  s_barrier
  v_add_u32 v4, s35, v2
  v_add_u32 v6, s35, v3
  v_xor_b32 v5, 64, v4
  s_add_u32 s35, s35, 53248
  s_cmp_eq_u32 s35, 159744
  s_cselect_b32 s35, 0, s35
  ds_read_b128 v[32:35], v4 offset:0
  ds_read_b128 v[36:39], v4 offset:2048
  v_mfma_f32_16x16x32_bf16 v[252:255], v[76:79], v[60:63], v[252:255]
  ds_read_b128 v[40:43], v4 offset:4096
  v_mfma_f32_16x16x32_bf16 v[248:251], v[76:79], v[56:59], v[248:251]
  ds_read_b128 v[44:47], v4 offset:6144
  v_mfma_f32_16x16x32_bf16 v[244:247], v[76:79], v[52:55], v[244:247]
  v_mfma_f32_16x16x32_bf16 v[240:243], v[76:79], v[48:51], v[240:243]
  s_sub_u32 s36, s36, 1
  s_cmp_lg_u32 s36, 0
  s_cbranch_scc1 L_cloop_lt3
  s_mov_b32 s36, s62
  s_branch L_cloopN_lt
.p2align 6
L_cloopN_lt:
  s_waitcnt lgkmcnt(3)
  s_waitcnt lgkmcnt(2)
  s_waitcnt lgkmcnt(1)
  s_waitcnt lgkmcnt(0)
  ds_read_b64_tr_b16 v[64:65], v6 offset:128
  ds_read_b64_tr_b16 v[66:67], v6 offset:1408
  s_waitcnt lgkmcnt(0)
  v_mfma_f32_16x16x32_bf16 v[160:163], v[64:67], v[32:35], v[160:163]
  v_mfma_f32_16x16x32_bf16 v[164:167], v[64:67], v[36:39], v[164:167]
  v_mfma_f32_16x16x32_bf16 v[168:171], v[64:67], v[40:43], v[168:171]
  ds_read_b128 v[48:51], v5 offset:0
  v_mfma_f32_16x16x32_bf16 v[172:175], v[64:67], v[44:47], v[172:175]
  ds_read_b128 v[52:55], v5 offset:2048
  ds_read_b64_tr_b16 v[68:69], v6 offset:10368
  ds_read_b64_tr_b16 v[70:71], v6 offset:11648
  ds_read_b128 v[56:59], v5 offset:4096
  ds_read_b128 v[60:63], v5 offset:6144
  s_waitcnt lgkmcnt(2)
  v_mfma_f32_16x16x32_bf16 v[252:255], v[68:71], v[44:47], v[252:255]
  v_mfma_f32_16x16x32_bf16 v[248:251], v[68:71], v[40:43], v[248:251]
  v_mfma_f32_16x16x32_bf16 v[244:247], v[68:71], v[36:39], v[244:247]
  v_mfma_f32_16x16x32_bf16 v[240:243], v[68:71], v[32:35], v[240:243]
  s_waitcnt lgkmcnt(1)
  s_waitcnt lgkmcnt(0)
  ds_read_b64_tr_b16 v[72:73], v6 offset:5248
  ds_read_b64_tr_b16 v[74:75], v6 offset:6528
  s_waitcnt lgkmcnt(0)
  v_mfma_f32_16x16x32_bf16 v[160:163], v[72:75], v[48:51], v[160:163]
  v_mfma_f32_16x16x32_bf16 v[164:167], v[72:75], v[52:55], v[164:167]
  v_mfma_f32_16x16x32_bf16 v[168:171], v[72:75], v[56:59], v[168:171]
  v_mfma_f32_16x16x32_bf16 v[172:175], v[72:75], v[60:63], v[172:175]
  ds_read_b64_tr_b16 v[76:77], v6 offset:15488
  ds_read_b64_tr_b16 v[78:79], v6 offset:16768
  s_waitcnt lgkmcnt(0)
  s_barrier
  v_add_u32 v4, s35, v2
  v_add_u32 v6, s35, v3
  v_xor_b32 v5, 64, v4
  s_add_u32 s35, s35, 53248
  s_cmp_eq_u32 s35, 159744
  s_cselect_b32 s35, 0, s35
  ds_read_b128 v[32:35], v4 offset:0
  ds_read_b128 v[36:39], v4 offset:2048
  v_mfma_f32_16x16x32_bf16 v[252:255], v[76:79], v[60:63], v[252:255]
  ds_read_b128 v[40:43], v4 offset:4096
  v_mfma_f32_16x16x32_bf16 v[248:251], v[76:79], v[56:59], v[248:251]
  ds_read_b128 v[44:47], v4 offset:6144
  v_mfma_f32_16x16x32_bf16 v[244:247], v[76:79], v[52:55], v[244:247]
  v_mfma_f32_16x16x32_bf16 v[240:243], v[76:79], v[48:51], v[240:243]
  s_sub_u32 s36, s36, 1
  s_cmp_lg_u32 s36, 0
  s_cbranch_scc1 L_cloopN_lt
  s_waitcnt lgkmcnt(0)
  s_branch L_sw_done
L_not_light:
  s_cmp_eq_u32 s28, 0
  s_cbranch_scc0 L_sw_n0
  s_mov_b32 s35, 0
  s_barrier
  v_add_u32 v4, s35, v2
  v_add_u32 v6, s35, v3
  v_xor_b32 v5, 64, v4
  s_add_u32 s35, s35, 53248
  s_cmp_eq_u32 s35, 159744
  s_cselect_b32 s35, 0, s35
  ds_read_b128 v[32:35], v4 offset:0
  ds_read_b128 v[36:39], v4 offset:2048
  ds_read_b64_tr_b16 v[64:65], v6 offset:0
  ds_read_b64_tr_b16 v[66:67], v6 offset:1280
  ds_read_b128 v[40:43], v4 offset:4096
  ds_read_b128 v[44:47], v4 offset:6144
  ds_read_b64_tr_b16 v[68:69], v6 offset:32
  ds_read_b64_tr_b16 v[70:71], v6 offset:1312
  s_cmp_lt_u32 s26, 2
  s_cselect_b32 s36, 2, 1
  s_sub_u32 s62, 10, s36
.p2align 6
L_cloop_sw0:
  s_waitcnt lgkmcnt(4)
  v_mfma_f32_16x16x32_bf16 v[96:99], v[64:67], v[32:35], v[96:99]
  ds_read_b64_tr_b16 v[72:73], v6 offset:64
  v_mfma_f32_16x16x32_bf16 v[100:103], v[64:67], v[36:39], v[100:103]
  ds_read_b64_tr_b16 v[74:75], v6 offset:1344
  s_waitcnt lgkmcnt(5)
  v_mfma_f32_16x16x32_bf16 v[104:107], v[64:67], v[40:43], v[104:107]
  ds_read_b64_tr_b16 v[76:77], v6 offset:96
  s_waitcnt lgkmcnt(5)
  v_mfma_f32_16x16x32_bf16 v[108:111], v[64:67], v[44:47], v[108:111]
  v_mfma_f32_16x16x32_bf16 v[80:83], v[64:67], v[92:95], v[80:83]
  ds_read_b64_tr_b16 v[78:79], v6 offset:1376
  s_waitcnt lgkmcnt(4)
  v_mfma_f32_16x16x32_bf16 v[124:127], v[68:71], v[44:47], v[124:127]
  ds_read_b64_tr_b16 v[64:65], v6 offset:128
  v_mfma_f32_16x16x32_bf16 v[120:123], v[68:71], v[40:43], v[120:123]
  ds_read_b64_tr_b16 v[66:67], v6 offset:1408
  v_mfma_f32_16x16x32_bf16 v[116:119], v[68:71], v[36:39], v[116:119]
  v_mfma_f32_16x16x32_bf16 v[112:115], v[68:71], v[32:35], v[112:115]
  s_waitcnt lgkmcnt(4)
  v_mfma_f32_16x16x32_bf16 v[128:131], v[72:75], v[32:35], v[128:131]
  ds_read_b64_tr_b16 v[68:69], v6 offset:10240
  v_mfma_f32_16x16x32_bf16 v[132:135], v[72:75], v[36:39], v[132:135]
  ds_read_b64_tr_b16 v[70:71], v6 offset:11520
  v_mfma_f32_16x16x32_bf16 v[136:139], v[72:75], v[40:43], v[136:139]
  v_mfma_f32_16x16x32_bf16 v[140:143], v[72:75], v[44:47], v[140:143]
  s_waitcnt lgkmcnt(4)
  v_mfma_f32_16x16x32_bf16 v[156:159], v[76:79], v[44:47], v[156:159]
  ds_read_b64_tr_b16 v[72:73], v6 offset:10272
  v_mfma_f32_16x16x32_bf16 v[152:155], v[76:79], v[40:43], v[152:155]
  ds_read_b64_tr_b16 v[74:75], v6 offset:11552
  v_mfma_f32_16x16x32_bf16 v[148:151], v[76:79], v[36:39], v[148:151]
  v_mfma_f32_16x16x32_bf16 v[144:147], v[76:79], v[32:35], v[144:147]
  s_waitcnt lgkmcnt(4)
  v_mfma_f32_16x16x32_bf16 v[160:163], v[64:67], v[32:35], v[160:163]
  ds_read_b64_tr_b16 v[76:77], v6 offset:10304
  v_mfma_f32_16x16x32_bf16 v[164:167], v[64:67], v[36:39], v[164:167]
  ds_read_b64_tr_b16 v[78:79], v6 offset:11584
  v_mfma_f32_16x16x32_bf16 v[168:171], v[64:67], v[40:43], v[168:171]
  ds_read_b128 v[48:51], v5 offset:0
  v_mfma_f32_16x16x32_bf16 v[172:175], v[64:67], v[44:47], v[172:175]
  v_mfma_f32_16x16x32_bf16 v[84:87], v[64:67], v[92:95], v[84:87]
  s_waitcnt lgkmcnt(5)
  v_mfma_f32_16x16x32_bf16 v[188:191], v[68:71], v[44:47], v[188:191]
  ds_read_b64_tr_b16 v[64:65], v6 offset:10336
  v_mfma_f32_16x16x32_bf16 v[184:187], v[68:71], v[40:43], v[184:187]
  ds_read_b64_tr_b16 v[66:67], v6 offset:11616
  v_mfma_f32_16x16x32_bf16 v[180:183], v[68:71], v[36:39], v[180:183]
  ds_read_b128 v[52:55], v5 offset:2048
  v_mfma_f32_16x16x32_bf16 v[176:179], v[68:71], v[32:35], v[176:179]
  s_waitcnt lgkmcnt(6)
  v_mfma_f32_16x16x32_bf16 v[192:195], v[72:75], v[32:35], v[192:195]
  ds_read_b64_tr_b16 v[68:69], v6 offset:10368
  v_mfma_f32_16x16x32_bf16 v[196:199], v[72:75], v[36:39], v[196:199]
  ds_read_b64_tr_b16 v[70:71], v6 offset:11648
  v_mfma_f32_16x16x32_bf16 v[200:203], v[72:75], v[40:43], v[200:203]
  ds_read_b128 v[56:59], v5 offset:4096
  v_mfma_f32_16x16x32_bf16 v[204:207], v[72:75], v[44:47], v[204:207]
  s_waitcnt lgkmcnt(7)
  v_mfma_f32_16x16x32_bf16 v[220:223], v[76:79], v[44:47], v[220:223]
  ds_read_b64_tr_b16 v[72:73], v6 offset:5120
  v_mfma_f32_16x16x32_bf16 v[216:219], v[76:79], v[40:43], v[216:219]
  ds_read_b64_tr_b16 v[74:75], v6 offset:6400
  v_mfma_f32_16x16x32_bf16 v[212:215], v[76:79], v[36:39], v[212:215]
  ds_read_b128 v[60:63], v5 offset:6144
  v_mfma_f32_16x16x32_bf16 v[208:211], v[76:79], v[32:35], v[208:211]
  s_waitcnt lgkmcnt(7)
  v_mfma_f32_16x16x32_bf16 v[224:227], v[64:67], v[32:35], v[224:227]
  ds_read_b64_tr_b16 v[76:77], v6 offset:5152
  v_mfma_f32_16x16x32_bf16 v[228:231], v[64:67], v[36:39], v[228:231]
  ds_read_b64_tr_b16 v[78:79], v6 offset:6432
  v_mfma_f32_16x16x32_bf16 v[232:235], v[64:67], v[40:43], v[232:235]
  v_mfma_f32_16x16x32_bf16 v[236:239], v[64:67], v[44:47], v[236:239]
  v_mfma_f32_16x16x32_bf16 v[88:91], v[64:67], v[92:95], v[88:91]
  s_waitcnt lgkmcnt(6)
  v_mfma_f32_16x16x32_bf16 v[252:255], v[68:71], v[44:47], v[252:255]
  ds_read_b64_tr_b16 v[64:65], v6 offset:5184
  v_mfma_f32_16x16x32_bf16 v[248:251], v[68:71], v[40:43], v[248:251]
  ds_read_b64_tr_b16 v[66:67], v6 offset:6464
  v_mfma_f32_16x16x32_bf16 v[244:247], v[68:71], v[36:39], v[244:247]
  v_mfma_f32_16x16x32_bf16 v[240:243], v[68:71], v[32:35], v[240:243]
  s_waitcnt lgkmcnt(5)
  v_mfma_f32_16x16x32_bf16 v[96:99], v[72:75], v[48:51], v[96:99]
  ds_read_b64_tr_b16 v[68:69], v6 offset:5216
  v_mfma_f32_16x16x32_bf16 v[100:103], v[72:75], v[52:55], v[100:103]
  ds_read_b64_tr_b16 v[70:71], v6 offset:6496
  v_mfma_f32_16x16x32_bf16 v[104:107], v[72:75], v[56:59], v[104:107]
  s_waitcnt lgkmcnt(6)
  v_mfma_f32_16x16x32_bf16 v[108:111], v[72:75], v[60:63], v[108:111]
  v_mfma_f32_16x16x32_bf16 v[80:83], v[72:75], v[92:95], v[80:83]
  s_waitcnt lgkmcnt(4)
  v_mfma_f32_16x16x32_bf16 v[124:127], v[76:79], v[60:63], v[124:127]
  ds_read_b64_tr_b16 v[72:73], v6 offset:5248
  v_mfma_f32_16x16x32_bf16 v[120:123], v[76:79], v[56:59], v[120:123]
  ds_read_b64_tr_b16 v[74:75], v6 offset:6528
  v_mfma_f32_16x16x32_bf16 v[116:119], v[76:79], v[52:55], v[116:119]
  v_mfma_f32_16x16x32_bf16 v[112:115], v[76:79], v[48:51], v[112:115]
  s_waitcnt lgkmcnt(4)
  v_mfma_f32_16x16x32_bf16 v[128:131], v[64:67], v[48:51], v[128:131]
  ds_read_b64_tr_b16 v[76:77], v6 offset:15360
  v_mfma_f32_16x16x32_bf16 v[132:135], v[64:67], v[52:55], v[132:135]
  ds_read_b64_tr_b16 v[78:79], v6 offset:16640
  v_mfma_f32_16x16x32_bf16 v[136:139], v[64:67], v[56:59], v[136:139]
  v_mfma_f32_16x16x32_bf16 v[140:143], v[64:67], v[60:63], v[140:143]
  s_waitcnt lgkmcnt(4)
  v_mfma_f32_16x16x32_bf16 v[156:159], v[68:71], v[60:63], v[156:159]
  ds_read_b64_tr_b16 v[64:65], v6 offset:15392
  v_mfma_f32_16x16x32_bf16 v[152:155], v[68:71], v[56:59], v[152:155]
  ds_read_b64_tr_b16 v[66:67], v6 offset:16672
  v_mfma_f32_16x16x32_bf16 v[148:151], v[68:71], v[52:55], v[148:151]
  v_mfma_f32_16x16x32_bf16 v[144:147], v[68:71], v[48:51], v[144:147]
  s_waitcnt lgkmcnt(4)
  v_mfma_f32_16x16x32_bf16 v[160:163], v[72:75], v[48:51], v[160:163]
  ds_read_b64_tr_b16 v[68:69], v6 offset:15424
  v_mfma_f32_16x16x32_bf16 v[164:167], v[72:75], v[52:55], v[164:167]
  ds_read_b64_tr_b16 v[70:71], v6 offset:16704
  v_mfma_f32_16x16x32_bf16 v[168:171], v[72:75], v[56:59], v[168:171]
  v_mfma_f32_16x16x32_bf16 v[172:175], v[72:75], v[60:63], v[172:175]
  v_mfma_f32_16x16x32_bf16 v[84:87], v[72:75], v[92:95], v[84:87]
  s_waitcnt lgkmcnt(4)
  v_mfma_f32_16x16x32_bf16 v[188:191], v[76:79], v[60:63], v[188:191]
  ds_read_b64_tr_b16 v[72:73], v6 offset:15456
  v_mfma_f32_16x16x32_bf16 v[184:187], v[76:79], v[56:59], v[184:187]
  ds_read_b64_tr_b16 v[74:75], v6 offset:16736
  v_mfma_f32_16x16x32_bf16 v[180:183], v[76:79], v[52:55], v[180:183]
  v_mfma_f32_16x16x32_bf16 v[176:179], v[76:79], v[48:51], v[176:179]
  s_waitcnt lgkmcnt(4)
  v_mfma_f32_16x16x32_bf16 v[192:195], v[64:67], v[48:51], v[192:195]
  ds_read_b64_tr_b16 v[76:77], v6 offset:15488
  v_mfma_f32_16x16x32_bf16 v[196:199], v[64:67], v[52:55], v[196:199]
  ds_read_b64_tr_b16 v[78:79], v6 offset:16768
  v_mfma_f32_16x16x32_bf16 v[200:203], v[64:67], v[56:59], v[200:203]
  v_mfma_f32_16x16x32_bf16 v[204:207], v[64:67], v[60:63], v[204:207]
  s_waitcnt lgkmcnt(4)
  v_mfma_f32_16x16x32_bf16 v[220:223], v[68:71], v[60:63], v[220:223]
  v_mfma_f32_16x16x32_bf16 v[216:219], v[68:71], v[56:59], v[216:219]
  v_mfma_f32_16x16x32_bf16 v[212:215], v[68:71], v[52:55], v[212:215]
  v_mfma_f32_16x16x32_bf16 v[208:211], v[68:71], v[48:51], v[208:211]
  s_waitcnt lgkmcnt(0)
  s_barrier
  v_add_u32 v4, s35, v2
  v_add_u32 v6, s35, v3
  v_xor_b32 v5, 64, v4
  s_add_u32 s35, s35, 53248
  s_cmp_eq_u32 s35, 159744
  s_cselect_b32 s35, 0, s35
  v_mfma_f32_16x16x32_bf16 v[224:227], v[72:75], v[48:51], v[224:227]
  ds_read_b128 v[32:35], v4 offset:0
  v_mfma_f32_16x16x32_bf16 v[228:231], v[72:75], v[52:55], v[228:231]
  ds_read_b128 v[36:39], v4 offset:2048
  v_mfma_f32_16x16x32_bf16 v[232:235], v[72:75], v[56:59], v[232:235]
  ds_read_b64_tr_b16 v[64:65], v6 offset:0
  v_mfma_f32_16x16x32_bf16 v[236:239], v[72:75], v[60:63], v[236:239]
  v_mfma_f32_16x16x32_bf16 v[88:91], v[72:75], v[92:95], v[88:91]
  ds_read_b64_tr_b16 v[66:67], v6 offset:1280
  v_mfma_f32_16x16x32_bf16 v[252:255], v[76:79], v[60:63], v[252:255]
  ds_read_b128 v[40:43], v4 offset:4096
  v_mfma_f32_16x16x32_bf16 v[248:251], v[76:79], v[56:59], v[248:251]
  ds_read_b128 v[44:47], v4 offset:6144
  v_mfma_f32_16x16x32_bf16 v[244:247], v[76:79], v[52:55], v[244:247]
  ds_read_b64_tr_b16 v[68:69], v6 offset:32
  v_mfma_f32_16x16x32_bf16 v[240:243], v[76:79], v[48:51], v[240:243]
  ds_read_b64_tr_b16 v[70:71], v6 offset:1312
  s_sub_u32 s36, s36, 1
  s_cmp_lg_u32 s36, 0
  s_cbranch_scc1 L_cloop_sw0
  v_lshlrev_b32 v11, 4, v10
  v_add_u32 v11, 161792, v11
  v_cmp_eq_u32 vcc, 0, v9
  s_nop 5
  s_and_saveexec_b64 s[64:65], vcc
  ds_write_b128 v11, v[80:83] offset:0
  ds_write_b128 v11, v[84:87] offset:256
  ds_write_b128 v11, v[88:91] offset:512
  s_mov_b64 exec, s[64:65]
  s_nop 3
  s_mov_b32 s36, s62
  s_branch L_cloopN_sw
L_sw_n0:
  s_cmp_eq_u32 s28, 1
  s_cbranch_scc0 L_sw_n1
  s_mov_b32 s35, 0
  s_barrier
  v_add_u32 v4, s35, v2
  v_add_u32 v6, s35, v3
  v_xor_b32 v5, 64, v4
  s_add_u32 s35, s35, 53248
  s_cmp_eq_u32 s35, 159744
  s_cselect_b32 s35, 0, s35
  ds_read_b128 v[32:35], v4 offset:0
  ds_read_b128 v[36:39], v4 offset:2048
  ds_read_b64_tr_b16 v[64:65], v6 offset:0
  ds_read_b64_tr_b16 v[66:67], v6 offset:1280
  ds_read_b128 v[40:43], v4 offset:4096
  ds_read_b128 v[44:47], v4 offset:6144
  ds_read_b64_tr_b16 v[68:69], v6 offset:32
  ds_read_b64_tr_b16 v[70:71], v6 offset:1312
  s_cmp_lt_u32 s26, 2
  s_cselect_b32 s36, 2, 1
  s_sub_u32 s62, 10, s36
.p2align 6
L_cloop_sw1:
  s_waitcnt lgkmcnt(4)
  v_mfma_f32_16x16x32_bf16 v[96:99], v[64:67], v[32:35], v[96:99]
  ds_read_b64_tr_b16 v[72:73], v6 offset:64
  v_mfma_f32_16x16x32_bf16 v[100:103], v[64:67], v[36:39], v[100:103]
  ds_read_b64_tr_b16 v[74:75], v6 offset:1344
  s_waitcnt lgkmcnt(5)
  v_mfma_f32_16x16x32_bf16 v[104:107], v[64:67], v[40:43], v[104:107]
  ds_read_b64_tr_b16 v[76:77], v6 offset:96
  s_waitcnt lgkmcnt(5)
  v_mfma_f32_16x16x32_bf16 v[108:111], v[64:67], v[44:47], v[108:111]
  ds_read_b64_tr_b16 v[78:79], v6 offset:1376
  s_waitcnt lgkmcnt(4)
  v_mfma_f32_16x16x32_bf16 v[124:127], v[68:71], v[44:47], v[124:127]
  ds_read_b64_tr_b16 v[64:65], v6 offset:128
  v_mfma_f32_16x16x32_bf16 v[120:123], v[68:71], v[40:43], v[120:123]
  ds_read_b64_tr_b16 v[66:67], v6 offset:1408
  v_mfma_f32_16x16x32_bf16 v[116:119], v[68:71], v[36:39], v[116:119]
  v_mfma_f32_16x16x32_bf16 v[112:115], v[68:71], v[32:35], v[112:115]
  v_mfma_f32_16x16x32_bf16 v[80:83], v[68:71], v[92:95], v[80:83]
  s_waitcnt lgkmcnt(4)
  v_mfma_f32_16x16x32_bf16 v[128:131], v[72:75], v[32:35], v[128:131]
  ds_read_b64_tr_b16 v[68:69], v6 offset:10240
  v_mfma_f32_16x16x32_bf16 v[132:135], v[72:75], v[36:39], v[132:135]
  ds_read_b64_tr_b16 v[70:71], v6 offset:11520
  v_mfma_f32_16x16x32_bf16 v[136:139], v[72:75], v[40:43], v[136:139]
  v_mfma_f32_16x16x32_bf16 v[140:143], v[72:75], v[44:47], v[140:143]
  s_waitcnt lgkmcnt(4)
  v_mfma_f32_16x16x32_bf16 v[156:159], v[76:79], v[44:47], v[156:159]
  ds_read_b64_tr_b16 v[72:73], v6 offset:10272
  v_mfma_f32_16x16x32_bf16 v[152:155], v[76:79], v[40:43], v[152:155]
  ds_read_b64_tr_b16 v[74:75], v6 offset:11552
  v_mfma_f32_16x16x32_bf16 v[148:151], v[76:79], v[36:39], v[148:151]
  v_mfma_f32_16x16x32_bf16 v[144:147], v[76:79], v[32:35], v[144:147]
  s_waitcnt lgkmcnt(4)
  v_mfma_f32_16x16x32_bf16 v[160:163], v[64:67], v[32:35], v[160:163]
  ds_read_b64_tr_b16 v[76:77], v6 offset:10304
  v_mfma_f32_16x16x32_bf16 v[164:167], v[64:67], v[36:39], v[164:167]
  ds_read_b64_tr_b16 v[78:79], v6 offset:11584
  v_mfma_f32_16x16x32_bf16 v[168:171], v[64:67], v[40:43], v[168:171]
  ds_read_b128 v[48:51], v5 offset:0
  v_mfma_f32_16x16x32_bf16 v[172:175], v[64:67], v[44:47], v[172:175]
  s_waitcnt lgkmcnt(5)
  v_mfma_f32_16x16x32_bf16 v[188:191], v[68:71], v[44:47], v[188:191]
  ds_read_b64_tr_b16 v[64:65], v6 offset:10336
  v_mfma_f32_16x16x32_bf16 v[184:187], v[68:71], v[40:43], v[184:187]
  ds_read_b64_tr_b16 v[66:67], v6 offset:11616
  v_mfma_f32_16x16x32_bf16 v[180:183], v[68:71], v[36:39], v[180:183]
  ds_read_b128 v[52:55], v5 offset:2048
  v_mfma_f32_16x16x32_bf16 v[176:179], v[68:71], v[32:35], v[176:179]
  v_mfma_f32_16x16x32_bf16 v[84:87], v[68:71], v[92:95], v[84:87]
  s_waitcnt lgkmcnt(6)
  v_mfma_f32_16x16x32_bf16 v[192:195], v[72:75], v[32:35], v[192:195]
  ds_read_b64_tr_b16 v[68:69], v6 offset:10368
  v_mfma_f32_16x16x32_bf16 v[196:199], v[72:75], v[36:39], v[196:199]
  ds_read_b64_tr_b16 v[70:71], v6 offset:11648
  v_mfma_f32_16x16x32_bf16 v[200:203], v[72:75], v[40:43], v[200:203]
  ds_read_b128 v[56:59], v5 offset:4096
  v_mfma_f32_16x16x32_bf16 v[204:207], v[72:75], v[44:47], v[204:207]
  s_waitcnt lgkmcnt(7)
  v_mfma_f32_16x16x32_bf16 v[220:223], v[76:79], v[44:47], v[220:223]
  ds_read_b64_tr_b16 v[72:73], v6 offset:5120
  v_mfma_f32_16x16x32_bf16 v[216:219], v[76:79], v[40:43], v[216:219]
  ds_read_b64_tr_b16 v[74:75], v6 offset:6400
  v_mfma_f32_16x16x32_bf16 v[212:215], v[76:79], v[36:39], v[212:215]
  ds_read_b128 v[60:63], v5 offset:6144
  v_mfma_f32_16x16x32_bf16 v[208:211], v[76:79], v[32:35], v[208:211]
  s_waitcnt lgkmcnt(7)
  v_mfma_f32_16x16x32_bf16 v[224:227], v[64:67], v[32:35], v[224:227]
  ds_read_b64_tr_b16 v[76:77], v6 offset:5152
  v_mfma_f32_16x16x32_bf16 v[228:231], v[64:67], v[36:39], v[228:231]
  ds_read_b64_tr_b16 v[78:79], v6 offset:6432
  v_mfma_f32_16x16x32_bf16 v[232:235], v[64:67], v[40:43], v[232:235]
  v_mfma_f32_16x16x32_bf16 v[236:239], v[64:67], v[44:47], v[236:239]
  s_waitcnt lgkmcnt(6)
  v_mfma_f32_16x16x32_bf16 v[252:255], v[68:71], v[44:47], v[252:255]
  ds_read_b64_tr_b16 v[64:65], v6 offset:5184
  v_mfma_f32_16x16x32_bf16 v[248:251], v[68:71], v[40:43], v[248:251]
  ds_read_b64_tr_b16 v[66:67], v6 offset:6464
  v_mfma_f32_16x16x32_bf16 v[244:247], v[68:71], v[36:39], v[244:247]
  v_mfma_f32_16x16x32_bf16 v[240:243], v[68:71], v[32:35], v[240:243]
  v_mfma_f32_16x16x32_bf16 v[88:91], v[68:71], v[92:95], v[88:91]
  s_waitcnt lgkmcnt(5)
  v_mfma_f32_16x16x32_bf16 v[96:99], v[72:75], v[48:51], v[96:99]
  ds_read_b64_tr_b16 v[68:69], v6 offset:5216
  v_mfma_f32_16x16x32_bf16 v[100:103], v[72:75], v[52:55], v[100:103]
  ds_read_b64_tr_b16 v[70:71], v6 offset:6496
  v_mfma_f32_16x16x32_bf16 v[104:107], v[72:75], v[56:59], v[104:107]
  s_waitcnt lgkmcnt(6)
  v_mfma_f32_16x16x32_bf16 v[108:111], v[72:75], v[60:63], v[108:111]
  s_waitcnt lgkmcnt(4)
  v_mfma_f32_16x16x32_bf16 v[124:127], v[76:79], v[60:63], v[124:127]
  ds_read_b64_tr_b16 v[72:73], v6 offset:5248
  v_mfma_f32_16x16x32_bf16 v[120:123], v[76:79], v[56:59], v[120:123]
  ds_read_b64_tr_b16 v[74:75], v6 offset:6528
  v_mfma_f32_16x16x32_bf16 v[116:119], v[76:79], v[52:55], v[116:119]
  v_mfma_f32_16x16x32_bf16 v[112:115], v[76:79], v[48:51], v[112:115]
  v_mfma_f32_16x16x32_bf16 v[80:83], v[76:79], v[92:95], v[80:83]
  s_waitcnt lgkmcnt(4)
  v_mfma_f32_16x16x32_bf16 v[128:131], v[64:67], v[48:51], v[128:131]
  ds_read_b64_tr_b16 v[76:77], v6 offset:15360
  v_mfma_f32_16x16x32_bf16 v[132:135], v[64:67], v[52:55], v[132:135]
  ds_read_b64_tr_b16 v[78:79], v6 offset:16640
  v_mfma_f32_16x16x32_bf16 v[136:139], v[64:67], v[56:59], v[136:139]
  v_mfma_f32_16x16x32_bf16 v[140:143], v[64:67], v[60:63], v[140:143]
  s_waitcnt lgkmcnt(4)
  v_mfma_f32_16x16x32_bf16 v[156:159], v[68:71], v[60:63], v[156:159]
  ds_read_b64_tr_b16 v[64:65], v6 offset:15392
  v_mfma_f32_16x16x32_bf16 v[152:155], v[68:71], v[56:59], v[152:155]
  ds_read_b64_tr_b16 v[66:67], v6 offset:16672
  v_mfma_f32_16x16x32_bf16 v[148:151], v[68:71], v[52:55], v[148:151]
  v_mfma_f32_16x16x32_bf16 v[144:147], v[68:71], v[48:51], v[144:147]
  s_waitcnt lgkmcnt(4)
  v_mfma_f32_16x16x32_bf16 v[160:163], v[72:75], v[48:51], v[160:163]
  ds_read_b64_tr_b16 v[68:69], v6 offset:15424
  v_mfma_f32_16x16x32_bf16 v[164:167], v[72:75], v[52:55], v[164:167]
  ds_read_b64_tr_b16 v[70:71], v6 offset:16704
  v_mfma_f32_16x16x32_bf16 v[168:171], v[72:75], v[56:59], v[168:171]
  v_mfma_f32_16x16x32_bf16 v[172:175], v[72:75], v[60:63], v[172:175]
  s_waitcnt lgkmcnt(4)
  v_mfma_f32_16x16x32_bf16 v[188:191], v[76:79], v[60:63], v[188:191]
  ds_read_b64_tr_b16 v[72:73], v6 offset:15456
  v_mfma_f32_16x16x32_bf16 v[184:187], v[76:79], v[56:59], v[184:187]
  ds_read_b64_tr_b16 v[74:75], v6 offset:16736
  v_mfma_f32_16x16x32_bf16 v[180:183], v[76:79], v[52:55], v[180:183]
  v_mfma_f32_16x16x32_bf16 v[176:179], v[76:79], v[48:51], v[176:179]
  v_mfma_f32_16x16x32_bf16 v[84:87], v[76:79], v[92:95], v[84:87]
  s_waitcnt lgkmcnt(4)
  v_mfma_f32_16x16x32_bf16 v[192:195], v[64:67], v[48:51], v[192:195]
  ds_read_b64_tr_b16 v[76:77], v6 offset:15488
  v_mfma_f32_16x16x32_bf16 v[196:199], v[64:67], v[52:55], v[196:199]
  ds_read_b64_tr_b16 v[78:79], v6 offset:16768
  v_mfma_f32_16x16x32_bf16 v[200:203], v[64:67], v[56:59], v[200:203]
  v_mfma_f32_16x16x32_bf16 v[204:207], v[64:67], v[60:63], v[204:207]
  s_waitcnt lgkmcnt(4)
  v_mfma_f32_16x16x32_bf16 v[220:223], v[68:71], v[60:63], v[220:223]
  v_mfma_f32_16x16x32_bf16 v[216:219], v[68:71], v[56:59], v[216:219]
  v_mfma_f32_16x16x32_bf16 v[212:215], v[68:71], v[52:55], v[212:215]
  v_mfma_f32_16x16x32_bf16 v[208:211], v[68:71], v[48:51], v[208:211]
  s_waitcnt lgkmcnt(0)
  s_barrier
  v_add_u32 v4, s35, v2
  v_add_u32 v6, s35, v3
  v_xor_b32 v5, 64, v4
  s_add_u32 s35, s35, 53248
  s_cmp_eq_u32 s35, 159744
  s_cselect_b32 s35, 0, s35
  v_mfma_f32_16x16x32_bf16 v[224:227], v[72:75], v[48:51], v[224:227]
  ds_read_b128 v[32:35], v4 offset:0
  v_mfma_f32_16x16x32_bf16 v[228:231], v[72:75], v[52:55], v[228:231]
  ds_read_b128 v[36:39], v4 offset:2048
  v_mfma_f32_16x16x32_bf16 v[232:235], v[72:75], v[56:59], v[232:235]
  ds_read_b64_tr_b16 v[64:65], v6 offset:0
  v_mfma_f32_16x16x32_bf16 v[236:239], v[72:75], v[60:63], v[236:239]
  ds_read_b64_tr_b16 v[66:67], v6 offset:1280
  v_mfma_f32_16x16x32_bf16 v[252:255], v[76:79], v[60:63], v[252:255]
  ds_read_b128 v[40:43], v4 offset:4096
  v_mfma_f32_16x16x32_bf16 v[248:251], v[76:79], v[56:59], v[248:251]
  ds_read_b128 v[44:47], v4 offset:6144
  v_mfma_f32_16x16x32_bf16 v[244:247], v[76:79], v[52:55], v[244:247]
  ds_read_b64_tr_b16 v[68:69], v6 offset:32
  v_mfma_f32_16x16x32_bf16 v[240:243], v[76:79], v[48:51], v[240:243]
  v_mfma_f32_16x16x32_bf16 v[88:91], v[76:79], v[92:95], v[88:91]
  ds_read_b64_tr_b16 v[70:71], v6 offset:1312
  s_sub_u32 s36, s36, 1
  s_cmp_lg_u32 s36, 0
  s_cbranch_scc1 L_cloop_sw1
  v_lshlrev_b32 v11, 4, v10
  v_add_u32 v11, 161792, v11
  v_cmp_eq_u32 vcc, 0, v9
  s_nop 5
  s_and_saveexec_b64 s[64:65], vcc
  ds_write_b128 v11, v[80:83] offset:64
  ds_write_b128 v11, v[84:87] offset:320
  ds_write_b128 v11, v[88:91] offset:576
  s_mov_b64 exec, s[64:65]
  s_nop 3
  s_mov_b32 s36, s62
  s_branch L_cloopN_sw
L_sw_n1:
  s_cmp_eq_u32 s28, 2
  s_cbranch_scc0 L_sw_n2
  s_mov_b32 s35, 0
  s_barrier
  v_add_u32 v4, s35, v2
  v_add_u32 v6, s35, v3
  v_xor_b32 v5, 64, v4
  s_add_u32 s35, s35, 53248
  s_cmp_eq_u32 s35, 159744
  s_cselect_b32 s35, 0, s35
  ds_read_b128 v[32:35], v4 offset:0
  ds_read_b128 v[36:39], v4 offset:2048
  ds_read_b64_tr_b16 v[64:65], v6 offset:0
  ds_read_b64_tr_b16 v[66:67], v6 offset:1280
  ds_read_b128 v[40:43], v4 offset:4096
  ds_read_b128 v[44:47], v4 offset:6144
  ds_read_b64_tr_b16 v[68:69], v6 offset:32
  ds_read_b64_tr_b16 v[70:71], v6 offset:1312
  s_cmp_lt_u32 s26, 2
  s_cselect_b32 s36, 2, 1
  s_sub_u32 s62, 10, s36
.p2align 6
L_cloop_sw2:
  s_waitcnt lgkmcnt(4)
  v_mfma_f32_16x16x32_bf16 v[96:99], v[64:67], v[32:35], v[96:99]
  ds_read_b64_tr_b16 v[72:73], v6 offset:64
  v_mfma_f32_16x16x32_bf16 v[100:103], v[64:67], v[36:39], v[100:103]
  ds_read_b64_tr_b16 v[74:75], v6 offset:1344
  s_waitcnt lgkmcnt(5)
  v_mfma_f32_16x16x32_bf16 v[104:107], v[64:67], v[40:43], v[104:107]
  ds_read_b64_tr_b16 v[76:77], v6 offset:96
  s_waitcnt lgkmcnt(5)
  v_mfma_f32_16x16x32_bf16 v[108:111], v[64:67], v[44:47], v[108:111]
  ds_read_b64_tr_b16 v[78:79], v6 offset:1376
  s_waitcnt lgkmcnt(4)
  v_mfma_f32_16x16x32_bf16 v[124:127], v[68:71], v[44:47], v[124:127]
  ds_read_b64_tr_b16 v[64:65], v6 offset:128
  v_mfma_f32_16x16x32_bf16 v[120:123], v[68:71], v[40:43], v[120:123]
  ds_read_b64_tr_b16 v[66:67], v6 offset:1408
  v_mfma_f32_16x16x32_bf16 v[116:119], v[68:71], v[36:39], v[116:119]
  v_mfma_f32_16x16x32_bf16 v[112:115], v[68:71], v[32:35], v[112:115]
  s_waitcnt lgkmcnt(4)
  v_mfma_f32_16x16x32_bf16 v[128:131], v[72:75], v[32:35], v[128:131]
  ds_read_b64_tr_b16 v[68:69], v6 offset:10240
  v_mfma_f32_16x16x32_bf16 v[132:135], v[72:75], v[36:39], v[132:135]
  ds_read_b64_tr_b16 v[70:71], v6 offset:11520
  v_mfma_f32_16x16x32_bf16 v[136:139], v[72:75], v[40:43], v[136:139]
  v_mfma_f32_16x16x32_bf16 v[140:143], v[72:75], v[44:47], v[140:143]
  v_mfma_f32_16x16x32_bf16 v[80:83], v[72:75], v[92:95], v[80:83]
  s_waitcnt lgkmcnt(4)
  v_mfma_f32_16x16x32_bf16 v[156:159], v[76:79], v[44:47], v[156:159]
  ds_read_b64_tr_b16 v[72:73], v6 offset:10272
  v_mfma_f32_16x16x32_bf16 v[152:155], v[76:79], v[40:43], v[152:155]
  ds_read_b64_tr_b16 v[74:75], v6 offset:11552
  v_mfma_f32_16x16x32_bf16 v[148:151], v[76:79], v[36:39], v[148:151]
  v_mfma_f32_16x16x32_bf16 v[144:147], v[76:79], v[32:35], v[144:147]
  s_waitcnt lgkmcnt(4)
  v_mfma_f32_16x16x32_bf16 v[160:163], v[64:67], v[32:35], v[160:163]
  ds_read_b64_tr_b16 v[76:77], v6 offset:10304
  v_mfma_f32_16x16x32_bf16 v[164:167], v[64:67], v[36:39], v[164:167]
  ds_read_b64_tr_b16 v[78:79], v6 offset:11584
  v_mfma_f32_16x16x32_bf16 v[168:171], v[64:67], v[40:43], v[168:171]
  ds_read_b128 v[48:51], v5 offset:0
  v_mfma_f32_16x16x32_bf16 v[172:175], v[64:67], v[44:47], v[172:175]
  s_waitcnt lgkmcnt(5)
  v_mfma_f32_16x16x32_bf16 v[188:191], v[68:71], v[44:47], v[188:191]
  ds_read_b64_tr_b16 v[64:65], v6 offset:10336
  v_mfma_f32_16x16x32_bf16 v[184:187], v[68:71], v[40:43], v[184:187]
  ds_read_b64_tr_b16 v[66:67], v6 offset:11616
  v_mfma_f32_16x16x32_bf16 v[180:183], v[68:71], v[36:39], v[180:183]
  ds_read_b128 v[52:55], v5 offset:2048
  v_mfma_f32_16x16x32_bf16 v[176:179], v[68:71], v[32:35], v[176:179]
  s_waitcnt lgkmcnt(6)
  v_mfma_f32_16x16x32_bf16 v[192:195], v[72:75], v[32:35], v[192:195]
  ds_read_b64_tr_b16 v[68:69], v6 offset:10368
  v_mfma_f32_16x16x32_bf16 v[196:199], v[72:75], v[36:39], v[196:199]
  ds_read_b64_tr_b16 v[70:71], v6 offset:11648
  v_mfma_f32_16x16x32_bf16 v[200:203], v[72:75], v[40:43], v[200:203]
  ds_read_b128 v[56:59], v5 offset:4096
  v_mfma_f32_16x16x32_bf16 v[204:207], v[72:75], v[44:47], v[204:207]
  v_mfma_f32_16x16x32_bf16 v[84:87], v[72:75], v[92:95], v[84:87]
  s_waitcnt lgkmcnt(7)
  v_mfma_f32_16x16x32_bf16 v[220:223], v[76:79], v[44:47], v[220:223]
  ds_read_b64_tr_b16 v[72:73], v6 offset:5120
  v_mfma_f32_16x16x32_bf16 v[216:219], v[76:79], v[40:43], v[216:219]
  ds_read_b64_tr_b16 v[74:75], v6 offset:6400
  v_mfma_f32_16x16x32_bf16 v[212:215], v[76:79], v[36:39], v[212:215]
  ds_read_b128 v[60:63], v5 offset:6144
  v_mfma_f32_16x16x32_bf16 v[208:211], v[76:79], v[32:35], v[208:211]
  s_waitcnt lgkmcnt(7)
  v_mfma_f32_16x16x32_bf16 v[224:227], v[64:67], v[32:35], v[224:227]
  ds_read_b64_tr_b16 v[76:77], v6 offset:5152
  v_mfma_f32_16x16x32_bf16 v[228:231], v[64:67], v[36:39], v[228:231]
  ds_read_b64_tr_b16 v[78:79], v6 offset:6432
  v_mfma_f32_16x16x32_bf16 v[232:235], v[64:67], v[40:43], v[232:235]
  v_mfma_f32_16x16x32_bf16 v[236:239], v[64:67], v[44:47], v[236:239]
  s_waitcnt lgkmcnt(6)
  v_mfma_f32_16x16x32_bf16 v[252:255], v[68:71], v[44:47], v[252:255]
  ds_read_b64_tr_b16 v[64:65], v6 offset:5184
  v_mfma_f32_16x16x32_bf16 v[248:251], v[68:71], v[40:43], v[248:251]
  ds_read_b64_tr_b16 v[66:67], v6 offset:6464
  v_mfma_f32_16x16x32_bf16 v[244:247], v[68:71], v[36:39], v[244:247]
  v_mfma_f32_16x16x32_bf16 v[240:243], v[68:71], v[32:35], v[240:243]
  s_waitcnt lgkmcnt(5)
  v_mfma_f32_16x16x32_bf16 v[96:99], v[72:75], v[48:51], v[96:99]
  ds_read_b64_tr_b16 v[68:69], v6 offset:5216
  v_mfma_f32_16x16x32_bf16 v[100:103], v[72:75], v[52:55], v[100:103]
  ds_read_b64_tr_b16 v[70:71], v6 offset:6496
  v_mfma_f32_16x16x32_bf16 v[104:107], v[72:75], v[56:59], v[104:107]
  s_waitcnt lgkmcnt(6)
  v_mfma_f32_16x16x32_bf16 v[108:111], v[72:75], v[60:63], v[108:111]
  s_waitcnt lgkmcnt(4)
  v_mfma_f32_16x16x32_bf16 v[124:127], v[76:79], v[60:63], v[124:127]
  ds_read_b64_tr_b16 v[72:73], v6 offset:5248
  v_mfma_f32_16x16x32_bf16 v[120:123], v[76:79], v[56:59], v[120:123]
  ds_read_b64_tr_b16 v[74:75], v6 offset:6528
  v_mfma_f32_16x16x32_bf16 v[116:119], v[76:79], v[52:55], v[116:119]
  v_mfma_f32_16x16x32_bf16 v[112:115], v[76:79], v[48:51], v[112:115]
  s_waitcnt lgkmcnt(4)
  v_mfma_f32_16x16x32_bf16 v[128:131], v[64:67], v[48:51], v[128:131]
  ds_read_b64_tr_b16 v[76:77], v6 offset:15360
  v_mfma_f32_16x16x32_bf16 v[132:135], v[64:67], v[52:55], v[132:135]
  ds_read_b64_tr_b16 v[78:79], v6 offset:16640
  v_mfma_f32_16x16x32_bf16 v[136:139], v[64:67], v[56:59], v[136:139]
  v_mfma_f32_16x16x32_bf16 v[140:143], v[64:67], v[60:63], v[140:143]
  v_mfma_f32_16x16x32_bf16 v[80:83], v[64:67], v[92:95], v[80:83]
  s_waitcnt lgkmcnt(4)
  v_mfma_f32_16x16x32_bf16 v[156:159], v[68:71], v[60:63], v[156:159]
  ds_read_b64_tr_b16 v[64:65], v6 offset:15392
  v_mfma_f32_16x16x32_bf16 v[152:155], v[68:71], v[56:59], v[152:155]
  ds_read_b64_tr_b16 v[66:67], v6 offset:16672
  v_mfma_f32_16x16x32_bf16 v[148:151], v[68:71], v[52:55], v[148:151]
  v_mfma_f32_16x16x32_bf16 v[144:147], v[68:71], v[48:51], v[144:147]
  s_waitcnt lgkmcnt(4)
  v_mfma_f32_16x16x32_bf16 v[160:163], v[72:75], v[48:51], v[160:163]
  ds_read_b64_tr_b16 v[68:69], v6 offset:15424
  v_mfma_f32_16x16x32_bf16 v[164:167], v[72:75], v[52:55], v[164:167]
  ds_read_b64_tr_b16 v[70:71], v6 offset:16704
  v_mfma_f32_16x16x32_bf16 v[168:171], v[72:75], v[56:59], v[168:171]
  v_mfma_f32_16x16x32_bf16 v[172:175], v[72:75], v[60:63], v[172:175]
  s_waitcnt lgkmcnt(4)
  v_mfma_f32_16x16x32_bf16 v[188:191], v[76:79], v[60:63], v[188:191]
  ds_read_b64_tr_b16 v[72:73], v6 offset:15456
  v_mfma_f32_16x16x32_bf16 v[184:187], v[76:79], v[56:59], v[184:187]
  ds_read_b64_tr_b16 v[74:75], v6 offset:16736
  v_mfma_f32_16x16x32_bf16 v[180:183], v[76:79], v[52:55], v[180:183]
  v_mfma_f32_16x16x32_bf16 v[176:179], v[76:79], v[48:51], v[176:179]
  s_waitcnt lgkmcnt(4)
  v_mfma_f32_16x16x32_bf16 v[192:195], v[64:67], v[48:51], v[192:195]
  ds_read_b64_tr_b16 v[76:77], v6 offset:15488
  v_mfma_f32_16x16x32_bf16 v[196:199], v[64:67], v[52:55], v[196:199]
  ds_read_b64_tr_b16 v[78:79], v6 offset:16768
  v_mfma_f32_16x16x32_bf16 v[200:203], v[64:67], v[56:59], v[200:203]
  v_mfma_f32_16x16x32_bf16 v[204:207], v[64:67], v[60:63], v[204:207]
  v_mfma_f32_16x16x32_bf16 v[84:87], v[64:67], v[92:95], v[84:87]
  s_waitcnt lgkmcnt(4)
  v_mfma_f32_16x16x32_bf16 v[220:223], v[68:71], v[60:63], v[220:223]
  v_mfma_f32_16x16x32_bf16 v[216:219], v[68:71], v[56:59], v[216:219]
  v_mfma_f32_16x16x32_bf16 v[212:215], v[68:71], v[52:55], v[212:215]
  v_mfma_f32_16x16x32_bf16 v[208:211], v[68:71], v[48:51], v[208:211]
  s_waitcnt lgkmcnt(0)
  s_barrier
  v_add_u32 v4, s35, v2
  v_add_u32 v6, s35, v3
  v_xor_b32 v5, 64, v4
  s_add_u32 s35, s35, 53248
  s_cmp_eq_u32 s35, 159744
  s_cselect_b32 s35, 0, s35
  v_mfma_f32_16x16x32_bf16 v[224:227], v[72:75], v[48:51], v[224:227]
  ds_read_b128 v[32:35], v4 offset:0
  v_mfma_f32_16x16x32_bf16 v[228:231], v[72:75], v[52:55], v[228:231]
  ds_read_b128 v[36:39], v4 offset:2048
  v_mfma_f32_16x16x32_bf16 v[232:235], v[72:75], v[56:59], v[232:235]
  ds_read_b64_tr_b16 v[64:65], v6 offset:0
  v_mfma_f32_16x16x32_bf16 v[236:239], v[72:75], v[60:63], v[236:239]
  ds_read_b64_tr_b16 v[66:67], v6 offset:1280
  v_mfma_f32_16x16x32_bf16 v[252:255], v[76:79], v[60:63], v[252:255]
  ds_read_b128 v[40:43], v4 offset:4096
  v_mfma_f32_16x16x32_bf16 v[248:251], v[76:79], v[56:59], v[248:251]
  ds_read_b128 v[44:47], v4 offset:6144
  v_mfma_f32_16x16x32_bf16 v[244:247], v[76:79], v[52:55], v[244:247]
  ds_read_b64_tr_b16 v[68:69], v6 offset:32
  v_mfma_f32_16x16x32_bf16 v[240:243], v[76:79], v[48:51], v[240:243]
  ds_read_b64_tr_b16 v[70:71], v6 offset:1312
  s_sub_u32 s36, s36, 1
  s_cmp_lg_u32 s36, 0
  s_cbranch_scc1 L_cloop_sw2
  v_lshlrev_b32 v11, 4, v10
  v_add_u32 v11, 161792, v11
  v_cmp_eq_u32 vcc, 0, v9
  s_nop 5
  s_and_saveexec_b64 s[64:65], vcc
  ds_write_b128 v11, v[80:83] offset:128
  ds_write_b128 v11, v[84:87] offset:384
  s_mov_b64 exec, s[64:65]
  s_nop 3
  s_mov_b32 s36, s62
  s_branch L_cloopN_sw
L_sw_n2:
  s_mov_b32 s35, 0
  s_barrier
  v_add_u32 v4, s35, v2
  v_add_u32 v6, s35, v3
  v_xor_b32 v5, 64, v4
  s_add_u32 s35, s35, 53248
  s_cmp_eq_u32 s35, 159744
  s_cselect_b32 s35, 0, s35
  ds_read_b128 v[32:35], v4 offset:0
  ds_read_b128 v[36:39], v4 offset:2048
  ds_read_b64_tr_b16 v[64:65], v6 offset:0
  ds_read_b64_tr_b16 v[66:67], v6 offset:1280
  ds_read_b128 v[40:43], v4 offset:4096
  ds_read_b128 v[44:47], v4 offset:6144
  ds_read_b64_tr_b16 v[68:69], v6 offset:32
  ds_read_b64_tr_b16 v[70:71], v6 offset:1312
  s_cmp_lt_u32 s26, 2
  s_cselect_b32 s36, 2, 1
  s_sub_u32 s62, 10, s36
.p2align 6
L_cloop_sw3:
  s_waitcnt lgkmcnt(4)
  v_mfma_f32_16x16x32_bf16 v[96:99], v[64:67], v[32:35], v[96:99]
  ds_read_b64_tr_b16 v[72:73], v6 offset:64
  v_mfma_f32_16x16x32_bf16 v[100:103], v[64:67], v[36:39], v[100:103]
  ds_read_b64_tr_b16 v[74:75], v6 offset:1344
  s_waitcnt lgkmcnt(5)
  v_mfma_f32_16x16x32_bf16 v[104:107], v[64:67], v[40:43], v[104:107]
  ds_read_b64_tr_b16 v[76:77], v6 offset:96
  s_waitcnt lgkmcnt(5)
  v_mfma_f32_16x16x32_bf16 v[108:111], v[64:67], v[44:47], v[108:111]
  ds_read_b64_tr_b16 v[78:79], v6 offset:1376
  s_waitcnt lgkmcnt(4)
  v_mfma_f32_16x16x32_bf16 v[124:127], v[68:71], v[44:47], v[124:127]
  ds_read_b64_tr_b16 v[64:65], v6 offset:128
  v_mfma_f32_16x16x32_bf16 v[120:123], v[68:71], v[40:43], v[120:123]
  ds_read_b64_tr_b16 v[66:67], v6 offset:1408
  v_mfma_f32_16x16x32_bf16 v[116:119], v[68:71], v[36:39], v[116:119]
  v_mfma_f32_16x16x32_bf16 v[112:115], v[68:71], v[32:35], v[112:115]
  s_waitcnt lgkmcnt(4)
  v_mfma_f32_16x16x32_bf16 v[128:131], v[72:75], v[32:35], v[128:131]
  ds_read_b64_tr_b16 v[68:69], v6 offset:10240
  v_mfma_f32_16x16x32_bf16 v[132:135], v[72:75], v[36:39], v[132:135]
  ds_read_b64_tr_b16 v[70:71], v6 offset:11520
  v_mfma_f32_16x16x32_bf16 v[136:139], v[72:75], v[40:43], v[136:139]
  v_mfma_f32_16x16x32_bf16 v[140:143], v[72:75], v[44:47], v[140:143]
  s_waitcnt lgkmcnt(4)
  v_mfma_f32_16x16x32_bf16 v[156:159], v[76:79], v[44:47], v[156:159]
  ds_read_b64_tr_b16 v[72:73], v6 offset:10272
  v_mfma_f32_16x16x32_bf16 v[152:155], v[76:79], v[40:43], v[152:155]
  ds_read_b64_tr_b16 v[74:75], v6 offset:11552
  v_mfma_f32_16x16x32_bf16 v[148:151], v[76:79], v[36:39], v[148:151]
  v_mfma_f32_16x16x32_bf16 v[144:147], v[76:79], v[32:35], v[144:147]
  v_mfma_f32_16x16x32_bf16 v[80:83], v[76:79], v[92:95], v[80:83]
  s_waitcnt lgkmcnt(4)
  v_mfma_f32_16x16x32_bf16 v[160:163], v[64:67], v[32:35], v[160:163]
  ds_read_b64_tr_b16 v[76:77], v6 offset:10304
  v_mfma_f32_16x16x32_bf16 v[164:167], v[64:67], v[36:39], v[164:167]
  ds_read_b64_tr_b16 v[78:79], v6 offset:11584
  v_mfma_f32_16x16x32_bf16 v[168:171], v[64:67], v[40:43], v[168:171]
  ds_read_b128 v[48:51], v5 offset:0
  v_mfma_f32_16x16x32_bf16 v[172:175], v[64:67], v[44:47], v[172:175]
  s_waitcnt lgkmcnt(5)
  v_mfma_f32_16x16x32_bf16 v[188:191], v[68:71], v[44:47], v[188:191]
  ds_read_b64_tr_b16 v[64:65], v6 offset:10336
  v_mfma_f32_16x16x32_bf16 v[184:187], v[68:71], v[40:43], v[184:187]
  ds_read_b64_tr_b16 v[66:67], v6 offset:11616
  v_mfma_f32_16x16x32_bf16 v[180:183], v[68:71], v[36:39], v[180:183]
  ds_read_b128 v[52:55], v5 offset:2048
  v_mfma_f32_16x16x32_bf16 v[176:179], v[68:71], v[32:35], v[176:179]
  s_waitcnt lgkmcnt(6)
  v_mfma_f32_16x16x32_bf16 v[192:195], v[72:75], v[32:35], v[192:195]
  ds_read_b64_tr_b16 v[68:69], v6 offset:10368
  v_mfma_f32_16x16x32_bf16 v[196:199], v[72:75], v[36:39], v[196:199]
  ds_read_b64_tr_b16 v[70:71], v6 offset:11648
  v_mfma_f32_16x16x32_bf16 v[200:203], v[72:75], v[40:43], v[200:203]
  ds_read_b128 v[56:59], v5 offset:4096
  v_mfma_f32_16x16x32_bf16 v[204:207], v[72:75], v[44:47], v[204:207]
  s_waitcnt lgkmcnt(7)
  v_mfma_f32_16x16x32_bf16 v[220:223], v[76:79], v[44:47], v[220:223]
  ds_read_b64_tr_b16 v[72:73], v6 offset:5120
  v_mfma_f32_16x16x32_bf16 v[216:219], v[76:79], v[40:43], v[216:219]
  ds_read_b64_tr_b16 v[74:75], v6 offset:6400
  v_mfma_f32_16x16x32_bf16 v[212:215], v[76:79], v[36:39], v[212:215]
  ds_read_b128 v[60:63], v5 offset:6144
  v_mfma_f32_16x16x32_bf16 v[208:211], v[76:79], v[32:35], v[208:211]
  v_mfma_f32_16x16x32_bf16 v[84:87], v[76:79], v[92:95], v[84:87]
  s_waitcnt lgkmcnt(7)
  v_mfma_f32_16x16x32_bf16 v[224:227], v[64:67], v[32:35], v[224:227]
  ds_read_b64_tr_b16 v[76:77], v6 offset:5152
  v_mfma_f32_16x16x32_bf16 v[228:231], v[64:67], v[36:39], v[228:231]
  ds_read_b64_tr_b16 v[78:79], v6 offset:6432
  v_mfma_f32_16x16x32_bf16 v[232:235], v[64:67], v[40:43], v[232:235]
  v_mfma_f32_16x16x32_bf16 v[236:239], v[64:67], v[44:47], v[236:239]
  s_waitcnt lgkmcnt(6)
  v_mfma_f32_16x16x32_bf16 v[252:255], v[68:71], v[44:47], v[252:255]
  ds_read_b64_tr_b16 v[64:65], v6 offset:5184
  v_mfma_f32_16x16x32_bf16 v[248:251], v[68:71], v[40:43], v[248:251]
  ds_read_b64_tr_b16 v[66:67], v6 offset:6464
  v_mfma_f32_16x16x32_bf16 v[244:247], v[68:71], v[36:39], v[244:247]
  v_mfma_f32_16x16x32_bf16 v[240:243], v[68:71], v[32:35], v[240:243]
  s_waitcnt lgkmcnt(5)
  v_mfma_f32_16x16x32_bf16 v[96:99], v[72:75], v[48:51], v[96:99]
  ds_read_b64_tr_b16 v[68:69], v6 offset:5216
  v_mfma_f32_16x16x32_bf16 v[100:103], v[72:75], v[52:55], v[100:103]
  ds_read_b64_tr_b16 v[70:71], v6 offset:6496
  v_mfma_f32_16x16x32_bf16 v[104:107], v[72:75], v[56:59], v[104:107]
  s_waitcnt lgkmcnt(6)
  v_mfma_f32_16x16x32_bf16 v[108:111], v[72:75], v[60:63], v[108:111]
  s_waitcnt lgkmcnt(4)
  v_mfma_f32_16x16x32_bf16 v[124:127], v[76:79], v[60:63], v[124:127]
  ds_read_b64_tr_b16 v[72:73], v6 offset:5248
  v_mfma_f32_16x16x32_bf16 v[120:123], v[76:79], v[56:59], v[120:123]
  ds_read_b64_tr_b16 v[74:75], v6 offset:6528
  v_mfma_f32_16x16x32_bf16 v[116:119], v[76:79], v[52:55], v[116:119]
  v_mfma_f32_16x16x32_bf16 v[112:115], v[76:79], v[48:51], v[112:115]
  s_waitcnt lgkmcnt(4)
  v_mfma_f32_16x16x32_bf16 v[128:131], v[64:67], v[48:51], v[128:131]
  ds_read_b64_tr_b16 v[76:77], v6 offset:15360
  v_mfma_f32_16x16x32_bf16 v[132:135], v[64:67], v[52:55], v[132:135]
  ds_read_b64_tr_b16 v[78:79], v6 offset:16640
  v_mfma_f32_16x16x32_bf16 v[136:139], v[64:67], v[56:59], v[136:139]
  v_mfma_f32_16x16x32_bf16 v[140:143], v[64:67], v[60:63], v[140:143]
  s_waitcnt lgkmcnt(4)
  v_mfma_f32_16x16x32_bf16 v[156:159], v[68:71], v[60:63], v[156:159]
  ds_read_b64_tr_b16 v[64:65], v6 offset:15392
  v_mfma_f32_16x16x32_bf16 v[152:155], v[68:71], v[56:59], v[152:155]
  ds_read_b64_tr_b16 v[66:67], v6 offset:16672
  v_mfma_f32_16x16x32_bf16 v[148:151], v[68:71], v[52:55], v[148:151]
  v_mfma_f32_16x16x32_bf16 v[144:147], v[68:71], v[48:51], v[144:147]
  v_mfma_f32_16x16x32_bf16 v[80:83], v[68:71], v[92:95], v[80:83]
  s_waitcnt lgkmcnt(4)
  v_mfma_f32_16x16x32_bf16 v[160:163], v[72:75], v[48:51], v[160:163]
  ds_read_b64_tr_b16 v[68:69], v6 offset:15424
  v_mfma_f32_16x16x32_bf16 v[164:167], v[72:75], v[52:55], v[164:167]
  ds_read_b64_tr_b16 v[70:71], v6 offset:16704
  v_mfma_f32_16x16x32_bf16 v[168:171], v[72:75], v[56:59], v[168:171]
  v_mfma_f32_16x16x32_bf16 v[172:175], v[72:75], v[60:63], v[172:175]
  s_waitcnt lgkmcnt(4)
  v_mfma_f32_16x16x32_bf16 v[188:191], v[76:79], v[60:63], v[188:191]
  ds_read_b64_tr_b16 v[72:73], v6 offset:15456
  v_mfma_f32_16x16x32_bf16 v[184:187], v[76:79], v[56:59], v[184:187]
  ds_read_b64_tr_b16 v[74:75], v6 offset:16736
  v_mfma_f32_16x16x32_bf16 v[180:183], v[76:79], v[52:55], v[180:183]
  v_mfma_f32_16x16x32_bf16 v[176:179], v[76:79], v[48:51], v[176:179]
  s_waitcnt lgkmcnt(4)
  v_mfma_f32_16x16x32_bf16 v[192:195], v[64:67], v[48:51], v[192:195]
  ds_read_b64_tr_b16 v[76:77], v6 offset:15488
  v_mfma_f32_16x16x32_bf16 v[196:199], v[64:67], v[52:55], v[196:199]
  ds_read_b64_tr_b16 v[78:79], v6 offset:16768
  v_mfma_f32_16x16x32_bf16 v[200:203], v[64:67], v[56:59], v[200:203]
  v_mfma_f32_16x16x32_bf16 v[204:207], v[64:67], v[60:63], v[204:207]
  s_waitcnt lgkmcnt(4)
  v_mfma_f32_16x16x32_bf16 v[220:223], v[68:71], v[60:63], v[220:223]
  v_mfma_f32_16x16x32_bf16 v[216:219], v[68:71], v[56:59], v[216:219]
  v_mfma_f32_16x16x32_bf16 v[212:215], v[68:71], v[52:55], v[212:215]
  v_mfma_f32_16x16x32_bf16 v[208:211], v[68:71], v[48:51], v[208:211]
  v_mfma_f32_16x16x32_bf16 v[84:87], v[68:71], v[92:95], v[84:87]
  s_waitcnt lgkmcnt(0)
  s_barrier
  v_add_u32 v4, s35, v2
  v_add_u32 v6, s35, v3
  v_xor_b32 v5, 64, v4
  s_add_u32 s35, s35, 53248
  s_cmp_eq_u32 s35, 159744
  s_cselect_b32 s35, 0, s35
  v_mfma_f32_16x16x32_bf16 v[224:227], v[72:75], v[48:51], v[224:227]
  ds_read_b128 v[32:35], v4 offset:0
  v_mfma_f32_16x16x32_bf16 v[228:231], v[72:75], v[52:55], v[228:231]
  ds_read_b128 v[36:39], v4 offset:2048
  v_mfma_f32_16x16x32_bf16 v[232:235], v[72:75], v[56:59], v[232:235]
  ds_read_b64_tr_b16 v[64:65], v6 offset:0
  v_mfma_f32_16x16x32_bf16 v[236:239], v[72:75], v[60:63], v[236:239]
  ds_read_b64_tr_b16 v[66:67], v6 offset:1280
  v_mfma_f32_16x16x32_bf16 v[252:255], v[76:79], v[60:63], v[252:255]
  ds_read_b128 v[40:43], v4 offset:4096
  v_mfma_f32_16x16x32_bf16 v[248:251], v[76:79], v[56:59], v[248:251]
  ds_read_b128 v[44:47], v4 offset:6144
  v_mfma_f32_16x16x32_bf16 v[244:247], v[76:79], v[52:55], v[244:247]
  ds_read_b64_tr_b16 v[68:69], v6 offset:32
  v_mfma_f32_16x16x32_bf16 v[240:243], v[76:79], v[48:51], v[240:243]
  ds_read_b64_tr_b16 v[70:71], v6 offset:1312
  s_sub_u32 s36, s36, 1
  s_cmp_lg_u32 s36, 0
  s_cbranch_scc1 L_cloop_sw3
  v_lshlrev_b32 v11, 4, v10
  v_add_u32 v11, 161792, v11
  v_cmp_eq_u32 vcc, 0, v9
  s_nop 5
  s_and_saveexec_b64 s[64:65], vcc
  ds_write_b128 v11, v[80:83] offset:192
  ds_write_b128 v11, v[84:87] offset:448
  s_mov_b64 exec, s[64:65]
  s_nop 3
  s_mov_b32 s36, s62
  s_branch L_cloopN_sw
.p2align 6
L_cloopN_sw:
  s_waitcnt lgkmcnt(4)
  v_mfma_f32_16x16x32_bf16 v[96:99], v[64:67], v[32:35], v[96:99]
  ds_read_b64_tr_b16 v[72:73], v6 offset:64
  v_mfma_f32_16x16x32_bf16 v[100:103], v[64:67], v[36:39], v[100:103]
  ds_read_b64_tr_b16 v[74:75], v6 offset:1344
  s_waitcnt lgkmcnt(5)
  v_mfma_f32_16x16x32_bf16 v[104:107], v[64:67], v[40:43], v[104:107]
  ds_read_b64_tr_b16 v[76:77], v6 offset:96
  s_waitcnt lgkmcnt(5)
  v_mfma_f32_16x16x32_bf16 v[108:111], v[64:67], v[44:47], v[108:111]
  ds_read_b64_tr_b16 v[78:79], v6 offset:1376
  s_waitcnt lgkmcnt(4)
  v_mfma_f32_16x16x32_bf16 v[124:127], v[68:71], v[44:47], v[124:127]
  ds_read_b64_tr_b16 v[64:65], v6 offset:128
  v_mfma_f32_16x16x32_bf16 v[120:123], v[68:71], v[40:43], v[120:123]
  ds_read_b64_tr_b16 v[66:67], v6 offset:1408
  v_mfma_f32_16x16x32_bf16 v[116:119], v[68:71], v[36:39], v[116:119]
  v_mfma_f32_16x16x32_bf16 v[112:115], v[68:71], v[32:35], v[112:115]
  s_waitcnt lgkmcnt(4)
  v_mfma_f32_16x16x32_bf16 v[128:131], v[72:75], v[32:35], v[128:131]
  ds_read_b64_tr_b16 v[68:69], v6 offset:10240
  v_mfma_f32_16x16x32_bf16 v[132:135], v[72:75], v[36:39], v[132:135]
  ds_read_b64_tr_b16 v[70:71], v6 offset:11520
  v_mfma_f32_16x16x32_bf16 v[136:139], v[72:75], v[40:43], v[136:139]
  v_mfma_f32_16x16x32_bf16 v[140:143], v[72:75], v[44:47], v[140:143]
  s_waitcnt lgkmcnt(4)
  v_mfma_f32_16x16x32_bf16 v[156:159], v[76:79], v[44:47], v[156:159]
  ds_read_b64_tr_b16 v[72:73], v6 offset:10272
  v_mfma_f32_16x16x32_bf16 v[152:155], v[76:79], v[40:43], v[152:155]
  ds_read_b64_tr_b16 v[74:75], v6 offset:11552
  v_mfma_f32_16x16x32_bf16 v[148:151], v[76:79], v[36:39], v[148:151]
  v_mfma_f32_16x16x32_bf16 v[144:147], v[76:79], v[32:35], v[144:147]
  s_waitcnt lgkmcnt(4)
  v_mfma_f32_16x16x32_bf16 v[160:163], v[64:67], v[32:35], v[160:163]
  ds_read_b64_tr_b16 v[76:77], v6 offset:10304
  v_mfma_f32_16x16x32_bf16 v[164:167], v[64:67], v[36:39], v[164:167]
  ds_read_b64_tr_b16 v[78:79], v6 offset:11584
  v_mfma_f32_16x16x32_bf16 v[168:171], v[64:67], v[40:43], v[168:171]
  ds_read_b128 v[48:51], v5 offset:0
  v_mfma_f32_16x16x32_bf16 v[172:175], v[64:67], v[44:47], v[172:175]
  s_waitcnt lgkmcnt(5)
  v_mfma_f32_16x16x32_bf16 v[188:191], v[68:71], v[44:47], v[188:191]
  ds_read_b64_tr_b16 v[64:65], v6 offset:10336
  v_mfma_f32_16x16x32_bf16 v[184:187], v[68:71], v[40:43], v[184:187]
  ds_read_b64_tr_b16 v[66:67], v6 offset:11616
  v_mfma_f32_16x16x32_bf16 v[180:183], v[68:71], v[36:39], v[180:183]
  ds_read_b128 v[52:55], v5 offset:2048
  v_mfma_f32_16x16x32_bf16 v[176:179], v[68:71], v[32:35], v[176:179]
  s_waitcnt lgkmcnt(6)
  v_mfma_f32_16x16x32_bf16 v[192:195], v[72:75], v[32:35], v[192:195]
  ds_read_b64_tr_b16 v[68:69], v6 offset:10368
  v_mfma_f32_16x16x32_bf16 v[196:199], v[72:75], v[36:39], v[196:199]
  ds_read_b64_tr_b16 v[70:71], v6 offset:11648
  v_mfma_f32_16x16x32_bf16 v[200:203], v[72:75], v[40:43], v[200:203]
  ds_read_b128 v[56:59], v5 offset:4096
  v_mfma_f32_16x16x32_bf16 v[204:207], v[72:75], v[44:47], v[204:207]
  s_waitcnt lgkmcnt(7)
  v_mfma_f32_16x16x32_bf16 v[220:223], v[76:79], v[44:47], v[220:223]
  ds_read_b64_tr_b16 v[72:73], v6 offset:5120
  v_mfma_f32_16x16x32_bf16 v[216:219], v[76:79], v[40:43], v[216:219]
  ds_read_b64_tr_b16 v[74:75], v6 offset:6400
  v_mfma_f32_16x16x32_bf16 v[212:215], v[76:79], v[36:39], v[212:215]
  ds_read_b128 v[60:63], v5 offset:6144
  v_mfma_f32_16x16x32_bf16 v[208:211], v[76:79], v[32:35], v[208:211]
  s_waitcnt lgkmcnt(7)
  v_mfma_f32_16x16x32_bf16 v[224:227], v[64:67], v[32:35], v[224:227]
  ds_read_b64_tr_b16 v[76:77], v6 offset:5152
  v_mfma_f32_16x16x32_bf16 v[228:231], v[64:67], v[36:39], v[228:231]
  ds_read_b64_tr_b16 v[78:79], v6 offset:6432
  v_mfma_f32_16x16x32_bf16 v[232:235], v[64:67], v[40:43], v[232:235]
  v_mfma_f32_16x16x32_bf16 v[236:239], v[64:67], v[44:47], v[236:239]
  s_waitcnt lgkmcnt(6)
  v_mfma_f32_16x16x32_bf16 v[252:255], v[68:71], v[44:47], v[252:255]
  ds_read_b64_tr_b16 v[64:65], v6 offset:5184
  v_mfma_f32_16x16x32_bf16 v[248:251], v[68:71], v[40:43], v[248:251]
  ds_read_b64_tr_b16 v[66:67], v6 offset:6464
  v_mfma_f32_16x16x32_bf16 v[244:247], v[68:71], v[36:39], v[244:247]
  v_mfma_f32_16x16x32_bf16 v[240:243], v[68:71], v[32:35], v[240:243]
  s_waitcnt lgkmcnt(5)
  v_mfma_f32_16x16x32_bf16 v[96:99], v[72:75], v[48:51], v[96:99]
  ds_read_b64_tr_b16 v[68:69], v6 offset:5216
  v_mfma_f32_16x16x32_bf16 v[100:103], v[72:75], v[52:55], v[100:103]
  ds_read_b64_tr_b16 v[70:71], v6 offset:6496
  v_mfma_f32_16x16x32_bf16 v[104:107], v[72:75], v[56:59], v[104:107]
  s_waitcnt lgkmcnt(6)
  v_mfma_f32_16x16x32_bf16 v[108:111], v[72:75], v[60:63], v[108:111]
  s_waitcnt lgkmcnt(4)
  v_mfma_f32_16x16x32_bf16 v[124:127], v[76:79], v[60:63], v[124:127]
  ds_read_b64_tr_b16 v[72:73], v6 offset:5248
  v_mfma_f32_16x16x32_bf16 v[120:123], v[76:79], v[56:59], v[120:123]
  ds_read_b64_tr_b16 v[74:75], v6 offset:6528
  v_mfma_f32_16x16x32_bf16 v[116:119], v[76:79], v[52:55], v[116:119]
  v_mfma_f32_16x16x32_bf16 v[112:115], v[76:79], v[48:51], v[112:115]
  s_waitcnt lgkmcnt(4)
  v_mfma_f32_16x16x32_bf16 v[128:131], v[64:67], v[48:51], v[128:131]
  ds_read_b64_tr_b16 v[76:77], v6 offset:15360
  v_mfma_f32_16x16x32_bf16 v[132:135], v[64:67], v[52:55], v[132:135]
  ds_read_b64_tr_b16 v[78:79], v6 offset:16640
  v_mfma_f32_16x16x32_bf16 v[136:139], v[64:67], v[56:59], v[136:139]
  v_mfma_f32_16x16x32_bf16 v[140:143], v[64:67], v[60:63], v[140:143]
  s_waitcnt lgkmcnt(4)
  v_mfma_f32_16x16x32_bf16 v[156:159], v[68:71], v[60:63], v[156:159]
  ds_read_b64_tr_b16 v[64:65], v6 offset:15392
  v_mfma_f32_16x16x32_bf16 v[152:155], v[68:71], v[56:59], v[152:155]
  ds_read_b64_tr_b16 v[66:67], v6 offset:16672
  v_mfma_f32_16x16x32_bf16 v[148:151], v[68:71], v[52:55], v[148:151]
  v_mfma_f32_16x16x32_bf16 v[144:147], v[68:71], v[48:51], v[144:147]
  s_waitcnt lgkmcnt(4)
  v_mfma_f32_16x16x32_bf16 v[160:163], v[72:75], v[48:51], v[160:163]
  ds_read_b64_tr_b16 v[68:69], v6 offset:15424
  v_mfma_f32_16x16x32_bf16 v[164:167], v[72:75], v[52:55], v[164:167]
  ds_read_b64_tr_b16 v[70:71], v6 offset:16704
  v_mfma_f32_16x16x32_bf16 v[168:171], v[72:75], v[56:59], v[168:171]
  v_mfma_f32_16x16x32_bf16 v[172:175], v[72:75], v[60:63], v[172:175]
  s_waitcnt lgkmcnt(4)
  v_mfma_f32_16x16x32_bf16 v[188:191], v[76:79], v[60:63], v[188:191]
  ds_read_b64_tr_b16 v[72:73], v6 offset:15456
  v_mfma_f32_16x16x32_bf16 v[184:187], v[76:79], v[56:59], v[184:187]
  ds_read_b64_tr_b16 v[74:75], v6 offset:16736
  v_mfma_f32_16x16x32_bf16 v[180:183], v[76:79], v[52:55], v[180:183]
  v_mfma_f32_16x16x32_bf16 v[176:179], v[76:79], v[48:51], v[176:179]
  s_waitcnt lgkmcnt(4)
  v_mfma_f32_16x16x32_bf16 v[192:195], v[64:67], v[48:51], v[192:195]
  ds_read_b64_tr_b16 v[76:77], v6 offset:15488
  v_mfma_f32_16x16x32_bf16 v[196:199], v[64:67], v[52:55], v[196:199]
  ds_read_b64_tr_b16 v[78:79], v6 offset:16768
  v_mfma_f32_16x16x32_bf16 v[200:203], v[64:67], v[56:59], v[200:203]
  v_mfma_f32_16x16x32_bf16 v[204:207], v[64:67], v[60:63], v[204:207]
  s_waitcnt lgkmcnt(4)
  v_mfma_f32_16x16x32_bf16 v[220:223], v[68:71], v[60:63], v[220:223]
  v_mfma_f32_16x16x32_bf16 v[216:219], v[68:71], v[56:59], v[216:219]
  v_mfma_f32_16x16x32_bf16 v[212:215], v[68:71], v[52:55], v[212:215]
  v_mfma_f32_16x16x32_bf16 v[208:211], v[68:71], v[48:51], v[208:211]
  s_waitcnt lgkmcnt(0)
  s_barrier
  v_add_u32 v4, s35, v2
  v_add_u32 v6, s35, v3
  v_xor_b32 v5, 64, v4
  s_add_u32 s35, s35, 53248
  s_cmp_eq_u32 s35, 159744
  s_cselect_b32 s35, 0, s35
  v_mfma_f32_16x16x32_bf16 v[224:227], v[72:75], v[48:51], v[224:227]
  ds_read_b128 v[32:35], v4 offset:0
  v_mfma_f32_16x16x32_bf16 v[228:231], v[72:75], v[52:55], v[228:231]
  ds_read_b128 v[36:39], v4 offset:2048
  v_mfma_f32_16x16x32_bf16 v[232:235], v[72:75], v[56:59], v[232:235]
  ds_read_b64_tr_b16 v[64:65], v6 offset:0
  v_mfma_f32_16x16x32_bf16 v[236:239], v[72:75], v[60:63], v[236:239]
  ds_read_b64_tr_b16 v[66:67], v6 offset:1280
  v_mfma_f32_16x16x32_bf16 v[252:255], v[76:79], v[60:63], v[252:255]
  ds_read_b128 v[40:43], v4 offset:4096
  v_mfma_f32_16x16x32_bf16 v[248:251], v[76:79], v[56:59], v[248:251]
  ds_read_b128 v[44:47], v4 offset:6144
  v_mfma_f32_16x16x32_bf16 v[244:247], v[76:79], v[52:55], v[244:247]
  ds_read_b64_tr_b16 v[68:69], v6 offset:32
  v_mfma_f32_16x16x32_bf16 v[240:243], v[76:79], v[48:51], v[240:243]
  ds_read_b64_tr_b16 v[70:71], v6 offset:1312
  s_sub_u32 s36, s36, 1
  s_cmp_lg_u32 s36, 0
  s_cbranch_scc1 L_cloopN_sw
  s_waitcnt lgkmcnt(0)
L_sw_done:
  s_barrier
  s_cmp_eq_u32 s29, 0
  s_cbranch_scc1 L_epi_q
  s_lshl_b32 s37, s28, 9
  v_lshlrev_b32 v11, 3, v9
  v_add_u32 v11, s37, v11
  v_add_u32 v11, 159744, v11
  ds_read_b64 v[16:17], v11 offset:0
  ds_read_b64 v[18:19], v11 offset:128
  ds_read_b64 v[20:21], v11 offset:256
  ds_read_b64 v[22:23], v11 offset:384
  v_lshlrev_b32 v12, 4, v10
  v_add_u32 v12, 161792, v12
  ds_read_b128 v[32:35], v12 offset:0
  ds_read_b128 v[36:39], v12 offset:64
  ds_read_b128 v[40:43], v12 offset:128
  ds_read_b128 v[44:47], v12 offset:192
  ds_read_b128 v[48:51], v12 offset:256
  ds_read_b128 v[52:55], v12 offset:320
  ds_read_b128 v[56:59], v12 offset:384
  ds_read_b128 v[60:63], v12 offset:448
  ds_read_b128 v[64:67], v12 offset:512
  ds_read_b128 v[68:71], v12 offset:576
  s_waitcnt lgkmcnt(0)
  v_mul_f32 v24, 0xbfb8aa3b, v17
  v_mul_f32 v25, v17, v17
  v_mul_f32 v26, 0xbfb8aa3b, v19
  v_mul_f32 v27, v19, v19
  v_mul_f32 v28, 0xbfb8aa3b, v21
  v_mul_f32 v29, v21, v21
  v_mul_f32 v30, 0xbfb8aa3b, v23
  v_mul_f32 v31, v23, v23
  v_rcp_f32 v25, v25
  v_rcp_f32 v27, v27
  v_rcp_f32 v29, v29
  v_rcp_f32 v31, v31
  v_lshlrev_b32 v11, 4, v8
  s_mul_i32 s37, s28, 196608
  v_add_u32 v11, s37, v11
  s_mul_i32 s37, s26, 786432
  s_add_u32 s37, s37, 2621440
  s_mul_i32 s38, s30, 5
  s_add_u32 s39, s38, 1
  s_lshr_b32 s39, s39, 1
  s_lshl_b32 s39, s39, 10
  s_add_u32 s61, s37, s39
  s_and_b32 s62, s30, 1
  s_cmp_eq_u32 s62, 0
  s_cselect_b32 s62, 4, -1
  s_add_u32 s38, s38, s62
  s_lshr_b32 s38, s38, 1
  s_lshl_b32 s38, s38, 10
  s_add_u32 s62, s37, s38
  s_and_b32 s38, s30, 1
  s_lshl_b32 s38, s38, 3
  s_add_u32 s62, s62, s38
L_gu_b0:
  v_pk_fma_f32 v[96:97], v[32:33], v[16:17], v[96:97] op_sel_hi:[1,0,1] neg_lo:[0,1,0] neg_hi:[0,1,0]
  v_pk_fma_f32 v[176:177], v[52:53], v[16:17], v[176:177] op_sel_hi:[1,0,1] neg_lo:[0,1,0] neg_hi:[0,1,0]
  v_pk_fma_f32 v[98:99], v[34:35], v[16:17], v[98:99] op_sel_hi:[1,0,1] neg_lo:[0,1,0] neg_hi:[0,1,0]
  v_pk_fma_f32 v[178:179], v[54:55], v[16:17], v[178:179] op_sel_hi:[1,0,1] neg_lo:[0,1,0] neg_hi:[0,1,0]
  v_pk_fma_f32 v[112:113], v[36:37], v[16:17], v[112:113] op_sel_hi:[1,0,1] neg_lo:[0,1,0] neg_hi:[0,1,0]
  v_pk_fma_f32 v[192:193], v[56:57], v[16:17], v[192:193] op_sel_hi:[1,0,1] neg_lo:[0,1,0] neg_hi:[0,1,0]
  v_pk_fma_f32 v[114:115], v[38:39], v[16:17], v[114:115] op_sel_hi:[1,0,1] neg_lo:[0,1,0] neg_hi:[0,1,0]
  v_pk_fma_f32 v[194:195], v[58:59], v[16:17], v[194:195] op_sel_hi:[1,0,1] neg_lo:[0,1,0] neg_hi:[0,1,0]
  v_pk_fma_f32 v[128:129], v[40:41], v[16:17], v[128:129] op_sel_hi:[1,0,1] neg_lo:[0,1,0] neg_hi:[0,1,0]
  v_pk_fma_f32 v[208:209], v[60:61], v[16:17], v[208:209] op_sel_hi:[1,0,1] neg_lo:[0,1,0] neg_hi:[0,1,0]
  v_pk_fma_f32 v[130:131], v[42:43], v[16:17], v[130:131] op_sel_hi:[1,0,1] neg_lo:[0,1,0] neg_hi:[0,1,0]
  v_pk_fma_f32 v[210:211], v[62:63], v[16:17], v[210:211] op_sel_hi:[1,0,1] neg_lo:[0,1,0] neg_hi:[0,1,0]
  v_pk_fma_f32 v[144:145], v[44:45], v[16:17], v[144:145] op_sel_hi:[1,0,1] neg_lo:[0,1,0] neg_hi:[0,1,0]
  v_pk_fma_f32 v[224:225], v[64:65], v[16:17], v[224:225] op_sel_hi:[1,0,1] neg_lo:[0,1,0] neg_hi:[0,1,0]
  v_pk_fma_f32 v[146:147], v[46:47], v[16:17], v[146:147] op_sel_hi:[1,0,1] neg_lo:[0,1,0] neg_hi:[0,1,0]
  v_pk_fma_f32 v[226:227], v[66:67], v[16:17], v[226:227] op_sel_hi:[1,0,1] neg_lo:[0,1,0] neg_hi:[0,1,0]
  v_pk_fma_f32 v[160:161], v[48:49], v[16:17], v[160:161] op_sel_hi:[1,0,1] neg_lo:[0,1,0] neg_hi:[0,1,0]
  v_pk_fma_f32 v[240:241], v[68:69], v[16:17], v[240:241] op_sel_hi:[1,0,1] neg_lo:[0,1,0] neg_hi:[0,1,0]
  v_pk_fma_f32 v[162:163], v[50:51], v[16:17], v[162:163] op_sel_hi:[1,0,1] neg_lo:[0,1,0] neg_hi:[0,1,0]
  v_pk_fma_f32 v[242:243], v[70:71], v[16:17], v[242:243] op_sel_hi:[1,0,1] neg_lo:[0,1,0] neg_hi:[0,1,0]
  v_pk_mul_f32 v[72:73], v[96:97], v[24:25] op_sel_hi:[1,0]
  v_pk_mul_f32 v[74:75], v[98:99], v[24:25] op_sel_hi:[1,0]
  v_pk_mul_f32 v[76:77], v[112:113], v[24:25] op_sel_hi:[1,0]
  v_pk_mul_f32 v[78:79], v[114:115], v[24:25] op_sel_hi:[1,0]
  v_pk_mul_f32 v[80:81], v[128:129], v[24:25] op_sel_hi:[1,0]
  v_pk_mul_f32 v[82:83], v[130:131], v[24:25] op_sel_hi:[1,0]
  v_pk_mul_f32 v[84:85], v[144:145], v[24:25] op_sel_hi:[1,0]
  v_pk_mul_f32 v[86:87], v[146:147], v[24:25] op_sel_hi:[1,0]
  v_pk_mul_f32 v[88:89], v[160:161], v[24:25] op_sel_hi:[1,0]
  v_pk_mul_f32 v[90:91], v[162:163], v[24:25] op_sel_hi:[1,0]
  v_exp_f32 v72, v72
  v_exp_f32 v73, v73
  v_exp_f32 v74, v74
  v_exp_f32 v75, v75
  v_exp_f32 v76, v76
  v_exp_f32 v77, v77
  v_exp_f32 v78, v78
  v_exp_f32 v79, v79
  v_exp_f32 v80, v80
  v_exp_f32 v81, v81
  v_exp_f32 v82, v82
  v_exp_f32 v83, v83
  v_exp_f32 v84, v84
  v_exp_f32 v85, v85
  v_exp_f32 v86, v86
  v_exp_f32 v87, v87
  v_exp_f32 v88, v88
  v_exp_f32 v89, v89
  v_exp_f32 v90, v90
  v_exp_f32 v91, v91
  v_pk_mul_f32 v[176:177], v[96:97], v[176:177]
  v_pk_mul_f32 v[178:179], v[98:99], v[178:179]
  v_pk_mul_f32 v[192:193], v[112:113], v[192:193]
  v_pk_mul_f32 v[194:195], v[114:115], v[194:195]
  v_pk_mul_f32 v[208:209], v[128:129], v[208:209]
  v_pk_mul_f32 v[210:211], v[130:131], v[210:211]
  v_pk_mul_f32 v[224:225], v[144:145], v[224:225]
  v_pk_mul_f32 v[226:227], v[146:147], v[226:227]
  v_pk_mul_f32 v[240:241], v[160:161], v[240:241]
  v_pk_mul_f32 v[242:243], v[162:163], v[242:243]
  v_pk_fma_f32 v[72:73], v[72:73], v[24:25], v[24:25] op_sel:[0,1,1] op_sel_hi:[1,1,1]
  v_pk_fma_f32 v[74:75], v[74:75], v[24:25], v[24:25] op_sel:[0,1,1] op_sel_hi:[1,1,1]
  v_pk_fma_f32 v[76:77], v[76:77], v[24:25], v[24:25] op_sel:[0,1,1] op_sel_hi:[1,1,1]
  v_pk_fma_f32 v[78:79], v[78:79], v[24:25], v[24:25] op_sel:[0,1,1] op_sel_hi:[1,1,1]
  v_pk_fma_f32 v[80:81], v[80:81], v[24:25], v[24:25] op_sel:[0,1,1] op_sel_hi:[1,1,1]
  v_pk_fma_f32 v[82:83], v[82:83], v[24:25], v[24:25] op_sel:[0,1,1] op_sel_hi:[1,1,1]
  v_pk_fma_f32 v[84:85], v[84:85], v[24:25], v[24:25] op_sel:[0,1,1] op_sel_hi:[1,1,1]
  v_pk_fma_f32 v[86:87], v[86:87], v[24:25], v[24:25] op_sel:[0,1,1] op_sel_hi:[1,1,1]
  v_pk_fma_f32 v[88:89], v[88:89], v[24:25], v[24:25] op_sel:[0,1,1] op_sel_hi:[1,1,1]
  v_pk_fma_f32 v[90:91], v[90:91], v[24:25], v[24:25] op_sel:[0,1,1] op_sel_hi:[1,1,1]
  v_rcp_f32 v72, v72
  v_rcp_f32 v73, v73
  v_rcp_f32 v74, v74
  v_rcp_f32 v75, v75
  v_rcp_f32 v76, v76
  v_rcp_f32 v77, v77
  v_rcp_f32 v78, v78
  v_rcp_f32 v79, v79
  v_rcp_f32 v80, v80
  v_rcp_f32 v81, v81
  v_rcp_f32 v82, v82
  v_rcp_f32 v83, v83
  v_rcp_f32 v84, v84
  v_rcp_f32 v85, v85
  v_rcp_f32 v86, v86
  v_rcp_f32 v87, v87
  v_rcp_f32 v88, v88
  v_rcp_f32 v89, v89
  v_rcp_f32 v90, v90
  v_rcp_f32 v91, v91
  s_nop 0
  v_pk_mul_f32 v[176:177], v[176:177], v[72:73]
  v_pk_mul_f32 v[178:179], v[178:179], v[74:75]
  v_pk_mul_f32 v[192:193], v[192:193], v[76:77]
  v_pk_mul_f32 v[194:195], v[194:195], v[78:79]
  v_pk_mul_f32 v[208:209], v[208:209], v[80:81]
  v_pk_mul_f32 v[210:211], v[210:211], v[82:83]
  v_pk_mul_f32 v[224:225], v[224:225], v[84:85]
  v_pk_mul_f32 v[226:227], v[226:227], v[86:87]
  v_pk_mul_f32 v[240:241], v[240:241], v[88:89]
  v_pk_mul_f32 v[242:243], v[242:243], v[90:91]
  v_cvt_pk_bf16_f32 v96, v176, v177
  v_cvt_pk_bf16_f32 v97, v178, v179
  v_cvt_pk_bf16_f32 v98, v192, v193
  v_cvt_pk_bf16_f32 v99, v194, v195
  v_cvt_pk_bf16_f32 v128, v208, v209
  v_cvt_pk_bf16_f32 v129, v210, v211
  v_cvt_pk_bf16_f32 v130, v224, v225
  v_cvt_pk_bf16_f32 v131, v226, v227
  v_cvt_pk_bf16_f32 v160, v240, v241
  v_cvt_pk_bf16_f32 v161, v242, v243
  s_cbranch_execz L_dry_ret
  s_cmp_eq_u32 s30, 19
  s_cbranch_scc1 L_gu_skip0
  buffer_store_dwordx4 v[96:99], v11, s[20:23], s61 offen sc1
  buffer_store_dwordx4 v[128:131], v11, s[20:23], s61 offen offset:1024 sc1
L_gu_skip0:
  buffer_store_dwordx2 v[160:161], v11, s[20:23], s62 offen sc1
  s_nop 1
L_gu_b1:
  v_pk_fma_f32 v[100:101], v[32:33], v[18:19], v[100:101] op_sel_hi:[1,0,1] neg_lo:[0,1,0] neg_hi:[0,1,0]
  v_pk_fma_f32 v[180:181], v[52:53], v[18:19], v[180:181] op_sel_hi:[1,0,1] neg_lo:[0,1,0] neg_hi:[0,1,0]
  v_pk_fma_f32 v[102:103], v[34:35], v[18:19], v[102:103] op_sel_hi:[1,0,1] neg_lo:[0,1,0] neg_hi:[0,1,0]
  v_pk_fma_f32 v[182:183], v[54:55], v[18:19], v[182:183] op_sel_hi:[1,0,1] neg_lo:[0,1,0] neg_hi:[0,1,0]
  v_pk_fma_f32 v[116:117], v[36:37], v[18:19], v[116:117] op_sel_hi:[1,0,1] neg_lo:[0,1,0] neg_hi:[0,1,0]
  v_pk_fma_f32 v[196:197], v[56:57], v[18:19], v[196:197] op_sel_hi:[1,0,1] neg_lo:[0,1,0] neg_hi:[0,1,0]
  v_pk_fma_f32 v[118:119], v[38:39], v[18:19], v[118:119] op_sel_hi:[1,0,1] neg_lo:[0,1,0] neg_hi:[0,1,0]
  v_pk_fma_f32 v[198:199], v[58:59], v[18:19], v[198:199] op_sel_hi:[1,0,1] neg_lo:[0,1,0] neg_hi:[0,1,0]
  v_pk_fma_f32 v[132:133], v[40:41], v[18:19], v[132:133] op_sel_hi:[1,0,1] neg_lo:[0,1,0] neg_hi:[0,1,0]
  v_pk_fma_f32 v[212:213], v[60:61], v[18:19], v[212:213] op_sel_hi:[1,0,1] neg_lo:[0,1,0] neg_hi:[0,1,0]
  v_pk_fma_f32 v[134:135], v[42:43], v[18:19], v[134:135] op_sel_hi:[1,0,1] neg_lo:[0,1,0] neg_hi:[0,1,0]
  v_pk_fma_f32 v[214:215], v[62:63], v[18:19], v[214:215] op_sel_hi:[1,0,1] neg_lo:[0,1,0] neg_hi:[0,1,0]
  v_pk_fma_f32 v[148:149], v[44:45], v[18:19], v[148:149] op_sel_hi:[1,0,1] neg_lo:[0,1,0] neg_hi:[0,1,0]
  v_pk_fma_f32 v[228:229], v[64:65], v[18:19], v[228:229] op_sel_hi:[1,0,1] neg_lo:[0,1,0] neg_hi:[0,1,0]
  v_pk_fma_f32 v[150:151], v[46:47], v[18:19], v[150:151] op_sel_hi:[1,0,1] neg_lo:[0,1,0] neg_hi:[0,1,0]
  v_pk_fma_f32 v[230:231], v[66:67], v[18:19], v[230:231] op_sel_hi:[1,0,1] neg_lo:[0,1,0] neg_hi:[0,1,0]
  v_pk_fma_f32 v[164:165], v[48:49], v[18:19], v[164:165] op_sel_hi:[1,0,1] neg_lo:[0,1,0] neg_hi:[0,1,0]
  v_pk_fma_f32 v[244:245], v[68:69], v[18:19], v[244:245] op_sel_hi:[1,0,1] neg_lo:[0,1,0] neg_hi:[0,1,0]
  v_pk_fma_f32 v[166:167], v[50:51], v[18:19], v[166:167] op_sel_hi:[1,0,1] neg_lo:[0,1,0] neg_hi:[0,1,0]
  v_pk_fma_f32 v[246:247], v[70:71], v[18:19], v[246:247] op_sel_hi:[1,0,1] neg_lo:[0,1,0] neg_hi:[0,1,0]
  v_pk_mul_f32 v[72:73], v[100:101], v[26:27] op_sel_hi:[1,0]
  v_pk_mul_f32 v[74:75], v[102:103], v[26:27] op_sel_hi:[1,0]
  v_pk_mul_f32 v[76:77], v[116:117], v[26:27] op_sel_hi:[1,0]
  v_pk_mul_f32 v[78:79], v[118:119], v[26:27] op_sel_hi:[1,0]
  v_pk_mul_f32 v[80:81], v[132:133], v[26:27] op_sel_hi:[1,0]
  v_pk_mul_f32 v[82:83], v[134:135], v[26:27] op_sel_hi:[1,0]
  v_pk_mul_f32 v[84:85], v[148:149], v[26:27] op_sel_hi:[1,0]
  v_pk_mul_f32 v[86:87], v[150:151], v[26:27] op_sel_hi:[1,0]
  v_pk_mul_f32 v[88:89], v[164:165], v[26:27] op_sel_hi:[1,0]
  v_pk_mul_f32 v[90:91], v[166:167], v[26:27] op_sel_hi:[1,0]
  v_exp_f32 v72, v72
  v_exp_f32 v73, v73
  v_exp_f32 v74, v74
  v_exp_f32 v75, v75
  v_exp_f32 v76, v76
  v_exp_f32 v77, v77
  v_exp_f32 v78, v78
  v_exp_f32 v79, v79
  v_exp_f32 v80, v80
  v_exp_f32 v81, v81
  v_exp_f32 v82, v82
  v_exp_f32 v83, v83
  v_exp_f32 v84, v84
  v_exp_f32 v85, v85
  v_exp_f32 v86, v86
  v_exp_f32 v87, v87
  v_exp_f32 v88, v88
  v_exp_f32 v89, v89
  v_exp_f32 v90, v90
  v_exp_f32 v91, v91
  v_pk_mul_f32 v[180:181], v[100:101], v[180:181]
  v_pk_mul_f32 v[182:183], v[102:103], v[182:183]
  v_pk_mul_f32 v[196:197], v[116:117], v[196:197]
  v_pk_mul_f32 v[198:199], v[118:119], v[198:199]
  v_pk_mul_f32 v[212:213], v[132:133], v[212:213]
  v_pk_mul_f32 v[214:215], v[134:135], v[214:215]
  v_pk_mul_f32 v[228:229], v[148:149], v[228:229]
  v_pk_mul_f32 v[230:231], v[150:151], v[230:231]
  v_pk_mul_f32 v[244:245], v[164:165], v[244:245]
  v_pk_mul_f32 v[246:247], v[166:167], v[246:247]
  v_pk_fma_f32 v[72:73], v[72:73], v[26:27], v[26:27] op_sel:[0,1,1] op_sel_hi:[1,1,1]
  v_pk_fma_f32 v[74:75], v[74:75], v[26:27], v[26:27] op_sel:[0,1,1] op_sel_hi:[1,1,1]
  v_pk_fma_f32 v[76:77], v[76:77], v[26:27], v[26:27] op_sel:[0,1,1] op_sel_hi:[1,1,1]
  v_pk_fma_f32 v[78:79], v[78:79], v[26:27], v[26:27] op_sel:[0,1,1] op_sel_hi:[1,1,1]
  v_pk_fma_f32 v[80:81], v[80:81], v[26:27], v[26:27] op_sel:[0,1,1] op_sel_hi:[1,1,1]
  v_pk_fma_f32 v[82:83], v[82:83], v[26:27], v[26:27] op_sel:[0,1,1] op_sel_hi:[1,1,1]
  v_pk_fma_f32 v[84:85], v[84:85], v[26:27], v[26:27] op_sel:[0,1,1] op_sel_hi:[1,1,1]
  v_pk_fma_f32 v[86:87], v[86:87], v[26:27], v[26:27] op_sel:[0,1,1] op_sel_hi:[1,1,1]
  v_pk_fma_f32 v[88:89], v[88:89], v[26:27], v[26:27] op_sel:[0,1,1] op_sel_hi:[1,1,1]
  v_pk_fma_f32 v[90:91], v[90:91], v[26:27], v[26:27] op_sel:[0,1,1] op_sel_hi:[1,1,1]
  v_rcp_f32 v72, v72
  v_rcp_f32 v73, v73
  v_rcp_f32 v74, v74
  v_rcp_f32 v75, v75
  v_rcp_f32 v76, v76
  v_rcp_f32 v77, v77
  v_rcp_f32 v78, v78
  v_rcp_f32 v79, v79
  v_rcp_f32 v80, v80
  v_rcp_f32 v81, v81
  v_rcp_f32 v82, v82
  v_rcp_f32 v83, v83
  v_rcp_f32 v84, v84
  v_rcp_f32 v85, v85
  v_rcp_f32 v86, v86
  v_rcp_f32 v87, v87
  v_rcp_f32 v88, v88
  v_rcp_f32 v89, v89
  v_rcp_f32 v90, v90
  v_rcp_f32 v91, v91
  s_nop 0
  v_pk_mul_f32 v[180:181], v[180:181], v[72:73]
  v_pk_mul_f32 v[182:183], v[182:183], v[74:75]
  v_pk_mul_f32 v[196:197], v[196:197], v[76:77]
  v_pk_mul_f32 v[198:199], v[198:199], v[78:79]
  v_pk_mul_f32 v[212:213], v[212:213], v[80:81]
  v_pk_mul_f32 v[214:215], v[214:215], v[82:83]
  v_pk_mul_f32 v[228:229], v[228:229], v[84:85]
  v_pk_mul_f32 v[230:231], v[230:231], v[86:87]
  v_pk_mul_f32 v[244:245], v[244:245], v[88:89]
  v_pk_mul_f32 v[246:247], v[246:247], v[90:91]
  v_cvt_pk_bf16_f32 v100, v180, v181
  v_cvt_pk_bf16_f32 v101, v182, v183
  v_cvt_pk_bf16_f32 v102, v196, v197
  v_cvt_pk_bf16_f32 v103, v198, v199
  v_cvt_pk_bf16_f32 v132, v212, v213
  v_cvt_pk_bf16_f32 v133, v214, v215
  v_cvt_pk_bf16_f32 v134, v228, v229
  v_cvt_pk_bf16_f32 v135, v230, v231
  v_cvt_pk_bf16_f32 v164, v244, v245
  v_cvt_pk_bf16_f32 v165, v246, v247
  s_cbranch_execz L_dry_ret
  v_add_u32 v11, 49152, v11
  s_cmp_eq_u32 s30, 19
  s_cbranch_scc1 L_gu_skip1
  buffer_store_dwordx4 v[100:103], v11, s[20:23], s61 offen sc1
  buffer_store_dwordx4 v[132:135], v11, s[20:23], s61 offen offset:1024 sc1
L_gu_skip1:
  buffer_store_dwordx2 v[164:165], v11, s[20:23], s62 offen sc1
  s_nop 1
L_gu_b2:
  v_pk_fma_f32 v[104:105], v[32:33], v[20:21], v[104:105] op_sel_hi:[1,0,1] neg_lo:[0,1,0] neg_hi:[0,1,0]
  v_pk_fma_f32 v[184:185], v[52:53], v[20:21], v[184:185] op_sel_hi:[1,0,1] neg_lo:[0,1,0] neg_hi:[0,1,0]
  v_pk_fma_f32 v[106:107], v[34:35], v[20:21], v[106:107] op_sel_hi:[1,0,1] neg_lo:[0,1,0] neg_hi:[0,1,0]
  v_pk_fma_f32 v[186:187], v[54:55], v[20:21], v[186:187] op_sel_hi:[1,0,1] neg_lo:[0,1,0] neg_hi:[0,1,0]
  v_pk_fma_f32 v[120:121], v[36:37], v[20:21], v[120:121] op_sel_hi:[1,0,1] neg_lo:[0,1,0] neg_hi:[0,1,0]
  v_pk_fma_f32 v[200:201], v[56:57], v[20:21], v[200:201] op_sel_hi:[1,0,1] neg_lo:[0,1,0] neg_hi:[0,1,0]
  v_pk_fma_f32 v[122:123], v[38:39], v[20:21], v[122:123] op_sel_hi:[1,0,1] neg_lo:[0,1,0] neg_hi:[0,1,0]
  v_pk_fma_f32 v[202:203], v[58:59], v[20:21], v[202:203] op_sel_hi:[1,0,1] neg_lo:[0,1,0] neg_hi:[0,1,0]
  v_pk_fma_f32 v[136:137], v[40:41], v[20:21], v[136:137] op_sel_hi:[1,0,1] neg_lo:[0,1,0] neg_hi:[0,1,0]
  v_pk_fma_f32 v[216:217], v[60:61], v[20:21], v[216:217] op_sel_hi:[1,0,1] neg_lo:[0,1,0] neg_hi:[0,1,0]
  v_pk_fma_f32 v[138:139], v[42:43], v[20:21], v[138:139] op_sel_hi:[1,0,1] neg_lo:[0,1,0] neg_hi:[0,1,0]
  v_pk_fma_f32 v[218:219], v[62:63], v[20:21], v[218:219] op_sel_hi:[1,0,1] neg_lo:[0,1,0] neg_hi:[0,1,0]
  v_pk_fma_f32 v[152:153], v[44:45], v[20:21], v[152:153] op_sel_hi:[1,0,1] neg_lo:[0,1,0] neg_hi:[0,1,0]
  v_pk_fma_f32 v[232:233], v[64:65], v[20:21], v[232:233] op_sel_hi:[1,0,1] neg_lo:[0,1,0] neg_hi:[0,1,0]
  v_pk_fma_f32 v[154:155], v[46:47], v[20:21], v[154:155] op_sel_hi:[1,0,1] neg_lo:[0,1,0] neg_hi:[0,1,0]
  v_pk_fma_f32 v[234:235], v[66:67], v[20:21], v[234:235] op_sel_hi:[1,0,1] neg_lo:[0,1,0] neg_hi:[0,1,0]
  v_pk_fma_f32 v[168:169], v[48:49], v[20:21], v[168:169] op_sel_hi:[1,0,1] neg_lo:[0,1,0] neg_hi:[0,1,0]
  v_pk_fma_f32 v[248:249], v[68:69], v[20:21], v[248:249] op_sel_hi:[1,0,1] neg_lo:[0,1,0] neg_hi:[0,1,0]
  v_pk_fma_f32 v[170:171], v[50:51], v[20:21], v[170:171] op_sel_hi:[1,0,1] neg_lo:[0,1,0] neg_hi:[0,1,0]
  v_pk_fma_f32 v[250:251], v[70:71], v[20:21], v[250:251] op_sel_hi:[1,0,1] neg_lo:[0,1,0] neg_hi:[0,1,0]
  v_pk_mul_f32 v[72:73], v[104:105], v[28:29] op_sel_hi:[1,0]
  v_pk_mul_f32 v[74:75], v[106:107], v[28:29] op_sel_hi:[1,0]
  v_pk_mul_f32 v[76:77], v[120:121], v[28:29] op_sel_hi:[1,0]
  v_pk_mul_f32 v[78:79], v[122:123], v[28:29] op_sel_hi:[1,0]
  v_pk_mul_f32 v[80:81], v[136:137], v[28:29] op_sel_hi:[1,0]
  v_pk_mul_f32 v[82:83], v[138:139], v[28:29] op_sel_hi:[1,0]
  v_pk_mul_f32 v[84:85], v[152:153], v[28:29] op_sel_hi:[1,0]
  v_pk_mul_f32 v[86:87], v[154:155], v[28:29] op_sel_hi:[1,0]
  v_pk_mul_f32 v[88:89], v[168:169], v[28:29] op_sel_hi:[1,0]
  v_pk_mul_f32 v[90:91], v[170:171], v[28:29] op_sel_hi:[1,0]
  v_exp_f32 v72, v72
  v_exp_f32 v73, v73
  v_exp_f32 v74, v74
  v_exp_f32 v75, v75
  v_exp_f32 v76, v76
  v_exp_f32 v77, v77
  v_exp_f32 v78, v78
  v_exp_f32 v79, v79
  v_exp_f32 v80, v80
  v_exp_f32 v81, v81
  v_exp_f32 v82, v82
  v_exp_f32 v83, v83
  v_exp_f32 v84, v84
  v_exp_f32 v85, v85
  v_exp_f32 v86, v86
  v_exp_f32 v87, v87
  v_exp_f32 v88, v88
  v_exp_f32 v89, v89
  v_exp_f32 v90, v90
  v_exp_f32 v91, v91
  v_pk_mul_f32 v[184:185], v[104:105], v[184:185]
  v_pk_mul_f32 v[186:187], v[106:107], v[186:187]
  v_pk_mul_f32 v[200:201], v[120:121], v[200:201]
  v_pk_mul_f32 v[202:203], v[122:123], v[202:203]
  v_pk_mul_f32 v[216:217], v[136:137], v[216:217]
  v_pk_mul_f32 v[218:219], v[138:139], v[218:219]
  v_pk_mul_f32 v[232:233], v[152:153], v[232:233]
  v_pk_mul_f32 v[234:235], v[154:155], v[234:235]
  v_pk_mul_f32 v[248:249], v[168:169], v[248:249]
  v_pk_mul_f32 v[250:251], v[170:171], v[250:251]
  v_pk_fma_f32 v[72:73], v[72:73], v[28:29], v[28:29] op_sel:[0,1,1] op_sel_hi:[1,1,1]
  v_pk_fma_f32 v[74:75], v[74:75], v[28:29], v[28:29] op_sel:[0,1,1] op_sel_hi:[1,1,1]
  v_pk_fma_f32 v[76:77], v[76:77], v[28:29], v[28:29] op_sel:[0,1,1] op_sel_hi:[1,1,1]
  v_pk_fma_f32 v[78:79], v[78:79], v[28:29], v[28:29] op_sel:[0,1,1] op_sel_hi:[1,1,1]
  v_pk_fma_f32 v[80:81], v[80:81], v[28:29], v[28:29] op_sel:[0,1,1] op_sel_hi:[1,1,1]
  v_pk_fma_f32 v[82:83], v[82:83], v[28:29], v[28:29] op_sel:[0,1,1] op_sel_hi:[1,1,1]
  v_pk_fma_f32 v[84:85], v[84:85], v[28:29], v[28:29] op_sel:[0,1,1] op_sel_hi:[1,1,1]
  v_pk_fma_f32 v[86:87], v[86:87], v[28:29], v[28:29] op_sel:[0,1,1] op_sel_hi:[1,1,1]
  v_pk_fma_f32 v[88:89], v[88:89], v[28:29], v[28:29] op_sel:[0,1,1] op_sel_hi:[1,1,1]
  v_pk_fma_f32 v[90:91], v[90:91], v[28:29], v[28:29] op_sel:[0,1,1] op_sel_hi:[1,1,1]
  v_rcp_f32 v72, v72
  v_rcp_f32 v73, v73
  v_rcp_f32 v74, v74
  v_rcp_f32 v75, v75
  v_rcp_f32 v76, v76
  v_rcp_f32 v77, v77
  v_rcp_f32 v78, v78
  v_rcp_f32 v79, v79
  v_rcp_f32 v80, v80
  v_rcp_f32 v81, v81
  v_rcp_f32 v82, v82
  v_rcp_f32 v83, v83
  v_rcp_f32 v84, v84
  v_rcp_f32 v85, v85
  v_rcp_f32 v86, v86
  v_rcp_f32 v87, v87
  v_rcp_f32 v88, v88
  v_rcp_f32 v89, v89
  v_rcp_f32 v90, v90
  v_rcp_f32 v91, v91
  s_nop 0
  v_pk_mul_f32 v[184:185], v[184:185], v[72:73]
  v_pk_mul_f32 v[186:187], v[186:187], v[74:75]
  v_pk_mul_f32 v[200:201], v[200:201], v[76:77]
  v_pk_mul_f32 v[202:203], v[202:203], v[78:79]
  v_pk_mul_f32 v[216:217], v[216:217], v[80:81]
  v_pk_mul_f32 v[218:219], v[218:219], v[82:83]
  v_pk_mul_f32 v[232:233], v[232:233], v[84:85]
  v_pk_mul_f32 v[234:235], v[234:235], v[86:87]
  v_pk_mul_f32 v[248:249], v[248:249], v[88:89]
  v_pk_mul_f32 v[250:251], v[250:251], v[90:91]
  v_cvt_pk_bf16_f32 v104, v184, v185
  v_cvt_pk_bf16_f32 v105, v186, v187
  v_cvt_pk_bf16_f32 v106, v200, v201
  v_cvt_pk_bf16_f32 v107, v202, v203
  v_cvt_pk_bf16_f32 v136, v216, v217
  v_cvt_pk_bf16_f32 v137, v218, v219
  v_cvt_pk_bf16_f32 v138, v232, v233
  v_cvt_pk_bf16_f32 v139, v234, v235
  v_cvt_pk_bf16_f32 v168, v248, v249
  v_cvt_pk_bf16_f32 v169, v250, v251
  s_cbranch_execz L_dry_ret
  v_add_u32 v11, 49152, v11
  s_cmp_eq_u32 s30, 19
  s_cbranch_scc1 L_gu_skip2
  buffer_store_dwordx4 v[104:107], v11, s[20:23], s61 offen sc1
  buffer_store_dwordx4 v[136:139], v11, s[20:23], s61 offen offset:1024 sc1
L_gu_skip2:
  buffer_store_dwordx2 v[168:169], v11, s[20:23], s62 offen sc1
  s_nop 1
L_gu_b3:
  v_pk_fma_f32 v[108:109], v[32:33], v[22:23], v[108:109] op_sel_hi:[1,0,1] neg_lo:[0,1,0] neg_hi:[0,1,0]
  v_pk_fma_f32 v[188:189], v[52:53], v[22:23], v[188:189] op_sel_hi:[1,0,1] neg_lo:[0,1,0] neg_hi:[0,1,0]
  v_pk_fma_f32 v[110:111], v[34:35], v[22:23], v[110:111] op_sel_hi:[1,0,1] neg_lo:[0,1,0] neg_hi:[0,1,0]
  v_pk_fma_f32 v[190:191], v[54:55], v[22:23], v[190:191] op_sel_hi:[1,0,1] neg_lo:[0,1,0] neg_hi:[0,1,0]
  v_pk_fma_f32 v[124:125], v[36:37], v[22:23], v[124:125] op_sel_hi:[1,0,1] neg_lo:[0,1,0] neg_hi:[0,1,0]
  v_pk_fma_f32 v[204:205], v[56:57], v[22:23], v[204:205] op_sel_hi:[1,0,1] neg_lo:[0,1,0] neg_hi:[0,1,0]
  v_pk_fma_f32 v[126:127], v[38:39], v[22:23], v[126:127] op_sel_hi:[1,0,1] neg_lo:[0,1,0] neg_hi:[0,1,0]
  v_pk_fma_f32 v[206:207], v[58:59], v[22:23], v[206:207] op_sel_hi:[1,0,1] neg_lo:[0,1,0] neg_hi:[0,1,0]
  v_pk_fma_f32 v[140:141], v[40:41], v[22:23], v[140:141] op_sel_hi:[1,0,1] neg_lo:[0,1,0] neg_hi:[0,1,0]
  v_pk_fma_f32 v[220:221], v[60:61], v[22:23], v[220:221] op_sel_hi:[1,0,1] neg_lo:[0,1,0] neg_hi:[0,1,0]
  v_pk_fma_f32 v[142:143], v[42:43], v[22:23], v[142:143] op_sel_hi:[1,0,1] neg_lo:[0,1,0] neg_hi:[0,1,0]
  v_pk_fma_f32 v[222:223], v[62:63], v[22:23], v[222:223] op_sel_hi:[1,0,1] neg_lo:[0,1,0] neg_hi:[0,1,0]
  v_pk_fma_f32 v[156:157], v[44:45], v[22:23], v[156:157] op_sel_hi:[1,0,1] neg_lo:[0,1,0] neg_hi:[0,1,0]
  v_pk_fma_f32 v[236:237], v[64:65], v[22:23], v[236:237] op_sel_hi:[1,0,1] neg_lo:[0,1,0] neg_hi:[0,1,0]
  v_pk_fma_f32 v[158:159], v[46:47], v[22:23], v[158:159] op_sel_hi:[1,0,1] neg_lo:[0,1,0] neg_hi:[0,1,0]
  v_pk_fma_f32 v[238:239], v[66:67], v[22:23], v[238:239] op_sel_hi:[1,0,1] neg_lo:[0,1,0] neg_hi:[0,1,0]
  v_pk_fma_f32 v[172:173], v[48:49], v[22:23], v[172:173] op_sel_hi:[1,0,1] neg_lo:[0,1,0] neg_hi:[0,1,0]
  v_pk_fma_f32 v[252:253], v[68:69], v[22:23], v[252:253] op_sel_hi:[1,0,1] neg_lo:[0,1,0] neg_hi:[0,1,0]
  v_pk_fma_f32 v[174:175], v[50:51], v[22:23], v[174:175] op_sel_hi:[1,0,1] neg_lo:[0,1,0] neg_hi:[0,1,0]
  v_pk_fma_f32 v[254:255], v[70:71], v[22:23], v[254:255] op_sel_hi:[1,0,1] neg_lo:[0,1,0] neg_hi:[0,1,0]
  v_pk_mul_f32 v[72:73], v[108:109], v[30:31] op_sel_hi:[1,0]
  v_pk_mul_f32 v[74:75], v[110:111], v[30:31] op_sel_hi:[1,0]
  v_pk_mul_f32 v[76:77], v[124:125], v[30:31] op_sel_hi:[1,0]
  v_pk_mul_f32 v[78:79], v[126:127], v[30:31] op_sel_hi:[1,0]
  v_pk_mul_f32 v[80:81], v[140:141], v[30:31] op_sel_hi:[1,0]
  v_pk_mul_f32 v[82:83], v[142:143], v[30:31] op_sel_hi:[1,0]
  v_pk_mul_f32 v[84:85], v[156:157], v[30:31] op_sel_hi:[1,0]
  v_pk_mul_f32 v[86:87], v[158:159], v[30:31] op_sel_hi:[1,0]
  v_pk_mul_f32 v[88:89], v[172:173], v[30:31] op_sel_hi:[1,0]
  v_pk_mul_f32 v[90:91], v[174:175], v[30:31] op_sel_hi:[1,0]
  v_exp_f32 v72, v72
  v_exp_f32 v73, v73
  v_exp_f32 v74, v74
  v_exp_f32 v75, v75
  v_exp_f32 v76, v76
  v_exp_f32 v77, v77
  v_exp_f32 v78, v78
  v_exp_f32 v79, v79
  v_exp_f32 v80, v80
  v_exp_f32 v81, v81
  v_exp_f32 v82, v82
  v_exp_f32 v83, v83
  v_exp_f32 v84, v84
  v_exp_f32 v85, v85
  v_exp_f32 v86, v86
  v_exp_f32 v87, v87
  v_exp_f32 v88, v88
  v_exp_f32 v89, v89
  v_exp_f32 v90, v90
  v_exp_f32 v91, v91
  v_pk_mul_f32 v[188:189], v[108:109], v[188:189]
  v_pk_mul_f32 v[190:191], v[110:111], v[190:191]
  v_pk_mul_f32 v[204:205], v[124:125], v[204:205]
  v_pk_mul_f32 v[206:207], v[126:127], v[206:207]
  v_pk_mul_f32 v[220:221], v[140:141], v[220:221]
  v_pk_mul_f32 v[222:223], v[142:143], v[222:223]
  v_pk_mul_f32 v[236:237], v[156:157], v[236:237]
  v_pk_mul_f32 v[238:239], v[158:159], v[238:239]
  v_pk_mul_f32 v[252:253], v[172:173], v[252:253]
  v_pk_mul_f32 v[254:255], v[174:175], v[254:255]
  v_pk_fma_f32 v[72:73], v[72:73], v[30:31], v[30:31] op_sel:[0,1,1] op_sel_hi:[1,1,1]
  v_pk_fma_f32 v[74:75], v[74:75], v[30:31], v[30:31] op_sel:[0,1,1] op_sel_hi:[1,1,1]
  v_pk_fma_f32 v[76:77], v[76:77], v[30:31], v[30:31] op_sel:[0,1,1] op_sel_hi:[1,1,1]
  v_pk_fma_f32 v[78:79], v[78:79], v[30:31], v[30:31] op_sel:[0,1,1] op_sel_hi:[1,1,1]
  v_pk_fma_f32 v[80:81], v[80:81], v[30:31], v[30:31] op_sel:[0,1,1] op_sel_hi:[1,1,1]
  v_pk_fma_f32 v[82:83], v[82:83], v[30:31], v[30:31] op_sel:[0,1,1] op_sel_hi:[1,1,1]
  v_pk_fma_f32 v[84:85], v[84:85], v[30:31], v[30:31] op_sel:[0,1,1] op_sel_hi:[1,1,1]
  v_pk_fma_f32 v[86:87], v[86:87], v[30:31], v[30:31] op_sel:[0,1,1] op_sel_hi:[1,1,1]
  v_pk_fma_f32 v[88:89], v[88:89], v[30:31], v[30:31] op_sel:[0,1,1] op_sel_hi:[1,1,1]
  v_pk_fma_f32 v[90:91], v[90:91], v[30:31], v[30:31] op_sel:[0,1,1] op_sel_hi:[1,1,1]
  v_rcp_f32 v72, v72
  v_rcp_f32 v73, v73
  v_rcp_f32 v74, v74
  v_rcp_f32 v75, v75
  v_rcp_f32 v76, v76
  v_rcp_f32 v77, v77
  v_rcp_f32 v78, v78
  v_rcp_f32 v79, v79
  v_rcp_f32 v80, v80
  v_rcp_f32 v81, v81
  v_rcp_f32 v82, v82
  v_rcp_f32 v83, v83
  v_rcp_f32 v84, v84
  v_rcp_f32 v85, v85
  v_rcp_f32 v86, v86
  v_rcp_f32 v87, v87
  v_rcp_f32 v88, v88
  v_rcp_f32 v89, v89
  v_rcp_f32 v90, v90
  v_rcp_f32 v91, v91
  s_nop 0
  v_pk_mul_f32 v[188:189], v[188:189], v[72:73]
  v_pk_mul_f32 v[190:191], v[190:191], v[74:75]
  v_pk_mul_f32 v[204:205], v[204:205], v[76:77]
  v_pk_mul_f32 v[206:207], v[206:207], v[78:79]
  v_pk_mul_f32 v[220:221], v[220:221], v[80:81]
  v_pk_mul_f32 v[222:223], v[222:223], v[82:83]
  v_pk_mul_f32 v[236:237], v[236:237], v[84:85]
  v_pk_mul_f32 v[238:239], v[238:239], v[86:87]
  v_pk_mul_f32 v[252:253], v[252:253], v[88:89]
  v_pk_mul_f32 v[254:255], v[254:255], v[90:91]
  v_cvt_pk_bf16_f32 v108, v188, v189
  v_cvt_pk_bf16_f32 v109, v190, v191
  v_cvt_pk_bf16_f32 v110, v204, v205
  v_cvt_pk_bf16_f32 v111, v206, v207
  v_cvt_pk_bf16_f32 v140, v220, v221
  v_cvt_pk_bf16_f32 v141, v222, v223
  v_cvt_pk_bf16_f32 v142, v236, v237
  v_cvt_pk_bf16_f32 v143, v238, v239
  v_cvt_pk_bf16_f32 v172, v252, v253
  v_cvt_pk_bf16_f32 v173, v254, v255
  s_cbranch_execz L_dry_ret
  v_add_u32 v11, 49152, v11
  s_cmp_eq_u32 s30, 19
  s_cbranch_scc1 L_gu_skip3
  buffer_store_dwordx4 v[108:111], v11, s[20:23], s61 offen sc1
  buffer_store_dwordx4 v[140:143], v11, s[20:23], s61 offen offset:1024 sc1
L_gu_skip3:
  buffer_store_dwordx2 v[172:173], v11, s[20:23], s62 offen sc1
  s_nop 1
  s_endpgm
L_epi_q:
  s_lshl_b32 s37, s28, 9
  v_lshlrev_b32 v11, 3, v9
  v_add_u32 v11, s37, v11
  v_add_u32 v11, 159744, v11
  ds_read_b64 v[16:17], v11 offset:0
  ds_read_b64 v[18:19], v11 offset:128
  ds_read_b64 v[20:21], v11 offset:256
  ds_read_b64 v[22:23], v11 offset:384
  v_lshlrev_b32 v12, 4, v10
  v_add_u32 v12, 161792, v12
  ds_read_b128 v[32:35], v12 offset:0
  ds_read_b128 v[36:39], v12 offset:64
  ds_read_b128 v[40:43], v12 offset:128
  ds_read_b128 v[44:47], v12 offset:192
  ds_read_b128 v[48:51], v12 offset:256
  ds_read_b128 v[52:55], v12 offset:320
  ds_read_b128 v[56:59], v12 offset:384
  ds_read_b128 v[60:63], v12 offset:448
  ds_read_b128 v[64:67], v12 offset:512
  ds_read_b128 v[68:71], v12 offset:576
  s_waitcnt lgkmcnt(0)
  v_lshlrev_b32 v11, 4, v8
  s_mul_i32 s37, s28, 81920
  v_add_u32 v11, s37, v11
  s_mul_i32 s37, s26, 327680
  s_mul_i32 s38, s30, 5120
  s_add_u32 s61, s37, s38
  s_add_u32 s61, s61, 0
  s_add_u32 s62, s61, 4096
L_q_b0:
  v_pk_fma_f32 v[96:97], v[32:33], v[16:17], v[96:97] op_sel_hi:[1,0,1] neg_lo:[0,1,0] neg_hi:[0,1,0]
  v_pk_fma_f32 v[98:99], v[34:35], v[16:17], v[98:99] op_sel_hi:[1,0,1] neg_lo:[0,1,0] neg_hi:[0,1,0]
  v_pk_fma_f32 v[112:113], v[36:37], v[16:17], v[112:113] op_sel_hi:[1,0,1] neg_lo:[0,1,0] neg_hi:[0,1,0]
  v_pk_fma_f32 v[114:115], v[38:39], v[16:17], v[114:115] op_sel_hi:[1,0,1] neg_lo:[0,1,0] neg_hi:[0,1,0]
  v_pk_fma_f32 v[128:129], v[40:41], v[16:17], v[128:129] op_sel_hi:[1,0,1] neg_lo:[0,1,0] neg_hi:[0,1,0]
  v_pk_fma_f32 v[130:131], v[42:43], v[16:17], v[130:131] op_sel_hi:[1,0,1] neg_lo:[0,1,0] neg_hi:[0,1,0]
  v_pk_fma_f32 v[144:145], v[44:45], v[16:17], v[144:145] op_sel_hi:[1,0,1] neg_lo:[0,1,0] neg_hi:[0,1,0]
  v_pk_fma_f32 v[146:147], v[46:47], v[16:17], v[146:147] op_sel_hi:[1,0,1] neg_lo:[0,1,0] neg_hi:[0,1,0]
  v_pk_fma_f32 v[160:161], v[48:49], v[16:17], v[160:161] op_sel_hi:[1,0,1] neg_lo:[0,1,0] neg_hi:[0,1,0]
  v_pk_fma_f32 v[162:163], v[50:51], v[16:17], v[162:163] op_sel_hi:[1,0,1] neg_lo:[0,1,0] neg_hi:[0,1,0]
  v_pk_fma_f32 v[96:97], v[96:97], v[16:17], s[40:41] op_sel:[0,1,0] op_sel_hi:[1,1,1]
  v_pk_fma_f32 v[98:99], v[98:99], v[16:17], s[40:41] op_sel:[0,1,0] op_sel_hi:[1,1,1]
  v_pk_fma_f32 v[112:113], v[112:113], v[16:17], s[40:41] op_sel:[0,1,0] op_sel_hi:[1,1,1]
  v_pk_fma_f32 v[114:115], v[114:115], v[16:17], s[40:41] op_sel:[0,1,0] op_sel_hi:[1,1,1]
  v_pk_fma_f32 v[128:129], v[128:129], v[16:17], s[40:41] op_sel:[0,1,0] op_sel_hi:[1,1,1]
  v_pk_fma_f32 v[130:131], v[130:131], v[16:17], s[40:41] op_sel:[0,1,0] op_sel_hi:[1,1,1]
  v_pk_fma_f32 v[144:145], v[144:145], v[16:17], s[40:41] op_sel:[0,1,0] op_sel_hi:[1,1,1]
  v_pk_fma_f32 v[146:147], v[146:147], v[16:17], s[40:41] op_sel:[0,1,0] op_sel_hi:[1,1,1]
  v_pk_fma_f32 v[160:161], v[160:161], v[16:17], s[40:41] op_sel:[0,1,0] op_sel_hi:[1,1,1]
  v_pk_fma_f32 v[162:163], v[162:163], v[16:17], s[40:41] op_sel:[0,1,0] op_sel_hi:[1,1,1]
  v_pk_mul_f32 v[72:73], v[96:97], s[42:43]
  v_pk_mul_f32 v[74:75], v[98:99], s[42:43]
  v_pk_mul_f32 v[76:77], v[112:113], s[42:43]
  v_pk_mul_f32 v[78:79], v[114:115], s[42:43]
  v_pk_mul_f32 v[80:81], v[128:129], s[42:43]
  v_pk_mul_f32 v[82:83], v[130:131], s[42:43]
  v_pk_mul_f32 v[84:85], v[144:145], s[42:43]
  v_pk_mul_f32 v[86:87], v[146:147], s[42:43]
  v_pk_mul_f32 v[88:89], v[160:161], s[42:43]
  v_pk_mul_f32 v[90:91], v[162:163], s[42:43]
  v_exp_f32_e64 v72, v72 clamp
  v_exp_f32_e64 v73, v73 clamp
  v_exp_f32_e64 v74, v74 clamp
  v_exp_f32_e64 v75, v75 clamp
  v_exp_f32_e64 v76, v76 clamp
  v_exp_f32_e64 v77, v77 clamp
  v_exp_f32_e64 v78, v78 clamp
  v_exp_f32_e64 v79, v79 clamp
  v_exp_f32_e64 v80, v80 clamp
  v_exp_f32_e64 v81, v81 clamp
  v_exp_f32_e64 v82, v82 clamp
  v_exp_f32_e64 v83, v83 clamp
  v_exp_f32_e64 v84, v84 clamp
  v_exp_f32_e64 v85, v85 clamp
  v_exp_f32_e64 v86, v86 clamp
  v_exp_f32_e64 v87, v87 clamp
  v_exp_f32_e64 v88, v88 clamp
  v_exp_f32_e64 v89, v89 clamp
  v_exp_f32_e64 v90, v90 clamp
  v_exp_f32_e64 v91, v91 clamp
  v_max_f32 v96, s40, v96
  v_max_f32 v97, s40, v97
  v_max_f32 v98, s40, v98
  v_max_f32 v99, s40, v99
  v_max_f32 v112, s40, v112
  v_max_f32 v113, s40, v113
  v_max_f32 v114, s40, v114
  v_max_f32 v115, s40, v115
  v_max_f32 v128, s40, v128
  v_max_f32 v129, s40, v129
  v_max_f32 v130, s40, v130
  v_max_f32 v131, s40, v131
  v_max_f32 v144, s40, v144
  v_max_f32 v145, s40, v145
  v_max_f32 v146, s40, v146
  v_max_f32 v147, s40, v147
  v_max_f32 v160, s40, v160
  v_max_f32 v161, s40, v161
  v_max_f32 v162, s40, v162
  v_max_f32 v163, s40, v163
  v_pk_add_f32 v[96:97], v[96:97], v[72:73]
  v_pk_add_f32 v[98:99], v[98:99], v[74:75]
  v_pk_add_f32 v[112:113], v[112:113], v[76:77]
  v_pk_add_f32 v[114:115], v[114:115], v[78:79]
  v_pk_add_f32 v[128:129], v[128:129], v[80:81]
  v_pk_add_f32 v[130:131], v[130:131], v[82:83]
  v_pk_add_f32 v[144:145], v[144:145], v[84:85]
  v_pk_add_f32 v[146:147], v[146:147], v[86:87]
  v_pk_add_f32 v[160:161], v[160:161], v[88:89]
  v_pk_add_f32 v[162:163], v[162:163], v[90:91]
  v_pk_fma_f32 v[176:177], v[52:53], v[16:17], v[176:177] op_sel_hi:[1,0,1] neg_lo:[0,1,0] neg_hi:[0,1,0]
  v_pk_fma_f32 v[178:179], v[54:55], v[16:17], v[178:179] op_sel_hi:[1,0,1] neg_lo:[0,1,0] neg_hi:[0,1,0]
  v_pk_fma_f32 v[192:193], v[56:57], v[16:17], v[192:193] op_sel_hi:[1,0,1] neg_lo:[0,1,0] neg_hi:[0,1,0]
  v_pk_fma_f32 v[194:195], v[58:59], v[16:17], v[194:195] op_sel_hi:[1,0,1] neg_lo:[0,1,0] neg_hi:[0,1,0]
  v_pk_fma_f32 v[208:209], v[60:61], v[16:17], v[208:209] op_sel_hi:[1,0,1] neg_lo:[0,1,0] neg_hi:[0,1,0]
  v_pk_fma_f32 v[210:211], v[62:63], v[16:17], v[210:211] op_sel_hi:[1,0,1] neg_lo:[0,1,0] neg_hi:[0,1,0]
  v_pk_fma_f32 v[224:225], v[64:65], v[16:17], v[224:225] op_sel_hi:[1,0,1] neg_lo:[0,1,0] neg_hi:[0,1,0]
  v_pk_fma_f32 v[226:227], v[66:67], v[16:17], v[226:227] op_sel_hi:[1,0,1] neg_lo:[0,1,0] neg_hi:[0,1,0]
  v_pk_fma_f32 v[240:241], v[68:69], v[16:17], v[240:241] op_sel_hi:[1,0,1] neg_lo:[0,1,0] neg_hi:[0,1,0]
  v_pk_fma_f32 v[242:243], v[70:71], v[16:17], v[242:243] op_sel_hi:[1,0,1] neg_lo:[0,1,0] neg_hi:[0,1,0]
  v_pk_fma_f32 v[176:177], v[176:177], v[16:17], s[40:41] op_sel:[0,1,0] op_sel_hi:[1,1,1]
  v_pk_fma_f32 v[178:179], v[178:179], v[16:17], s[40:41] op_sel:[0,1,0] op_sel_hi:[1,1,1]
  v_pk_fma_f32 v[192:193], v[192:193], v[16:17], s[40:41] op_sel:[0,1,0] op_sel_hi:[1,1,1]
  v_pk_fma_f32 v[194:195], v[194:195], v[16:17], s[40:41] op_sel:[0,1,0] op_sel_hi:[1,1,1]
  v_pk_fma_f32 v[208:209], v[208:209], v[16:17], s[40:41] op_sel:[0,1,0] op_sel_hi:[1,1,1]
  v_pk_fma_f32 v[210:211], v[210:211], v[16:17], s[40:41] op_sel:[0,1,0] op_sel_hi:[1,1,1]
  v_pk_fma_f32 v[224:225], v[224:225], v[16:17], s[40:41] op_sel:[0,1,0] op_sel_hi:[1,1,1]
  v_pk_fma_f32 v[226:227], v[226:227], v[16:17], s[40:41] op_sel:[0,1,0] op_sel_hi:[1,1,1]
  v_pk_fma_f32 v[240:241], v[240:241], v[16:17], s[40:41] op_sel:[0,1,0] op_sel_hi:[1,1,1]
  v_pk_fma_f32 v[242:243], v[242:243], v[16:17], s[40:41] op_sel:[0,1,0] op_sel_hi:[1,1,1]
  v_pk_mul_f32 v[72:73], v[176:177], s[42:43]
  v_pk_mul_f32 v[74:75], v[178:179], s[42:43]
  v_pk_mul_f32 v[76:77], v[192:193], s[42:43]
  v_pk_mul_f32 v[78:79], v[194:195], s[42:43]
  v_pk_mul_f32 v[80:81], v[208:209], s[42:43]
  v_pk_mul_f32 v[82:83], v[210:211], s[42:43]
  v_pk_mul_f32 v[84:85], v[224:225], s[42:43]
  v_pk_mul_f32 v[86:87], v[226:227], s[42:43]
  v_pk_mul_f32 v[88:89], v[240:241], s[42:43]
  v_pk_mul_f32 v[90:91], v[242:243], s[42:43]
  v_exp_f32_e64 v72, v72 clamp
  v_exp_f32_e64 v73, v73 clamp
  v_exp_f32_e64 v74, v74 clamp
  v_exp_f32_e64 v75, v75 clamp
  v_exp_f32_e64 v76, v76 clamp
  v_exp_f32_e64 v77, v77 clamp
  v_exp_f32_e64 v78, v78 clamp
  v_exp_f32_e64 v79, v79 clamp
  v_exp_f32_e64 v80, v80 clamp
  v_exp_f32_e64 v81, v81 clamp
  v_exp_f32_e64 v82, v82 clamp
  v_exp_f32_e64 v83, v83 clamp
  v_exp_f32_e64 v84, v84 clamp
  v_exp_f32_e64 v85, v85 clamp
  v_exp_f32_e64 v86, v86 clamp
  v_exp_f32_e64 v87, v87 clamp
  v_exp_f32_e64 v88, v88 clamp
  v_exp_f32_e64 v89, v89 clamp
  v_exp_f32_e64 v90, v90 clamp
  v_exp_f32_e64 v91, v91 clamp
  v_max_f32 v176, s40, v176
  v_max_f32 v177, s40, v177
  v_max_f32 v178, s40, v178
  v_max_f32 v179, s40, v179
  v_max_f32 v192, s40, v192
  v_max_f32 v193, s40, v193
  v_max_f32 v194, s40, v194
  v_max_f32 v195, s40, v195
  v_max_f32 v208, s40, v208
  v_max_f32 v209, s40, v209
  v_max_f32 v210, s40, v210
  v_max_f32 v211, s40, v211
  v_max_f32 v224, s40, v224
  v_max_f32 v225, s40, v225
  v_max_f32 v226, s40, v226
  v_max_f32 v227, s40, v227
  v_max_f32 v240, s40, v240
  v_max_f32 v241, s40, v241
  v_max_f32 v242, s40, v242
  v_max_f32 v243, s40, v243
  v_pk_add_f32 v[176:177], v[176:177], v[72:73]
  v_pk_add_f32 v[178:179], v[178:179], v[74:75]
  v_pk_add_f32 v[192:193], v[192:193], v[76:77]
  v_pk_add_f32 v[194:195], v[194:195], v[78:79]
  v_pk_add_f32 v[208:209], v[208:209], v[80:81]
  v_pk_add_f32 v[210:211], v[210:211], v[82:83]
  v_pk_add_f32 v[224:225], v[224:225], v[84:85]
  v_pk_add_f32 v[226:227], v[226:227], v[86:87]
  v_pk_add_f32 v[240:241], v[240:241], v[88:89]
  v_pk_add_f32 v[242:243], v[242:243], v[90:91]
  v_cvt_pk_bf16_f32 v96, v96, v97
  v_cvt_pk_bf16_f32 v97, v98, v99
  v_cvt_pk_bf16_f32 v98, v112, v113
  v_cvt_pk_bf16_f32 v99, v114, v115
  v_cvt_pk_bf16_f32 v128, v128, v129
  v_cvt_pk_bf16_f32 v129, v130, v131
  v_cvt_pk_bf16_f32 v130, v144, v145
  v_cvt_pk_bf16_f32 v131, v146, v147
  v_cvt_pk_bf16_f32 v160, v160, v161
  v_cvt_pk_bf16_f32 v161, v162, v163
  v_cvt_pk_bf16_f32 v162, v176, v177
  v_cvt_pk_bf16_f32 v163, v178, v179
  v_cvt_pk_bf16_f32 v192, v192, v193
  v_cvt_pk_bf16_f32 v193, v194, v195
  v_cvt_pk_bf16_f32 v194, v208, v209
  v_cvt_pk_bf16_f32 v195, v210, v211
  v_cvt_pk_bf16_f32 v224, v224, v225
  v_cvt_pk_bf16_f32 v225, v226, v227
  v_cvt_pk_bf16_f32 v226, v240, v241
  v_cvt_pk_bf16_f32 v227, v242, v243
  s_cbranch_execz L_dry_ret
  buffer_store_dwordx4 v[96:99], v11, s[20:23], s61 offen offset:0 sc1
  buffer_store_dwordx4 v[128:131], v11, s[20:23], s61 offen offset:1024 sc1
  buffer_store_dwordx4 v[160:163], v11, s[20:23], s61 offen offset:2048 sc1
  buffer_store_dwordx4 v[192:195], v11, s[20:23], s61 offen offset:3072 sc1
  buffer_store_dwordx4 v[224:227], v11, s[20:23], s62 offen sc1
  s_nop 1
L_q_b1:
  v_pk_fma_f32 v[100:101], v[32:33], v[18:19], v[100:101] op_sel_hi:[1,0,1] neg_lo:[0,1,0] neg_hi:[0,1,0]
  v_pk_fma_f32 v[102:103], v[34:35], v[18:19], v[102:103] op_sel_hi:[1,0,1] neg_lo:[0,1,0] neg_hi:[0,1,0]
  v_pk_fma_f32 v[116:117], v[36:37], v[18:19], v[116:117] op_sel_hi:[1,0,1] neg_lo:[0,1,0] neg_hi:[0,1,0]
  v_pk_fma_f32 v[118:119], v[38:39], v[18:19], v[118:119] op_sel_hi:[1,0,1] neg_lo:[0,1,0] neg_hi:[0,1,0]
  v_pk_fma_f32 v[132:133], v[40:41], v[18:19], v[132:133] op_sel_hi:[1,0,1] neg_lo:[0,1,0] neg_hi:[0,1,0]
  v_pk_fma_f32 v[134:135], v[42:43], v[18:19], v[134:135] op_sel_hi:[1,0,1] neg_lo:[0,1,0] neg_hi:[0,1,0]
  v_pk_fma_f32 v[148:149], v[44:45], v[18:19], v[148:149] op_sel_hi:[1,0,1] neg_lo:[0,1,0] neg_hi:[0,1,0]
  v_pk_fma_f32 v[150:151], v[46:47], v[18:19], v[150:151] op_sel_hi:[1,0,1] neg_lo:[0,1,0] neg_hi:[0,1,0]
  v_pk_fma_f32 v[164:165], v[48:49], v[18:19], v[164:165] op_sel_hi:[1,0,1] neg_lo:[0,1,0] neg_hi:[0,1,0]
  v_pk_fma_f32 v[166:167], v[50:51], v[18:19], v[166:167] op_sel_hi:[1,0,1] neg_lo:[0,1,0] neg_hi:[0,1,0]
  v_pk_fma_f32 v[100:101], v[100:101], v[18:19], s[40:41] op_sel:[0,1,0] op_sel_hi:[1,1,1]
  v_pk_fma_f32 v[102:103], v[102:103], v[18:19], s[40:41] op_sel:[0,1,0] op_sel_hi:[1,1,1]
  v_pk_fma_f32 v[116:117], v[116:117], v[18:19], s[40:41] op_sel:[0,1,0] op_sel_hi:[1,1,1]
  v_pk_fma_f32 v[118:119], v[118:119], v[18:19], s[40:41] op_sel:[0,1,0] op_sel_hi:[1,1,1]
  v_pk_fma_f32 v[132:133], v[132:133], v[18:19], s[40:41] op_sel:[0,1,0] op_sel_hi:[1,1,1]
  v_pk_fma_f32 v[134:135], v[134:135], v[18:19], s[40:41] op_sel:[0,1,0] op_sel_hi:[1,1,1]
  v_pk_fma_f32 v[148:149], v[148:149], v[18:19], s[40:41] op_sel:[0,1,0] op_sel_hi:[1,1,1]
  v_pk_fma_f32 v[150:151], v[150:151], v[18:19], s[40:41] op_sel:[0,1,0] op_sel_hi:[1,1,1]
  v_pk_fma_f32 v[164:165], v[164:165], v[18:19], s[40:41] op_sel:[0,1,0] op_sel_hi:[1,1,1]
  v_pk_fma_f32 v[166:167], v[166:167], v[18:19], s[40:41] op_sel:[0,1,0] op_sel_hi:[1,1,1]
  v_pk_mul_f32 v[72:73], v[100:101], s[42:43]
  v_pk_mul_f32 v[74:75], v[102:103], s[42:43]
  v_pk_mul_f32 v[76:77], v[116:117], s[42:43]
  v_pk_mul_f32 v[78:79], v[118:119], s[42:43]
  v_pk_mul_f32 v[80:81], v[132:133], s[42:43]
  v_pk_mul_f32 v[82:83], v[134:135], s[42:43]
  v_pk_mul_f32 v[84:85], v[148:149], s[42:43]
  v_pk_mul_f32 v[86:87], v[150:151], s[42:43]
  v_pk_mul_f32 v[88:89], v[164:165], s[42:43]
  v_pk_mul_f32 v[90:91], v[166:167], s[42:43]
  v_exp_f32_e64 v72, v72 clamp
  v_exp_f32_e64 v73, v73 clamp
  v_exp_f32_e64 v74, v74 clamp
  v_exp_f32_e64 v75, v75 clamp
  v_exp_f32_e64 v76, v76 clamp
  v_exp_f32_e64 v77, v77 clamp
  v_exp_f32_e64 v78, v78 clamp
  v_exp_f32_e64 v79, v79 clamp
  v_exp_f32_e64 v80, v80 clamp
  v_exp_f32_e64 v81, v81 clamp
  v_exp_f32_e64 v82, v82 clamp
  v_exp_f32_e64 v83, v83 clamp
  v_exp_f32_e64 v84, v84 clamp
  v_exp_f32_e64 v85, v85 clamp
  v_exp_f32_e64 v86, v86 clamp
  v_exp_f32_e64 v87, v87 clamp
  v_exp_f32_e64 v88, v88 clamp
  v_exp_f32_e64 v89, v89 clamp
  v_exp_f32_e64 v90, v90 clamp
  v_exp_f32_e64 v91, v91 clamp
  v_max_f32 v100, s40, v100
  v_max_f32 v101, s40, v101
  v_max_f32 v102, s40, v102
  v_max_f32 v103, s40, v103
  v_max_f32 v116, s40, v116
  v_max_f32 v117, s40, v117
  v_max_f32 v118, s40, v118
  v_max_f32 v119, s40, v119
  v_max_f32 v132, s40, v132
  v_max_f32 v133, s40, v133
  v_max_f32 v134, s40, v134
  v_max_f32 v135, s40, v135
  v_max_f32 v148, s40, v148
  v_max_f32 v149, s40, v149
  v_max_f32 v150, s40, v150
  v_max_f32 v151, s40, v151
  v_max_f32 v164, s40, v164
  v_max_f32 v165, s40, v165
  v_max_f32 v166, s40, v166
  v_max_f32 v167, s40, v167
  v_pk_add_f32 v[100:101], v[100:101], v[72:73]
  v_pk_add_f32 v[102:103], v[102:103], v[74:75]
  v_pk_add_f32 v[116:117], v[116:117], v[76:77]
  v_pk_add_f32 v[118:119], v[118:119], v[78:79]
  v_pk_add_f32 v[132:133], v[132:133], v[80:81]
  v_pk_add_f32 v[134:135], v[134:135], v[82:83]
  v_pk_add_f32 v[148:149], v[148:149], v[84:85]
  v_pk_add_f32 v[150:151], v[150:151], v[86:87]
  v_pk_add_f32 v[164:165], v[164:165], v[88:89]
  v_pk_add_f32 v[166:167], v[166:167], v[90:91]
  v_pk_fma_f32 v[180:181], v[52:53], v[18:19], v[180:181] op_sel_hi:[1,0,1] neg_lo:[0,1,0] neg_hi:[0,1,0]
  v_pk_fma_f32 v[182:183], v[54:55], v[18:19], v[182:183] op_sel_hi:[1,0,1] neg_lo:[0,1,0] neg_hi:[0,1,0]
  v_pk_fma_f32 v[196:197], v[56:57], v[18:19], v[196:197] op_sel_hi:[1,0,1] neg_lo:[0,1,0] neg_hi:[0,1,0]
  v_pk_fma_f32 v[198:199], v[58:59], v[18:19], v[198:199] op_sel_hi:[1,0,1] neg_lo:[0,1,0] neg_hi:[0,1,0]
  v_pk_fma_f32 v[212:213], v[60:61], v[18:19], v[212:213] op_sel_hi:[1,0,1] neg_lo:[0,1,0] neg_hi:[0,1,0]
  v_pk_fma_f32 v[214:215], v[62:63], v[18:19], v[214:215] op_sel_hi:[1,0,1] neg_lo:[0,1,0] neg_hi:[0,1,0]
  v_pk_fma_f32 v[228:229], v[64:65], v[18:19], v[228:229] op_sel_hi:[1,0,1] neg_lo:[0,1,0] neg_hi:[0,1,0]
  v_pk_fma_f32 v[230:231], v[66:67], v[18:19], v[230:231] op_sel_hi:[1,0,1] neg_lo:[0,1,0] neg_hi:[0,1,0]
  v_pk_fma_f32 v[244:245], v[68:69], v[18:19], v[244:245] op_sel_hi:[1,0,1] neg_lo:[0,1,0] neg_hi:[0,1,0]
  v_pk_fma_f32 v[246:247], v[70:71], v[18:19], v[246:247] op_sel_hi:[1,0,1] neg_lo:[0,1,0] neg_hi:[0,1,0]
  v_pk_fma_f32 v[180:181], v[180:181], v[18:19], s[40:41] op_sel:[0,1,0] op_sel_hi:[1,1,1]
  v_pk_fma_f32 v[182:183], v[182:183], v[18:19], s[40:41] op_sel:[0,1,0] op_sel_hi:[1,1,1]
  v_pk_fma_f32 v[196:197], v[196:197], v[18:19], s[40:41] op_sel:[0,1,0] op_sel_hi:[1,1,1]
  v_pk_fma_f32 v[198:199], v[198:199], v[18:19], s[40:41] op_sel:[0,1,0] op_sel_hi:[1,1,1]
  v_pk_fma_f32 v[212:213], v[212:213], v[18:19], s[40:41] op_sel:[0,1,0] op_sel_hi:[1,1,1]
  v_pk_fma_f32 v[214:215], v[214:215], v[18:19], s[40:41] op_sel:[0,1,0] op_sel_hi:[1,1,1]
  v_pk_fma_f32 v[228:229], v[228:229], v[18:19], s[40:41] op_sel:[0,1,0] op_sel_hi:[1,1,1]
  v_pk_fma_f32 v[230:231], v[230:231], v[18:19], s[40:41] op_sel:[0,1,0] op_sel_hi:[1,1,1]
  v_pk_fma_f32 v[244:245], v[244:245], v[18:19], s[40:41] op_sel:[0,1,0] op_sel_hi:[1,1,1]
  v_pk_fma_f32 v[246:247], v[246:247], v[18:19], s[40:41] op_sel:[0,1,0] op_sel_hi:[1,1,1]
  v_pk_mul_f32 v[72:73], v[180:181], s[42:43]
  v_pk_mul_f32 v[74:75], v[182:183], s[42:43]
  v_pk_mul_f32 v[76:77], v[196:197], s[42:43]
  v_pk_mul_f32 v[78:79], v[198:199], s[42:43]
  v_pk_mul_f32 v[80:81], v[212:213], s[42:43]
  v_pk_mul_f32 v[82:83], v[214:215], s[42:43]
  v_pk_mul_f32 v[84:85], v[228:229], s[42:43]
  v_pk_mul_f32 v[86:87], v[230:231], s[42:43]
  v_pk_mul_f32 v[88:89], v[244:245], s[42:43]
  v_pk_mul_f32 v[90:91], v[246:247], s[42:43]
  v_exp_f32_e64 v72, v72 clamp
  v_exp_f32_e64 v73, v73 clamp
  v_exp_f32_e64 v74, v74 clamp
  v_exp_f32_e64 v75, v75 clamp
  v_exp_f32_e64 v76, v76 clamp
  v_exp_f32_e64 v77, v77 clamp
  v_exp_f32_e64 v78, v78 clamp
  v_exp_f32_e64 v79, v79 clamp
  v_exp_f32_e64 v80, v80 clamp
  v_exp_f32_e64 v81, v81 clamp
  v_exp_f32_e64 v82, v82 clamp
  v_exp_f32_e64 v83, v83 clamp
  v_exp_f32_e64 v84, v84 clamp
  v_exp_f32_e64 v85, v85 clamp
  v_exp_f32_e64 v86, v86 clamp
  v_exp_f32_e64 v87, v87 clamp
  v_exp_f32_e64 v88, v88 clamp
  v_exp_f32_e64 v89, v89 clamp
  v_exp_f32_e64 v90, v90 clamp
  v_exp_f32_e64 v91, v91 clamp
  v_max_f32 v180, s40, v180
  v_max_f32 v181, s40, v181
  v_max_f32 v182, s40, v182
  v_max_f32 v183, s40, v183
  v_max_f32 v196, s40, v196
  v_max_f32 v197, s40, v197
  v_max_f32 v198, s40, v198
  v_max_f32 v199, s40, v199
  v_max_f32 v212, s40, v212
  v_max_f32 v213, s40, v213
  v_max_f32 v214, s40, v214
  v_max_f32 v215, s40, v215
  v_max_f32 v228, s40, v228
  v_max_f32 v229, s40, v229
  v_max_f32 v230, s40, v230
  v_max_f32 v231, s40, v231
  v_max_f32 v244, s40, v244
  v_max_f32 v245, s40, v245
  v_max_f32 v246, s40, v246
  v_max_f32 v247, s40, v247
  v_pk_add_f32 v[180:181], v[180:181], v[72:73]
  v_pk_add_f32 v[182:183], v[182:183], v[74:75]
  v_pk_add_f32 v[196:197], v[196:197], v[76:77]
  v_pk_add_f32 v[198:199], v[198:199], v[78:79]
  v_pk_add_f32 v[212:213], v[212:213], v[80:81]
  v_pk_add_f32 v[214:215], v[214:215], v[82:83]
  v_pk_add_f32 v[228:229], v[228:229], v[84:85]
  v_pk_add_f32 v[230:231], v[230:231], v[86:87]
  v_pk_add_f32 v[244:245], v[244:245], v[88:89]
  v_pk_add_f32 v[246:247], v[246:247], v[90:91]
  v_cvt_pk_bf16_f32 v100, v100, v101
  v_cvt_pk_bf16_f32 v101, v102, v103
  v_cvt_pk_bf16_f32 v102, v116, v117
  v_cvt_pk_bf16_f32 v103, v118, v119
  v_cvt_pk_bf16_f32 v132, v132, v133
  v_cvt_pk_bf16_f32 v133, v134, v135
  v_cvt_pk_bf16_f32 v134, v148, v149
  v_cvt_pk_bf16_f32 v135, v150, v151
  v_cvt_pk_bf16_f32 v164, v164, v165
  v_cvt_pk_bf16_f32 v165, v166, v167
  v_cvt_pk_bf16_f32 v166, v180, v181
  v_cvt_pk_bf16_f32 v167, v182, v183
  v_cvt_pk_bf16_f32 v196, v196, v197
  v_cvt_pk_bf16_f32 v197, v198, v199
  v_cvt_pk_bf16_f32 v198, v212, v213
  v_cvt_pk_bf16_f32 v199, v214, v215
  v_cvt_pk_bf16_f32 v228, v228, v229
  v_cvt_pk_bf16_f32 v229, v230, v231
  v_cvt_pk_bf16_f32 v230, v244, v245
  v_cvt_pk_bf16_f32 v231, v246, v247
  s_cbranch_execz L_dry_ret
  v_add_u32 v11, 20480, v11
  buffer_store_dwordx4 v[100:103], v11, s[20:23], s61 offen offset:0 sc1
  buffer_store_dwordx4 v[132:135], v11, s[20:23], s61 offen offset:1024 sc1
  buffer_store_dwordx4 v[164:167], v11, s[20:23], s61 offen offset:2048 sc1
  buffer_store_dwordx4 v[196:199], v11, s[20:23], s61 offen offset:3072 sc1
  buffer_store_dwordx4 v[228:231], v11, s[20:23], s62 offen sc1
  s_nop 1
L_q_b2:
  v_pk_fma_f32 v[104:105], v[32:33], v[20:21], v[104:105] op_sel_hi:[1,0,1] neg_lo:[0,1,0] neg_hi:[0,1,0]
  v_pk_fma_f32 v[106:107], v[34:35], v[20:21], v[106:107] op_sel_hi:[1,0,1] neg_lo:[0,1,0] neg_hi:[0,1,0]
  v_pk_fma_f32 v[120:121], v[36:37], v[20:21], v[120:121] op_sel_hi:[1,0,1] neg_lo:[0,1,0] neg_hi:[0,1,0]
  v_pk_fma_f32 v[122:123], v[38:39], v[20:21], v[122:123] op_sel_hi:[1,0,1] neg_lo:[0,1,0] neg_hi:[0,1,0]
  v_pk_fma_f32 v[136:137], v[40:41], v[20:21], v[136:137] op_sel_hi:[1,0,1] neg_lo:[0,1,0] neg_hi:[0,1,0]
  v_pk_fma_f32 v[138:139], v[42:43], v[20:21], v[138:139] op_sel_hi:[1,0,1] neg_lo:[0,1,0] neg_hi:[0,1,0]
  v_pk_fma_f32 v[152:153], v[44:45], v[20:21], v[152:153] op_sel_hi:[1,0,1] neg_lo:[0,1,0] neg_hi:[0,1,0]
  v_pk_fma_f32 v[154:155], v[46:47], v[20:21], v[154:155] op_sel_hi:[1,0,1] neg_lo:[0,1,0] neg_hi:[0,1,0]
  v_pk_fma_f32 v[168:169], v[48:49], v[20:21], v[168:169] op_sel_hi:[1,0,1] neg_lo:[0,1,0] neg_hi:[0,1,0]
  v_pk_fma_f32 v[170:171], v[50:51], v[20:21], v[170:171] op_sel_hi:[1,0,1] neg_lo:[0,1,0] neg_hi:[0,1,0]
  v_pk_fma_f32 v[104:105], v[104:105], v[20:21], s[40:41] op_sel:[0,1,0] op_sel_hi:[1,1,1]
  v_pk_fma_f32 v[106:107], v[106:107], v[20:21], s[40:41] op_sel:[0,1,0] op_sel_hi:[1,1,1]
  v_pk_fma_f32 v[120:121], v[120:121], v[20:21], s[40:41] op_sel:[0,1,0] op_sel_hi:[1,1,1]
  v_pk_fma_f32 v[122:123], v[122:123], v[20:21], s[40:41] op_sel:[0,1,0] op_sel_hi:[1,1,1]
  v_pk_fma_f32 v[136:137], v[136:137], v[20:21], s[40:41] op_sel:[0,1,0] op_sel_hi:[1,1,1]
  v_pk_fma_f32 v[138:139], v[138:139], v[20:21], s[40:41] op_sel:[0,1,0] op_sel_hi:[1,1,1]
  v_pk_fma_f32 v[152:153], v[152:153], v[20:21], s[40:41] op_sel:[0,1,0] op_sel_hi:[1,1,1]
  v_pk_fma_f32 v[154:155], v[154:155], v[20:21], s[40:41] op_sel:[0,1,0] op_sel_hi:[1,1,1]
  v_pk_fma_f32 v[168:169], v[168:169], v[20:21], s[40:41] op_sel:[0,1,0] op_sel_hi:[1,1,1]
  v_pk_fma_f32 v[170:171], v[170:171], v[20:21], s[40:41] op_sel:[0,1,0] op_sel_hi:[1,1,1]
  v_pk_mul_f32 v[72:73], v[104:105], s[42:43]
  v_pk_mul_f32 v[74:75], v[106:107], s[42:43]
  v_pk_mul_f32 v[76:77], v[120:121], s[42:43]
  v_pk_mul_f32 v[78:79], v[122:123], s[42:43]
  v_pk_mul_f32 v[80:81], v[136:137], s[42:43]
  v_pk_mul_f32 v[82:83], v[138:139], s[42:43]
  v_pk_mul_f32 v[84:85], v[152:153], s[42:43]
  v_pk_mul_f32 v[86:87], v[154:155], s[42:43]
  v_pk_mul_f32 v[88:89], v[168:169], s[42:43]
  v_pk_mul_f32 v[90:91], v[170:171], s[42:43]
  v_exp_f32_e64 v72, v72 clamp
  v_exp_f32_e64 v73, v73 clamp
  v_exp_f32_e64 v74, v74 clamp
  v_exp_f32_e64 v75, v75 clamp
  v_exp_f32_e64 v76, v76 clamp
  v_exp_f32_e64 v77, v77 clamp
  v_exp_f32_e64 v78, v78 clamp
  v_exp_f32_e64 v79, v79 clamp
  v_exp_f32_e64 v80, v80 clamp
  v_exp_f32_e64 v81, v81 clamp
  v_exp_f32_e64 v82, v82 clamp
  v_exp_f32_e64 v83, v83 clamp
  v_exp_f32_e64 v84, v84 clamp
  v_exp_f32_e64 v85, v85 clamp
  v_exp_f32_e64 v86, v86 clamp
  v_exp_f32_e64 v87, v87 clamp
  v_exp_f32_e64 v88, v88 clamp
  v_exp_f32_e64 v89, v89 clamp
  v_exp_f32_e64 v90, v90 clamp
  v_exp_f32_e64 v91, v91 clamp
  v_max_f32 v104, s40, v104
  v_max_f32 v105, s40, v105
  v_max_f32 v106, s40, v106
  v_max_f32 v107, s40, v107
  v_max_f32 v120, s40, v120
  v_max_f32 v121, s40, v121
  v_max_f32 v122, s40, v122
  v_max_f32 v123, s40, v123
  v_max_f32 v136, s40, v136
  v_max_f32 v137, s40, v137
  v_max_f32 v138, s40, v138
  v_max_f32 v139, s40, v139
  v_max_f32 v152, s40, v152
  v_max_f32 v153, s40, v153
  v_max_f32 v154, s40, v154
  v_max_f32 v155, s40, v155
  v_max_f32 v168, s40, v168
  v_max_f32 v169, s40, v169
  v_max_f32 v170, s40, v170
  v_max_f32 v171, s40, v171
  v_pk_add_f32 v[104:105], v[104:105], v[72:73]
  v_pk_add_f32 v[106:107], v[106:107], v[74:75]
  v_pk_add_f32 v[120:121], v[120:121], v[76:77]
  v_pk_add_f32 v[122:123], v[122:123], v[78:79]
  v_pk_add_f32 v[136:137], v[136:137], v[80:81]
  v_pk_add_f32 v[138:139], v[138:139], v[82:83]
  v_pk_add_f32 v[152:153], v[152:153], v[84:85]
  v_pk_add_f32 v[154:155], v[154:155], v[86:87]
  v_pk_add_f32 v[168:169], v[168:169], v[88:89]
  v_pk_add_f32 v[170:171], v[170:171], v[90:91]
  v_pk_fma_f32 v[184:185], v[52:53], v[20:21], v[184:185] op_sel_hi:[1,0,1] neg_lo:[0,1,0] neg_hi:[0,1,0]
  v_pk_fma_f32 v[186:187], v[54:55], v[20:21], v[186:187] op_sel_hi:[1,0,1] neg_lo:[0,1,0] neg_hi:[0,1,0]
  v_pk_fma_f32 v[200:201], v[56:57], v[20:21], v[200:201] op_sel_hi:[1,0,1] neg_lo:[0,1,0] neg_hi:[0,1,0]
  v_pk_fma_f32 v[202:203], v[58:59], v[20:21], v[202:203] op_sel_hi:[1,0,1] neg_lo:[0,1,0] neg_hi:[0,1,0]
  v_pk_fma_f32 v[216:217], v[60:61], v[20:21], v[216:217] op_sel_hi:[1,0,1] neg_lo:[0,1,0] neg_hi:[0,1,0]
  v_pk_fma_f32 v[218:219], v[62:63], v[20:21], v[218:219] op_sel_hi:[1,0,1] neg_lo:[0,1,0] neg_hi:[0,1,0]
  v_pk_fma_f32 v[232:233], v[64:65], v[20:21], v[232:233] op_sel_hi:[1,0,1] neg_lo:[0,1,0] neg_hi:[0,1,0]
  v_pk_fma_f32 v[234:235], v[66:67], v[20:21], v[234:235] op_sel_hi:[1,0,1] neg_lo:[0,1,0] neg_hi:[0,1,0]
  v_pk_fma_f32 v[248:249], v[68:69], v[20:21], v[248:249] op_sel_hi:[1,0,1] neg_lo:[0,1,0] neg_hi:[0,1,0]
  v_pk_fma_f32 v[250:251], v[70:71], v[20:21], v[250:251] op_sel_hi:[1,0,1] neg_lo:[0,1,0] neg_hi:[0,1,0]
  v_pk_fma_f32 v[184:185], v[184:185], v[20:21], s[40:41] op_sel:[0,1,0] op_sel_hi:[1,1,1]
  v_pk_fma_f32 v[186:187], v[186:187], v[20:21], s[40:41] op_sel:[0,1,0] op_sel_hi:[1,1,1]
  v_pk_fma_f32 v[200:201], v[200:201], v[20:21], s[40:41] op_sel:[0,1,0] op_sel_hi:[1,1,1]
  v_pk_fma_f32 v[202:203], v[202:203], v[20:21], s[40:41] op_sel:[0,1,0] op_sel_hi:[1,1,1]
  v_pk_fma_f32 v[216:217], v[216:217], v[20:21], s[40:41] op_sel:[0,1,0] op_sel_hi:[1,1,1]
  v_pk_fma_f32 v[218:219], v[218:219], v[20:21], s[40:41] op_sel:[0,1,0] op_sel_hi:[1,1,1]
  v_pk_fma_f32 v[232:233], v[232:233], v[20:21], s[40:41] op_sel:[0,1,0] op_sel_hi:[1,1,1]
  v_pk_fma_f32 v[234:235], v[234:235], v[20:21], s[40:41] op_sel:[0,1,0] op_sel_hi:[1,1,1]
  v_pk_fma_f32 v[248:249], v[248:249], v[20:21], s[40:41] op_sel:[0,1,0] op_sel_hi:[1,1,1]
  v_pk_fma_f32 v[250:251], v[250:251], v[20:21], s[40:41] op_sel:[0,1,0] op_sel_hi:[1,1,1]
  v_pk_mul_f32 v[72:73], v[184:185], s[42:43]
  v_pk_mul_f32 v[74:75], v[186:187], s[42:43]
  v_pk_mul_f32 v[76:77], v[200:201], s[42:43]
  v_pk_mul_f32 v[78:79], v[202:203], s[42:43]
  v_pk_mul_f32 v[80:81], v[216:217], s[42:43]
  v_pk_mul_f32 v[82:83], v[218:219], s[42:43]
  v_pk_mul_f32 v[84:85], v[232:233], s[42:43]
  v_pk_mul_f32 v[86:87], v[234:235], s[42:43]
  v_pk_mul_f32 v[88:89], v[248:249], s[42:43]
  v_pk_mul_f32 v[90:91], v[250:251], s[42:43]
  v_exp_f32_e64 v72, v72 clamp
  v_exp_f32_e64 v73, v73 clamp
  v_exp_f32_e64 v74, v74 clamp
  v_exp_f32_e64 v75, v75 clamp
  v_exp_f32_e64 v76, v76 clamp
  v_exp_f32_e64 v77, v77 clamp
  v_exp_f32_e64 v78, v78 clamp
  v_exp_f32_e64 v79, v79 clamp
  v_exp_f32_e64 v80, v80 clamp
  v_exp_f32_e64 v81, v81 clamp
  v_exp_f32_e64 v82, v82 clamp
  v_exp_f32_e64 v83, v83 clamp
  v_exp_f32_e64 v84, v84 clamp
  v_exp_f32_e64 v85, v85 clamp
  v_exp_f32_e64 v86, v86 clamp
  v_exp_f32_e64 v87, v87 clamp
  v_exp_f32_e64 v88, v88 clamp
  v_exp_f32_e64 v89, v89 clamp
  v_exp_f32_e64 v90, v90 clamp
  v_exp_f32_e64 v91, v91 clamp
  v_max_f32 v184, s40, v184
  v_max_f32 v185, s40, v185
  v_max_f32 v186, s40, v186
  v_max_f32 v187, s40, v187
  v_max_f32 v200, s40, v200
  v_max_f32 v201, s40, v201
  v_max_f32 v202, s40, v202
  v_max_f32 v203, s40, v203
  v_max_f32 v216, s40, v216
  v_max_f32 v217, s40, v217
  v_max_f32 v218, s40, v218
  v_max_f32 v219, s40, v219
  v_max_f32 v232, s40, v232
  v_max_f32 v233, s40, v233
  v_max_f32 v234, s40, v234
  v_max_f32 v235, s40, v235
  v_max_f32 v248, s40, v248
  v_max_f32 v249, s40, v249
  v_max_f32 v250, s40, v250
  v_max_f32 v251, s40, v251
  v_pk_add_f32 v[184:185], v[184:185], v[72:73]
  v_pk_add_f32 v[186:187], v[186:187], v[74:75]
  v_pk_add_f32 v[200:201], v[200:201], v[76:77]
  v_pk_add_f32 v[202:203], v[202:203], v[78:79]
  v_pk_add_f32 v[216:217], v[216:217], v[80:81]
  v_pk_add_f32 v[218:219], v[218:219], v[82:83]
  v_pk_add_f32 v[232:233], v[232:233], v[84:85]
  v_pk_add_f32 v[234:235], v[234:235], v[86:87]
  v_pk_add_f32 v[248:249], v[248:249], v[88:89]
  v_pk_add_f32 v[250:251], v[250:251], v[90:91]
  v_cvt_pk_bf16_f32 v104, v104, v105
  v_cvt_pk_bf16_f32 v105, v106, v107
  v_cvt_pk_bf16_f32 v106, v120, v121
  v_cvt_pk_bf16_f32 v107, v122, v123
  v_cvt_pk_bf16_f32 v136, v136, v137
  v_cvt_pk_bf16_f32 v137, v138, v139
  v_cvt_pk_bf16_f32 v138, v152, v153
  v_cvt_pk_bf16_f32 v139, v154, v155
  v_cvt_pk_bf16_f32 v168, v168, v169
  v_cvt_pk_bf16_f32 v169, v170, v171
  v_cvt_pk_bf16_f32 v170, v184, v185
  v_cvt_pk_bf16_f32 v171, v186, v187
  v_cvt_pk_bf16_f32 v200, v200, v201
  v_cvt_pk_bf16_f32 v201, v202, v203
  v_cvt_pk_bf16_f32 v202, v216, v217
  v_cvt_pk_bf16_f32 v203, v218, v219
  v_cvt_pk_bf16_f32 v232, v232, v233
  v_cvt_pk_bf16_f32 v233, v234, v235
  v_cvt_pk_bf16_f32 v234, v248, v249
  v_cvt_pk_bf16_f32 v235, v250, v251
  s_cbranch_execz L_dry_ret
  v_add_u32 v11, 20480, v11
  buffer_store_dwordx4 v[104:107], v11, s[20:23], s61 offen offset:0 sc1
  buffer_store_dwordx4 v[136:139], v11, s[20:23], s61 offen offset:1024 sc1
  buffer_store_dwordx4 v[168:171], v11, s[20:23], s61 offen offset:2048 sc1
  buffer_store_dwordx4 v[200:203], v11, s[20:23], s61 offen offset:3072 sc1
  buffer_store_dwordx4 v[232:235], v11, s[20:23], s62 offen sc1
  s_nop 1
L_q_b3:
  v_pk_fma_f32 v[108:109], v[32:33], v[22:23], v[108:109] op_sel_hi:[1,0,1] neg_lo:[0,1,0] neg_hi:[0,1,0]
  v_pk_fma_f32 v[110:111], v[34:35], v[22:23], v[110:111] op_sel_hi:[1,0,1] neg_lo:[0,1,0] neg_hi:[0,1,0]
  v_pk_fma_f32 v[124:125], v[36:37], v[22:23], v[124:125] op_sel_hi:[1,0,1] neg_lo:[0,1,0] neg_hi:[0,1,0]
  v_pk_fma_f32 v[126:127], v[38:39], v[22:23], v[126:127] op_sel_hi:[1,0,1] neg_lo:[0,1,0] neg_hi:[0,1,0]
  v_pk_fma_f32 v[140:141], v[40:41], v[22:23], v[140:141] op_sel_hi:[1,0,1] neg_lo:[0,1,0] neg_hi:[0,1,0]
  v_pk_fma_f32 v[142:143], v[42:43], v[22:23], v[142:143] op_sel_hi:[1,0,1] neg_lo:[0,1,0] neg_hi:[0,1,0]
  v_pk_fma_f32 v[156:157], v[44:45], v[22:23], v[156:157] op_sel_hi:[1,0,1] neg_lo:[0,1,0] neg_hi:[0,1,0]
  v_pk_fma_f32 v[158:159], v[46:47], v[22:23], v[158:159] op_sel_hi:[1,0,1] neg_lo:[0,1,0] neg_hi:[0,1,0]
  v_pk_fma_f32 v[172:173], v[48:49], v[22:23], v[172:173] op_sel_hi:[1,0,1] neg_lo:[0,1,0] neg_hi:[0,1,0]
  v_pk_fma_f32 v[174:175], v[50:51], v[22:23], v[174:175] op_sel_hi:[1,0,1] neg_lo:[0,1,0] neg_hi:[0,1,0]
  v_pk_fma_f32 v[108:109], v[108:109], v[22:23], s[40:41] op_sel:[0,1,0] op_sel_hi:[1,1,1]
  v_pk_fma_f32 v[110:111], v[110:111], v[22:23], s[40:41] op_sel:[0,1,0] op_sel_hi:[1,1,1]
  v_pk_fma_f32 v[124:125], v[124:125], v[22:23], s[40:41] op_sel:[0,1,0] op_sel_hi:[1,1,1]
  v_pk_fma_f32 v[126:127], v[126:127], v[22:23], s[40:41] op_sel:[0,1,0] op_sel_hi:[1,1,1]
  v_pk_fma_f32 v[140:141], v[140:141], v[22:23], s[40:41] op_sel:[0,1,0] op_sel_hi:[1,1,1]
  v_pk_fma_f32 v[142:143], v[142:143], v[22:23], s[40:41] op_sel:[0,1,0] op_sel_hi:[1,1,1]
  v_pk_fma_f32 v[156:157], v[156:157], v[22:23], s[40:41] op_sel:[0,1,0] op_sel_hi:[1,1,1]
  v_pk_fma_f32 v[158:159], v[158:159], v[22:23], s[40:41] op_sel:[0,1,0] op_sel_hi:[1,1,1]
  v_pk_fma_f32 v[172:173], v[172:173], v[22:23], s[40:41] op_sel:[0,1,0] op_sel_hi:[1,1,1]
  v_pk_fma_f32 v[174:175], v[174:175], v[22:23], s[40:41] op_sel:[0,1,0] op_sel_hi:[1,1,1]
  v_pk_mul_f32 v[72:73], v[108:109], s[42:43]
  v_pk_mul_f32 v[74:75], v[110:111], s[42:43]
  v_pk_mul_f32 v[76:77], v[124:125], s[42:43]
  v_pk_mul_f32 v[78:79], v[126:127], s[42:43]
  v_pk_mul_f32 v[80:81], v[140:141], s[42:43]
  v_pk_mul_f32 v[82:83], v[142:143], s[42:43]
  v_pk_mul_f32 v[84:85], v[156:157], s[42:43]
  v_pk_mul_f32 v[86:87], v[158:159], s[42:43]
  v_pk_mul_f32 v[88:89], v[172:173], s[42:43]
  v_pk_mul_f32 v[90:91], v[174:175], s[42:43]
  v_exp_f32_e64 v72, v72 clamp
  v_exp_f32_e64 v73, v73 clamp
  v_exp_f32_e64 v74, v74 clamp
  v_exp_f32_e64 v75, v75 clamp
  v_exp_f32_e64 v76, v76 clamp
  v_exp_f32_e64 v77, v77 clamp
  v_exp_f32_e64 v78, v78 clamp
  v_exp_f32_e64 v79, v79 clamp
  v_exp_f32_e64 v80, v80 clamp
  v_exp_f32_e64 v81, v81 clamp
  v_exp_f32_e64 v82, v82 clamp
  v_exp_f32_e64 v83, v83 clamp
  v_exp_f32_e64 v84, v84 clamp
  v_exp_f32_e64 v85, v85 clamp
  v_exp_f32_e64 v86, v86 clamp
  v_exp_f32_e64 v87, v87 clamp
  v_exp_f32_e64 v88, v88 clamp
  v_exp_f32_e64 v89, v89 clamp
  v_exp_f32_e64 v90, v90 clamp
  v_exp_f32_e64 v91, v91 clamp
  v_max_f32 v108, s40, v108
  v_max_f32 v109, s40, v109
  v_max_f32 v110, s40, v110
  v_max_f32 v111, s40, v111
  v_max_f32 v124, s40, v124
  v_max_f32 v125, s40, v125
  v_max_f32 v126, s40, v126
  v_max_f32 v127, s40, v127
  v_max_f32 v140, s40, v140
  v_max_f32 v141, s40, v141
  v_max_f32 v142, s40, v142
  v_max_f32 v143, s40, v143
  v_max_f32 v156, s40, v156
  v_max_f32 v157, s40, v157
  v_max_f32 v158, s40, v158
  v_max_f32 v159, s40, v159
  v_max_f32 v172, s40, v172
  v_max_f32 v173, s40, v173
  v_max_f32 v174, s40, v174
  v_max_f32 v175, s40, v175
  v_pk_add_f32 v[108:109], v[108:109], v[72:73]
  v_pk_add_f32 v[110:111], v[110:111], v[74:75]
  v_pk_add_f32 v[124:125], v[124:125], v[76:77]
  v_pk_add_f32 v[126:127], v[126:127], v[78:79]
  v_pk_add_f32 v[140:141], v[140:141], v[80:81]
  v_pk_add_f32 v[142:143], v[142:143], v[82:83]
  v_pk_add_f32 v[156:157], v[156:157], v[84:85]
  v_pk_add_f32 v[158:159], v[158:159], v[86:87]
  v_pk_add_f32 v[172:173], v[172:173], v[88:89]
  v_pk_add_f32 v[174:175], v[174:175], v[90:91]
  v_pk_fma_f32 v[188:189], v[52:53], v[22:23], v[188:189] op_sel_hi:[1,0,1] neg_lo:[0,1,0] neg_hi:[0,1,0]
  v_pk_fma_f32 v[190:191], v[54:55], v[22:23], v[190:191] op_sel_hi:[1,0,1] neg_lo:[0,1,0] neg_hi:[0,1,0]
  v_pk_fma_f32 v[204:205], v[56:57], v[22:23], v[204:205] op_sel_hi:[1,0,1] neg_lo:[0,1,0] neg_hi:[0,1,0]
  v_pk_fma_f32 v[206:207], v[58:59], v[22:23], v[206:207] op_sel_hi:[1,0,1] neg_lo:[0,1,0] neg_hi:[0,1,0]
  v_pk_fma_f32 v[220:221], v[60:61], v[22:23], v[220:221] op_sel_hi:[1,0,1] neg_lo:[0,1,0] neg_hi:[0,1,0]
  v_pk_fma_f32 v[222:223], v[62:63], v[22:23], v[222:223] op_sel_hi:[1,0,1] neg_lo:[0,1,0] neg_hi:[0,1,0]
  v_pk_fma_f32 v[236:237], v[64:65], v[22:23], v[236:237] op_sel_hi:[1,0,1] neg_lo:[0,1,0] neg_hi:[0,1,0]
  v_pk_fma_f32 v[238:239], v[66:67], v[22:23], v[238:239] op_sel_hi:[1,0,1] neg_lo:[0,1,0] neg_hi:[0,1,0]
  v_pk_fma_f32 v[252:253], v[68:69], v[22:23], v[252:253] op_sel_hi:[1,0,1] neg_lo:[0,1,0] neg_hi:[0,1,0]
  v_pk_fma_f32 v[254:255], v[70:71], v[22:23], v[254:255] op_sel_hi:[1,0,1] neg_lo:[0,1,0] neg_hi:[0,1,0]
  v_pk_fma_f32 v[188:189], v[188:189], v[22:23], s[40:41] op_sel:[0,1,0] op_sel_hi:[1,1,1]
  v_pk_fma_f32 v[190:191], v[190:191], v[22:23], s[40:41] op_sel:[0,1,0] op_sel_hi:[1,1,1]
  v_pk_fma_f32 v[204:205], v[204:205], v[22:23], s[40:41] op_sel:[0,1,0] op_sel_hi:[1,1,1]
  v_pk_fma_f32 v[206:207], v[206:207], v[22:23], s[40:41] op_sel:[0,1,0] op_sel_hi:[1,1,1]
  v_pk_fma_f32 v[220:221], v[220:221], v[22:23], s[40:41] op_sel:[0,1,0] op_sel_hi:[1,1,1]
  v_pk_fma_f32 v[222:223], v[222:223], v[22:23], s[40:41] op_sel:[0,1,0] op_sel_hi:[1,1,1]
  v_pk_fma_f32 v[236:237], v[236:237], v[22:23], s[40:41] op_sel:[0,1,0] op_sel_hi:[1,1,1]
  v_pk_fma_f32 v[238:239], v[238:239], v[22:23], s[40:41] op_sel:[0,1,0] op_sel_hi:[1,1,1]
  v_pk_fma_f32 v[252:253], v[252:253], v[22:23], s[40:41] op_sel:[0,1,0] op_sel_hi:[1,1,1]
  v_pk_fma_f32 v[254:255], v[254:255], v[22:23], s[40:41] op_sel:[0,1,0] op_sel_hi:[1,1,1]
  v_pk_mul_f32 v[72:73], v[188:189], s[42:43]
  v_pk_mul_f32 v[74:75], v[190:191], s[42:43]
  v_pk_mul_f32 v[76:77], v[204:205], s[42:43]
  v_pk_mul_f32 v[78:79], v[206:207], s[42:43]
  v_pk_mul_f32 v[80:81], v[220:221], s[42:43]
  v_pk_mul_f32 v[82:83], v[222:223], s[42:43]
  v_pk_mul_f32 v[84:85], v[236:237], s[42:43]
  v_pk_mul_f32 v[86:87], v[238:239], s[42:43]
  v_pk_mul_f32 v[88:89], v[252:253], s[42:43]
  v_pk_mul_f32 v[90:91], v[254:255], s[42:43]
  v_exp_f32_e64 v72, v72 clamp
  v_exp_f32_e64 v73, v73 clamp
  v_exp_f32_e64 v74, v74 clamp
  v_exp_f32_e64 v75, v75 clamp
  v_exp_f32_e64 v76, v76 clamp
  v_exp_f32_e64 v77, v77 clamp
  v_exp_f32_e64 v78, v78 clamp
  v_exp_f32_e64 v79, v79 clamp
  v_exp_f32_e64 v80, v80 clamp
  v_exp_f32_e64 v81, v81 clamp
  v_exp_f32_e64 v82, v82 clamp
  v_exp_f32_e64 v83, v83 clamp
  v_exp_f32_e64 v84, v84 clamp
  v_exp_f32_e64 v85, v85 clamp
  v_exp_f32_e64 v86, v86 clamp
  v_exp_f32_e64 v87, v87 clamp
  v_exp_f32_e64 v88, v88 clamp
  v_exp_f32_e64 v89, v89 clamp
  v_exp_f32_e64 v90, v90 clamp
  v_exp_f32_e64 v91, v91 clamp
  v_max_f32 v188, s40, v188
  v_max_f32 v189, s40, v189
  v_max_f32 v190, s40, v190
  v_max_f32 v191, s40, v191
  v_max_f32 v204, s40, v204
  v_max_f32 v205, s40, v205
  v_max_f32 v206, s40, v206
  v_max_f32 v207, s40, v207
  v_max_f32 v220, s40, v220
  v_max_f32 v221, s40, v221
  v_max_f32 v222, s40, v222
  v_max_f32 v223, s40, v223
  v_max_f32 v236, s40, v236
  v_max_f32 v237, s40, v237
  v_max_f32 v238, s40, v238
  v_max_f32 v239, s40, v239
  v_max_f32 v252, s40, v252
  v_max_f32 v253, s40, v253
  v_max_f32 v254, s40, v254
  v_max_f32 v255, s40, v255
  v_pk_add_f32 v[188:189], v[188:189], v[72:73]
  v_pk_add_f32 v[190:191], v[190:191], v[74:75]
  v_pk_add_f32 v[204:205], v[204:205], v[76:77]
  v_pk_add_f32 v[206:207], v[206:207], v[78:79]
  v_pk_add_f32 v[220:221], v[220:221], v[80:81]
  v_pk_add_f32 v[222:223], v[222:223], v[82:83]
  v_pk_add_f32 v[236:237], v[236:237], v[84:85]
  v_pk_add_f32 v[238:239], v[238:239], v[86:87]
  v_pk_add_f32 v[252:253], v[252:253], v[88:89]
  v_pk_add_f32 v[254:255], v[254:255], v[90:91]
  v_cvt_pk_bf16_f32 v108, v108, v109
  v_cvt_pk_bf16_f32 v109, v110, v111
  v_cvt_pk_bf16_f32 v110, v124, v125
  v_cvt_pk_bf16_f32 v111, v126, v127
  v_cvt_pk_bf16_f32 v140, v140, v141
  v_cvt_pk_bf16_f32 v141, v142, v143
  v_cvt_pk_bf16_f32 v142, v156, v157
  v_cvt_pk_bf16_f32 v143, v158, v159
  v_cvt_pk_bf16_f32 v172, v172, v173
  v_cvt_pk_bf16_f32 v173, v174, v175
  v_cvt_pk_bf16_f32 v174, v188, v189
  v_cvt_pk_bf16_f32 v175, v190, v191
  v_cvt_pk_bf16_f32 v204, v204, v205
  v_cvt_pk_bf16_f32 v205, v206, v207
  v_cvt_pk_bf16_f32 v206, v220, v221
  v_cvt_pk_bf16_f32 v207, v222, v223
  v_cvt_pk_bf16_f32 v236, v236, v237
  v_cvt_pk_bf16_f32 v237, v238, v239
  v_cvt_pk_bf16_f32 v238, v252, v253
  v_cvt_pk_bf16_f32 v239, v254, v255
  s_cbranch_execz L_dry_ret
  v_add_u32 v11, 20480, v11
  buffer_store_dwordx4 v[108:111], v11, s[20:23], s61 offen offset:0 sc1
  buffer_store_dwordx4 v[140:143], v11, s[20:23], s61 offen offset:1024 sc1
  buffer_store_dwordx4 v[172:175], v11, s[20:23], s61 offen offset:2048 sc1
  buffer_store_dwordx4 v[204:207], v11, s[20:23], s61 offen offset:3072 sc1
  buffer_store_dwordx4 v[236:239], v11, s[20:23], s62 offen sc1
  s_nop 1
  s_endpgm
L_cons_kv:
  s_cmp_eq_u32 s28, 0
  s_cbranch_scc0 L_ns_n0
  s_mov_b32 s35, 0
  s_barrier
  v_add_u32 v4, s35, v2
  v_add_u32 v6, s35, v3
  v_xor_b32 v5, 64, v4
  s_add_u32 s35, s35, 53248
  s_cmp_eq_u32 s35, 159744
  s_cselect_b32 s35, 0, s35
  ds_read_b128 v[32:35], v4 offset:0
  ds_read_b128 v[36:39], v4 offset:2048
  ds_read_b64_tr_b16 v[64:65], v6 offset:0
  ds_read_b64_tr_b16 v[66:67], v6 offset:1280
  ds_read_b128 v[40:43], v4 offset:4096
  ds_read_b128 v[44:47], v4 offset:6144
  ds_read_b64_tr_b16 v[68:69], v6 offset:32
  ds_read_b64_tr_b16 v[70:71], v6 offset:1312
  s_cmp_lt_u32 s26, 2
  s_cselect_b32 s36, 2, 1
  s_sub_u32 s62, 10, s36
.p2align 6
L_cloop_ns0:
  s_waitcnt lgkmcnt(4)
  v_mfma_f32_16x16x32_bf16 v[96:99], v[32:35], v[64:67], v[96:99]
  ds_read_b64_tr_b16 v[72:73], v6 offset:64
  v_mfma_f32_16x16x32_bf16 v[100:103], v[36:39], v[64:67], v[100:103]
  ds_read_b64_tr_b16 v[74:75], v6 offset:1344
  s_waitcnt lgkmcnt(5)
  v_mfma_f32_16x16x32_bf16 v[104:107], v[40:43], v[64:67], v[104:107]
  ds_read_b64_tr_b16 v[76:77], v6 offset:96
  s_waitcnt lgkmcnt(5)
  v_mfma_f32_16x16x32_bf16 v[108:111], v[44:47], v[64:67], v[108:111]
  v_mfma_f32_16x16x32_bf16 v[80:83], v[92:95], v[64:67], v[80:83]
  ds_read_b64_tr_b16 v[78:79], v6 offset:1376
  s_waitcnt lgkmcnt(4)
  v_mfma_f32_16x16x32_bf16 v[124:127], v[44:47], v[68:71], v[124:127]
  ds_read_b64_tr_b16 v[64:65], v6 offset:128
  v_mfma_f32_16x16x32_bf16 v[120:123], v[40:43], v[68:71], v[120:123]
  ds_read_b64_tr_b16 v[66:67], v6 offset:1408
  v_mfma_f32_16x16x32_bf16 v[116:119], v[36:39], v[68:71], v[116:119]
  v_mfma_f32_16x16x32_bf16 v[112:115], v[32:35], v[68:71], v[112:115]
  s_waitcnt lgkmcnt(4)
  v_mfma_f32_16x16x32_bf16 v[128:131], v[32:35], v[72:75], v[128:131]
  ds_read_b64_tr_b16 v[68:69], v6 offset:10240
  v_mfma_f32_16x16x32_bf16 v[132:135], v[36:39], v[72:75], v[132:135]
  ds_read_b64_tr_b16 v[70:71], v6 offset:11520
  v_mfma_f32_16x16x32_bf16 v[136:139], v[40:43], v[72:75], v[136:139]
  v_mfma_f32_16x16x32_bf16 v[140:143], v[44:47], v[72:75], v[140:143]
  s_waitcnt lgkmcnt(4)
  v_mfma_f32_16x16x32_bf16 v[156:159], v[44:47], v[76:79], v[156:159]
  ds_read_b64_tr_b16 v[72:73], v6 offset:10272
  v_mfma_f32_16x16x32_bf16 v[152:155], v[40:43], v[76:79], v[152:155]
  ds_read_b64_tr_b16 v[74:75], v6 offset:11552
  v_mfma_f32_16x16x32_bf16 v[148:151], v[36:39], v[76:79], v[148:151]
  v_mfma_f32_16x16x32_bf16 v[144:147], v[32:35], v[76:79], v[144:147]
  s_waitcnt lgkmcnt(4)
  v_mfma_f32_16x16x32_bf16 v[160:163], v[32:35], v[64:67], v[160:163]
  ds_read_b64_tr_b16 v[76:77], v6 offset:10304
  v_mfma_f32_16x16x32_bf16 v[164:167], v[36:39], v[64:67], v[164:167]
  ds_read_b64_tr_b16 v[78:79], v6 offset:11584
  v_mfma_f32_16x16x32_bf16 v[168:171], v[40:43], v[64:67], v[168:171]
  ds_read_b128 v[48:51], v5 offset:0
  v_mfma_f32_16x16x32_bf16 v[172:175], v[44:47], v[64:67], v[172:175]
  v_mfma_f32_16x16x32_bf16 v[84:87], v[92:95], v[64:67], v[84:87]
  s_waitcnt lgkmcnt(5)
  v_mfma_f32_16x16x32_bf16 v[188:191], v[44:47], v[68:71], v[188:191]
  ds_read_b64_tr_b16 v[64:65], v6 offset:10336
  v_mfma_f32_16x16x32_bf16 v[184:187], v[40:43], v[68:71], v[184:187]
  ds_read_b64_tr_b16 v[66:67], v6 offset:11616
  v_mfma_f32_16x16x32_bf16 v[180:183], v[36:39], v[68:71], v[180:183]
  ds_read_b128 v[52:55], v5 offset:2048
  v_mfma_f32_16x16x32_bf16 v[176:179], v[32:35], v[68:71], v[176:179]
  s_waitcnt lgkmcnt(6)
  v_mfma_f32_16x16x32_bf16 v[192:195], v[32:35], v[72:75], v[192:195]
  ds_read_b64_tr_b16 v[68:69], v6 offset:10368
  v_mfma_f32_16x16x32_bf16 v[196:199], v[36:39], v[72:75], v[196:199]
  ds_read_b64_tr_b16 v[70:71], v6 offset:11648
  v_mfma_f32_16x16x32_bf16 v[200:203], v[40:43], v[72:75], v[200:203]
  ds_read_b128 v[56:59], v5 offset:4096
  v_mfma_f32_16x16x32_bf16 v[204:207], v[44:47], v[72:75], v[204:207]
  s_waitcnt lgkmcnt(7)
  v_mfma_f32_16x16x32_bf16 v[220:223], v[44:47], v[76:79], v[220:223]
  ds_read_b64_tr_b16 v[72:73], v6 offset:5120
  v_mfma_f32_16x16x32_bf16 v[216:219], v[40:43], v[76:79], v[216:219]
  ds_read_b64_tr_b16 v[74:75], v6 offset:6400
  v_mfma_f32_16x16x32_bf16 v[212:215], v[36:39], v[76:79], v[212:215]
  ds_read_b128 v[60:63], v5 offset:6144
  v_mfma_f32_16x16x32_bf16 v[208:211], v[32:35], v[76:79], v[208:211]
  s_waitcnt lgkmcnt(7)
  v_mfma_f32_16x16x32_bf16 v[224:227], v[32:35], v[64:67], v[224:227]
  ds_read_b64_tr_b16 v[76:77], v6 offset:5152
  v_mfma_f32_16x16x32_bf16 v[228:231], v[36:39], v[64:67], v[228:231]
  ds_read_b64_tr_b16 v[78:79], v6 offset:6432
  v_mfma_f32_16x16x32_bf16 v[232:235], v[40:43], v[64:67], v[232:235]
  v_mfma_f32_16x16x32_bf16 v[236:239], v[44:47], v[64:67], v[236:239]
  v_mfma_f32_16x16x32_bf16 v[88:91], v[92:95], v[64:67], v[88:91]
  s_waitcnt lgkmcnt(6)
  v_mfma_f32_16x16x32_bf16 v[252:255], v[44:47], v[68:71], v[252:255]
  ds_read_b64_tr_b16 v[64:65], v6 offset:5184
  v_mfma_f32_16x16x32_bf16 v[248:251], v[40:43], v[68:71], v[248:251]
  ds_read_b64_tr_b16 v[66:67], v6 offset:6464
  v_mfma_f32_16x16x32_bf16 v[244:247], v[36:39], v[68:71], v[244:247]
  v_mfma_f32_16x16x32_bf16 v[240:243], v[32:35], v[68:71], v[240:243]
  s_waitcnt lgkmcnt(5)
  v_mfma_f32_16x16x32_bf16 v[96:99], v[48:51], v[72:75], v[96:99]
  ds_read_b64_tr_b16 v[68:69], v6 offset:5216
  v_mfma_f32_16x16x32_bf16 v[100:103], v[52:55], v[72:75], v[100:103]
  ds_read_b64_tr_b16 v[70:71], v6 offset:6496
  v_mfma_f32_16x16x32_bf16 v[104:107], v[56:59], v[72:75], v[104:107]
  s_waitcnt lgkmcnt(6)
  v_mfma_f32_16x16x32_bf16 v[108:111], v[60:63], v[72:75], v[108:111]
  v_mfma_f32_16x16x32_bf16 v[80:83], v[92:95], v[72:75], v[80:83]
  s_waitcnt lgkmcnt(4)
  v_mfma_f32_16x16x32_bf16 v[124:127], v[60:63], v[76:79], v[124:127]
  ds_read_b64_tr_b16 v[72:73], v6 offset:5248
  v_mfma_f32_16x16x32_bf16 v[120:123], v[56:59], v[76:79], v[120:123]
  ds_read_b64_tr_b16 v[74:75], v6 offset:6528
  v_mfma_f32_16x16x32_bf16 v[116:119], v[52:55], v[76:79], v[116:119]
  v_mfma_f32_16x16x32_bf16 v[112:115], v[48:51], v[76:79], v[112:115]
  s_waitcnt lgkmcnt(4)
  v_mfma_f32_16x16x32_bf16 v[128:131], v[48:51], v[64:67], v[128:131]
  ds_read_b64_tr_b16 v[76:77], v6 offset:15360
  v_mfma_f32_16x16x32_bf16 v[132:135], v[52:55], v[64:67], v[132:135]
  ds_read_b64_tr_b16 v[78:79], v6 offset:16640
  v_mfma_f32_16x16x32_bf16 v[136:139], v[56:59], v[64:67], v[136:139]
  v_mfma_f32_16x16x32_bf16 v[140:143], v[60:63], v[64:67], v[140:143]
  s_waitcnt lgkmcnt(4)
  v_mfma_f32_16x16x32_bf16 v[156:159], v[60:63], v[68:71], v[156:159]
  ds_read_b64_tr_b16 v[64:65], v6 offset:15392
  v_mfma_f32_16x16x32_bf16 v[152:155], v[56:59], v[68:71], v[152:155]
  ds_read_b64_tr_b16 v[66:67], v6 offset:16672
  v_mfma_f32_16x16x32_bf16 v[148:151], v[52:55], v[68:71], v[148:151]
  v_mfma_f32_16x16x32_bf16 v[144:147], v[48:51], v[68:71], v[144:147]
  s_waitcnt lgkmcnt(4)
  v_mfma_f32_16x16x32_bf16 v[160:163], v[48:51], v[72:75], v[160:163]
  ds_read_b64_tr_b16 v[68:69], v6 offset:15424
  v_mfma_f32_16x16x32_bf16 v[164:167], v[52:55], v[72:75], v[164:167]
  ds_read_b64_tr_b16 v[70:71], v6 offset:16704
  v_mfma_f32_16x16x32_bf16 v[168:171], v[56:59], v[72:75], v[168:171]
  v_mfma_f32_16x16x32_bf16 v[172:175], v[60:63], v[72:75], v[172:175]
  v_mfma_f32_16x16x32_bf16 v[84:87], v[92:95], v[72:75], v[84:87]
  s_waitcnt lgkmcnt(4)
  v_mfma_f32_16x16x32_bf16 v[188:191], v[60:63], v[76:79], v[188:191]
  ds_read_b64_tr_b16 v[72:73], v6 offset:15456
  v_mfma_f32_16x16x32_bf16 v[184:187], v[56:59], v[76:79], v[184:187]
  ds_read_b64_tr_b16 v[74:75], v6 offset:16736
  v_mfma_f32_16x16x32_bf16 v[180:183], v[52:55], v[76:79], v[180:183]
  v_mfma_f32_16x16x32_bf16 v[176:179], v[48:51], v[76:79], v[176:179]
  s_waitcnt lgkmcnt(4)
  v_mfma_f32_16x16x32_bf16 v[192:195], v[48:51], v[64:67], v[192:195]
  ds_read_b64_tr_b16 v[76:77], v6 offset:15488
  v_mfma_f32_16x16x32_bf16 v[196:199], v[52:55], v[64:67], v[196:199]
  ds_read_b64_tr_b16 v[78:79], v6 offset:16768
  v_mfma_f32_16x16x32_bf16 v[200:203], v[56:59], v[64:67], v[200:203]
  v_mfma_f32_16x16x32_bf16 v[204:207], v[60:63], v[64:67], v[204:207]
  s_waitcnt lgkmcnt(4)
  v_mfma_f32_16x16x32_bf16 v[220:223], v[60:63], v[68:71], v[220:223]
  v_mfma_f32_16x16x32_bf16 v[216:219], v[56:59], v[68:71], v[216:219]
  v_mfma_f32_16x16x32_bf16 v[212:215], v[52:55], v[68:71], v[212:215]
  v_mfma_f32_16x16x32_bf16 v[208:211], v[48:51], v[68:71], v[208:211]
  s_waitcnt lgkmcnt(0)
  s_barrier
  v_add_u32 v4, s35, v2
  v_add_u32 v6, s35, v3
  v_xor_b32 v5, 64, v4
  s_add_u32 s35, s35, 53248
  s_cmp_eq_u32 s35, 159744
  s_cselect_b32 s35, 0, s35
  v_mfma_f32_16x16x32_bf16 v[224:227], v[48:51], v[72:75], v[224:227]
  ds_read_b128 v[32:35], v4 offset:0
  v_mfma_f32_16x16x32_bf16 v[228:231], v[52:55], v[72:75], v[228:231]
  ds_read_b128 v[36:39], v4 offset:2048
  v_mfma_f32_16x16x32_bf16 v[232:235], v[56:59], v[72:75], v[232:235]
  ds_read_b64_tr_b16 v[64:65], v6 offset:0
  v_mfma_f32_16x16x32_bf16 v[236:239], v[60:63], v[72:75], v[236:239]
  v_mfma_f32_16x16x32_bf16 v[88:91], v[92:95], v[72:75], v[88:91]
  ds_read_b64_tr_b16 v[66:67], v6 offset:1280
  v_mfma_f32_16x16x32_bf16 v[252:255], v[60:63], v[76:79], v[252:255]
  ds_read_b128 v[40:43], v4 offset:4096
  v_mfma_f32_16x16x32_bf16 v[248:251], v[56:59], v[76:79], v[248:251]
  ds_read_b128 v[44:47], v4 offset:6144
  v_mfma_f32_16x16x32_bf16 v[244:247], v[52:55], v[76:79], v[244:247]
  ds_read_b64_tr_b16 v[68:69], v6 offset:32
  v_mfma_f32_16x16x32_bf16 v[240:243], v[48:51], v[76:79], v[240:243]
  ds_read_b64_tr_b16 v[70:71], v6 offset:1312
  s_sub_u32 s36, s36, 1
  s_cmp_lg_u32 s36, 0
  s_cbranch_scc1 L_cloop_ns0
  v_lshlrev_b32 v11, 2, v9
  v_add_u32 v11, 161792, v11
  v_cmp_eq_u32 vcc, 0, v10
  s_nop 5
  s_and_saveexec_b64 s[64:65], vcc
  ds_write_b32 v11, v80 offset:0
  ds_write_b32 v11, v84 offset:256
  ds_write_b32 v11, v88 offset:512
  s_mov_b64 exec, s[64:65]
  s_nop 3
  s_mov_b32 s36, s62
  s_branch L_cloopN_ns
L_ns_n0:
  s_cmp_eq_u32 s28, 1
  s_cbranch_scc0 L_ns_n1
  s_mov_b32 s35, 0
  s_barrier
  v_add_u32 v4, s35, v2
  v_add_u32 v6, s35, v3
  v_xor_b32 v5, 64, v4
  s_add_u32 s35, s35, 53248
  s_cmp_eq_u32 s35, 159744
  s_cselect_b32 s35, 0, s35
  ds_read_b128 v[32:35], v4 offset:0
  ds_read_b128 v[36:39], v4 offset:2048
  ds_read_b64_tr_b16 v[64:65], v6 offset:0
  ds_read_b64_tr_b16 v[66:67], v6 offset:1280
  ds_read_b128 v[40:43], v4 offset:4096
  ds_read_b128 v[44:47], v4 offset:6144
  ds_read_b64_tr_b16 v[68:69], v6 offset:32
  ds_read_b64_tr_b16 v[70:71], v6 offset:1312
  s_cmp_lt_u32 s26, 2
  s_cselect_b32 s36, 2, 1
  s_sub_u32 s62, 10, s36
.p2align 6
L_cloop_ns1:
  s_waitcnt lgkmcnt(4)
  v_mfma_f32_16x16x32_bf16 v[96:99], v[32:35], v[64:67], v[96:99]
  ds_read_b64_tr_b16 v[72:73], v6 offset:64
  v_mfma_f32_16x16x32_bf16 v[100:103], v[36:39], v[64:67], v[100:103]
  ds_read_b64_tr_b16 v[74:75], v6 offset:1344
  s_waitcnt lgkmcnt(5)
  v_mfma_f32_16x16x32_bf16 v[104:107], v[40:43], v[64:67], v[104:107]
  ds_read_b64_tr_b16 v[76:77], v6 offset:96
  s_waitcnt lgkmcnt(5)
  v_mfma_f32_16x16x32_bf16 v[108:111], v[44:47], v[64:67], v[108:111]
  ds_read_b64_tr_b16 v[78:79], v6 offset:1376
  s_waitcnt lgkmcnt(4)
  v_mfma_f32_16x16x32_bf16 v[124:127], v[44:47], v[68:71], v[124:127]
  ds_read_b64_tr_b16 v[64:65], v6 offset:128
  v_mfma_f32_16x16x32_bf16 v[120:123], v[40:43], v[68:71], v[120:123]
  ds_read_b64_tr_b16 v[66:67], v6 offset:1408
  v_mfma_f32_16x16x32_bf16 v[116:119], v[36:39], v[68:71], v[116:119]
  v_mfma_f32_16x16x32_bf16 v[112:115], v[32:35], v[68:71], v[112:115]
  v_mfma_f32_16x16x32_bf16 v[80:83], v[92:95], v[68:71], v[80:83]
  s_waitcnt lgkmcnt(4)
  v_mfma_f32_16x16x32_bf16 v[128:131], v[32:35], v[72:75], v[128:131]
  ds_read_b64_tr_b16 v[68:69], v6 offset:10240
  v_mfma_f32_16x16x32_bf16 v[132:135], v[36:39], v[72:75], v[132:135]
  ds_read_b64_tr_b16 v[70:71], v6 offset:11520
  v_mfma_f32_16x16x32_bf16 v[136:139], v[40:43], v[72:75], v[136:139]
  v_mfma_f32_16x16x32_bf16 v[140:143], v[44:47], v[72:75], v[140:143]
  s_waitcnt lgkmcnt(4)
  v_mfma_f32_16x16x32_bf16 v[156:159], v[44:47], v[76:79], v[156:159]
  ds_read_b64_tr_b16 v[72:73], v6 offset:10272
  v_mfma_f32_16x16x32_bf16 v[152:155], v[40:43], v[76:79], v[152:155]
  ds_read_b64_tr_b16 v[74:75], v6 offset:11552
  v_mfma_f32_16x16x32_bf16 v[148:151], v[36:39], v[76:79], v[148:151]
  v_mfma_f32_16x16x32_bf16 v[144:147], v[32:35], v[76:79], v[144:147]
  s_waitcnt lgkmcnt(4)
  v_mfma_f32_16x16x32_bf16 v[160:163], v[32:35], v[64:67], v[160:163]
  ds_read_b64_tr_b16 v[76:77], v6 offset:10304
  v_mfma_f32_16x16x32_bf16 v[164:167], v[36:39], v[64:67], v[164:167]
  ds_read_b64_tr_b16 v[78:79], v6 offset:11584
  v_mfma_f32_16x16x32_bf16 v[168:171], v[40:43], v[64:67], v[168:171]
  ds_read_b128 v[48:51], v5 offset:0
  v_mfma_f32_16x16x32_bf16 v[172:175], v[44:47], v[64:67], v[172:175]
  s_waitcnt lgkmcnt(5)
  v_mfma_f32_16x16x32_bf16 v[188:191], v[44:47], v[68:71], v[188:191]
  ds_read_b64_tr_b16 v[64:65], v6 offset:10336
  v_mfma_f32_16x16x32_bf16 v[184:187], v[40:43], v[68:71], v[184:187]
  ds_read_b64_tr_b16 v[66:67], v6 offset:11616
  v_mfma_f32_16x16x32_bf16 v[180:183], v[36:39], v[68:71], v[180:183]
  ds_read_b128 v[52:55], v5 offset:2048
  v_mfma_f32_16x16x32_bf16 v[176:179], v[32:35], v[68:71], v[176:179]
  v_mfma_f32_16x16x32_bf16 v[84:87], v[92:95], v[68:71], v[84:87]
  s_waitcnt lgkmcnt(6)
  v_mfma_f32_16x16x32_bf16 v[192:195], v[32:35], v[72:75], v[192:195]
  ds_read_b64_tr_b16 v[68:69], v6 offset:10368
  v_mfma_f32_16x16x32_bf16 v[196:199], v[36:39], v[72:75], v[196:199]
  ds_read_b64_tr_b16 v[70:71], v6 offset:11648
  v_mfma_f32_16x16x32_bf16 v[200:203], v[40:43], v[72:75], v[200:203]
  ds_read_b128 v[56:59], v5 offset:4096
  v_mfma_f32_16x16x32_bf16 v[204:207], v[44:47], v[72:75], v[204:207]
  s_waitcnt lgkmcnt(7)
  v_mfma_f32_16x16x32_bf16 v[220:223], v[44:47], v[76:79], v[220:223]
  ds_read_b64_tr_b16 v[72:73], v6 offset:5120
  v_mfma_f32_16x16x32_bf16 v[216:219], v[40:43], v[76:79], v[216:219]
  ds_read_b64_tr_b16 v[74:75], v6 offset:6400
  v_mfma_f32_16x16x32_bf16 v[212:215], v[36:39], v[76:79], v[212:215]
  ds_read_b128 v[60:63], v5 offset:6144
  v_mfma_f32_16x16x32_bf16 v[208:211], v[32:35], v[76:79], v[208:211]
  s_waitcnt lgkmcnt(7)
  v_mfma_f32_16x16x32_bf16 v[224:227], v[32:35], v[64:67], v[224:227]
  ds_read_b64_tr_b16 v[76:77], v6 offset:5152
  v_mfma_f32_16x16x32_bf16 v[228:231], v[36:39], v[64:67], v[228:231]
  ds_read_b64_tr_b16 v[78:79], v6 offset:6432
  v_mfma_f32_16x16x32_bf16 v[232:235], v[40:43], v[64:67], v[232:235]
  v_mfma_f32_16x16x32_bf16 v[236:239], v[44:47], v[64:67], v[236:239]
  s_waitcnt lgkmcnt(6)
  v_mfma_f32_16x16x32_bf16 v[252:255], v[44:47], v[68:71], v[252:255]
  ds_read_b64_tr_b16 v[64:65], v6 offset:5184
  v_mfma_f32_16x16x32_bf16 v[248:251], v[40:43], v[68:71], v[248:251]
  ds_read_b64_tr_b16 v[66:67], v6 offset:6464
  v_mfma_f32_16x16x32_bf16 v[244:247], v[36:39], v[68:71], v[244:247]
  v_mfma_f32_16x16x32_bf16 v[240:243], v[32:35], v[68:71], v[240:243]
  v_mfma_f32_16x16x32_bf16 v[88:91], v[92:95], v[68:71], v[88:91]
  s_waitcnt lgkmcnt(5)
  v_mfma_f32_16x16x32_bf16 v[96:99], v[48:51], v[72:75], v[96:99]
  ds_read_b64_tr_b16 v[68:69], v6 offset:5216
  v_mfma_f32_16x16x32_bf16 v[100:103], v[52:55], v[72:75], v[100:103]
  ds_read_b64_tr_b16 v[70:71], v6 offset:6496
  v_mfma_f32_16x16x32_bf16 v[104:107], v[56:59], v[72:75], v[104:107]
  s_waitcnt lgkmcnt(6)
  v_mfma_f32_16x16x32_bf16 v[108:111], v[60:63], v[72:75], v[108:111]
  s_waitcnt lgkmcnt(4)
  v_mfma_f32_16x16x32_bf16 v[124:127], v[60:63], v[76:79], v[124:127]
  ds_read_b64_tr_b16 v[72:73], v6 offset:5248
  v_mfma_f32_16x16x32_bf16 v[120:123], v[56:59], v[76:79], v[120:123]
  ds_read_b64_tr_b16 v[74:75], v6 offset:6528
  v_mfma_f32_16x16x32_bf16 v[116:119], v[52:55], v[76:79], v[116:119]
  v_mfma_f32_16x16x32_bf16 v[112:115], v[48:51], v[76:79], v[112:115]
  v_mfma_f32_16x16x32_bf16 v[80:83], v[92:95], v[76:79], v[80:83]
  s_waitcnt lgkmcnt(4)
  v_mfma_f32_16x16x32_bf16 v[128:131], v[48:51], v[64:67], v[128:131]
  ds_read_b64_tr_b16 v[76:77], v6 offset:15360
  v_mfma_f32_16x16x32_bf16 v[132:135], v[52:55], v[64:67], v[132:135]
  ds_read_b64_tr_b16 v[78:79], v6 offset:16640
  v_mfma_f32_16x16x32_bf16 v[136:139], v[56:59], v[64:67], v[136:139]
  v_mfma_f32_16x16x32_bf16 v[140:143], v[60:63], v[64:67], v[140:143]
  s_waitcnt lgkmcnt(4)
  v_mfma_f32_16x16x32_bf16 v[156:159], v[60:63], v[68:71], v[156:159]
  ds_read_b64_tr_b16 v[64:65], v6 offset:15392
  v_mfma_f32_16x16x32_bf16 v[152:155], v[56:59], v[68:71], v[152:155]
  ds_read_b64_tr_b16 v[66:67], v6 offset:16672
  v_mfma_f32_16x16x32_bf16 v[148:151], v[52:55], v[68:71], v[148:151]
  v_mfma_f32_16x16x32_bf16 v[144:147], v[48:51], v[68:71], v[144:147]
  s_waitcnt lgkmcnt(4)
  v_mfma_f32_16x16x32_bf16 v[160:163], v[48:51], v[72:75], v[160:163]
  ds_read_b64_tr_b16 v[68:69], v6 offset:15424
  v_mfma_f32_16x16x32_bf16 v[164:167], v[52:55], v[72:75], v[164:167]
  ds_read_b64_tr_b16 v[70:71], v6 offset:16704
  v_mfma_f32_16x16x32_bf16 v[168:171], v[56:59], v[72:75], v[168:171]
  v_mfma_f32_16x16x32_bf16 v[172:175], v[60:63], v[72:75], v[172:175]
  s_waitcnt lgkmcnt(4)
  v_mfma_f32_16x16x32_bf16 v[188:191], v[60:63], v[76:79], v[188:191]
  ds_read_b64_tr_b16 v[72:73], v6 offset:15456
  v_mfma_f32_16x16x32_bf16 v[184:187], v[56:59], v[76:79], v[184:187]
  ds_read_b64_tr_b16 v[74:75], v6 offset:16736
  v_mfma_f32_16x16x32_bf16 v[180:183], v[52:55], v[76:79], v[180:183]
  v_mfma_f32_16x16x32_bf16 v[176:179], v[48:51], v[76:79], v[176:179]
  v_mfma_f32_16x16x32_bf16 v[84:87], v[92:95], v[76:79], v[84:87]
  s_waitcnt lgkmcnt(4)
  v_mfma_f32_16x16x32_bf16 v[192:195], v[48:51], v[64:67], v[192:195]
  ds_read_b64_tr_b16 v[76:77], v6 offset:15488
  v_mfma_f32_16x16x32_bf16 v[196:199], v[52:55], v[64:67], v[196:199]
  ds_read_b64_tr_b16 v[78:79], v6 offset:16768
  v_mfma_f32_16x16x32_bf16 v[200:203], v[56:59], v[64:67], v[200:203]
  v_mfma_f32_16x16x32_bf16 v[204:207], v[60:63], v[64:67], v[204:207]
  s_waitcnt lgkmcnt(4)
  v_mfma_f32_16x16x32_bf16 v[220:223], v[60:63], v[68:71], v[220:223]
  v_mfma_f32_16x16x32_bf16 v[216:219], v[56:59], v[68:71], v[216:219]
  v_mfma_f32_16x16x32_bf16 v[212:215], v[52:55], v[68:71], v[212:215]
  v_mfma_f32_16x16x32_bf16 v[208:211], v[48:51], v[68:71], v[208:211]
  s_waitcnt lgkmcnt(0)
  s_barrier
  v_add_u32 v4, s35, v2
  v_add_u32 v6, s35, v3
  v_xor_b32 v5, 64, v4
  s_add_u32 s35, s35, 53248
  s_cmp_eq_u32 s35, 159744
  s_cselect_b32 s35, 0, s35
  v_mfma_f32_16x16x32_bf16 v[224:227], v[48:51], v[72:75], v[224:227]
  ds_read_b128 v[32:35], v4 offset:0
  v_mfma_f32_16x16x32_bf16 v[228:231], v[52:55], v[72:75], v[228:231]
  ds_read_b128 v[36:39], v4 offset:2048
  v_mfma_f32_16x16x32_bf16 v[232:235], v[56:59], v[72:75], v[232:235]
  ds_read_b64_tr_b16 v[64:65], v6 offset:0
  v_mfma_f32_16x16x32_bf16 v[236:239], v[60:63], v[72:75], v[236:239]
  ds_read_b64_tr_b16 v[66:67], v6 offset:1280
  v_mfma_f32_16x16x32_bf16 v[252:255], v[60:63], v[76:79], v[252:255]
  ds_read_b128 v[40:43], v4 offset:4096
  v_mfma_f32_16x16x32_bf16 v[248:251], v[56:59], v[76:79], v[248:251]
  ds_read_b128 v[44:47], v4 offset:6144
  v_mfma_f32_16x16x32_bf16 v[244:247], v[52:55], v[76:79], v[244:247]
  ds_read_b64_tr_b16 v[68:69], v6 offset:32
  v_mfma_f32_16x16x32_bf16 v[240:243], v[48:51], v[76:79], v[240:243]
  v_mfma_f32_16x16x32_bf16 v[88:91], v[92:95], v[76:79], v[88:91]
  ds_read_b64_tr_b16 v[70:71], v6 offset:1312
  s_sub_u32 s36, s36, 1
  s_cmp_lg_u32 s36, 0
  s_cbranch_scc1 L_cloop_ns1
  v_lshlrev_b32 v11, 2, v9
  v_add_u32 v11, 161792, v11
  v_cmp_eq_u32 vcc, 0, v10
  s_nop 5
  s_and_saveexec_b64 s[64:65], vcc
  ds_write_b32 v11, v80 offset:64
  ds_write_b32 v11, v84 offset:320
  ds_write_b32 v11, v88 offset:576
  s_mov_b64 exec, s[64:65]
  s_nop 3
  s_mov_b32 s36, s62
  s_branch L_cloopN_ns
L_ns_n1:
  s_cmp_eq_u32 s28, 2
  s_cbranch_scc0 L_ns_n2
  s_mov_b32 s35, 0
  s_barrier
  v_add_u32 v4, s35, v2
  v_add_u32 v6, s35, v3
  v_xor_b32 v5, 64, v4
  s_add_u32 s35, s35, 53248
  s_cmp_eq_u32 s35, 159744
  s_cselect_b32 s35, 0, s35
  ds_read_b128 v[32:35], v4 offset:0
  ds_read_b128 v[36:39], v4 offset:2048
  ds_read_b64_tr_b16 v[64:65], v6 offset:0
  ds_read_b64_tr_b16 v[66:67], v6 offset:1280
  ds_read_b128 v[40:43], v4 offset:4096
  ds_read_b128 v[44:47], v4 offset:6144
  ds_read_b64_tr_b16 v[68:69], v6 offset:32
  ds_read_b64_tr_b16 v[70:71], v6 offset:1312
  s_cmp_lt_u32 s26, 2
  s_cselect_b32 s36, 2, 1
  s_sub_u32 s62, 10, s36
.p2align 6
L_cloop_ns2:
  s_waitcnt lgkmcnt(4)
  v_mfma_f32_16x16x32_bf16 v[96:99], v[32:35], v[64:67], v[96:99]
  ds_read_b64_tr_b16 v[72:73], v6 offset:64
  v_mfma_f32_16x16x32_bf16 v[100:103], v[36:39], v[64:67], v[100:103]
  ds_read_b64_tr_b16 v[74:75], v6 offset:1344
  s_waitcnt lgkmcnt(5)
  v_mfma_f32_16x16x32_bf16 v[104:107], v[40:43], v[64:67], v[104:107]
  ds_read_b64_tr_b16 v[76:77], v6 offset:96
  s_waitcnt lgkmcnt(5)
  v_mfma_f32_16x16x32_bf16 v[108:111], v[44:47], v[64:67], v[108:111]
  ds_read_b64_tr_b16 v[78:79], v6 offset:1376
  s_waitcnt lgkmcnt(4)
  v_mfma_f32_16x16x32_bf16 v[124:127], v[44:47], v[68:71], v[124:127]
  ds_read_b64_tr_b16 v[64:65], v6 offset:128
  v_mfma_f32_16x16x32_bf16 v[120:123], v[40:43], v[68:71], v[120:123]
  ds_read_b64_tr_b16 v[66:67], v6 offset:1408
  v_mfma_f32_16x16x32_bf16 v[116:119], v[36:39], v[68:71], v[116:119]
  v_mfma_f32_16x16x32_bf16 v[112:115], v[32:35], v[68:71], v[112:115]
  s_waitcnt lgkmcnt(4)
  v_mfma_f32_16x16x32_bf16 v[128:131], v[32:35], v[72:75], v[128:131]
  ds_read_b64_tr_b16 v[68:69], v6 offset:10240
  v_mfma_f32_16x16x32_bf16 v[132:135], v[36:39], v[72:75], v[132:135]
  ds_read_b64_tr_b16 v[70:71], v6 offset:11520
  v_mfma_f32_16x16x32_bf16 v[136:139], v[40:43], v[72:75], v[136:139]
  v_mfma_f32_16x16x32_bf16 v[140:143], v[44:47], v[72:75], v[140:143]
  v_mfma_f32_16x16x32_bf16 v[80:83], v[92:95], v[72:75], v[80:83]
  s_waitcnt lgkmcnt(4)
  v_mfma_f32_16x16x32_bf16 v[156:159], v[44:47], v[76:79], v[156:159]
  ds_read_b64_tr_b16 v[72:73], v6 offset:10272
  v_mfma_f32_16x16x32_bf16 v[152:155], v[40:43], v[76:79], v[152:155]
  ds_read_b64_tr_b16 v[74:75], v6 offset:11552
  v_mfma_f32_16x16x32_bf16 v[148:151], v[36:39], v[76:79], v[148:151]
  v_mfma_f32_16x16x32_bf16 v[144:147], v[32:35], v[76:79], v[144:147]
  s_waitcnt lgkmcnt(4)
  v_mfma_f32_16x16x32_bf16 v[160:163], v[32:35], v[64:67], v[160:163]
  ds_read_b64_tr_b16 v[76:77], v6 offset:10304
  v_mfma_f32_16x16x32_bf16 v[164:167], v[36:39], v[64:67], v[164:167]
  ds_read_b64_tr_b16 v[78:79], v6 offset:11584
  v_mfma_f32_16x16x32_bf16 v[168:171], v[40:43], v[64:67], v[168:171]
  ds_read_b128 v[48:51], v5 offset:0
  v_mfma_f32_16x16x32_bf16 v[172:175], v[44:47], v[64:67], v[172:175]
  s_waitcnt lgkmcnt(5)
  v_mfma_f32_16x16x32_bf16 v[188:191], v[44:47], v[68:71], v[188:191]
  ds_read_b64_tr_b16 v[64:65], v6 offset:10336
  v_mfma_f32_16x16x32_bf16 v[184:187], v[40:43], v[68:71], v[184:187]
  ds_read_b64_tr_b16 v[66:67], v6 offset:11616
  v_mfma_f32_16x16x32_bf16 v[180:183], v[36:39], v[68:71], v[180:183]
  ds_read_b128 v[52:55], v5 offset:2048
  v_mfma_f32_16x16x32_bf16 v[176:179], v[32:35], v[68:71], v[176:179]
  s_waitcnt lgkmcnt(6)
  v_mfma_f32_16x16x32_bf16 v[192:195], v[32:35], v[72:75], v[192:195]
  ds_read_b64_tr_b16 v[68:69], v6 offset:10368
  v_mfma_f32_16x16x32_bf16 v[196:199], v[36:39], v[72:75], v[196:199]
  ds_read_b64_tr_b16 v[70:71], v6 offset:11648
  v_mfma_f32_16x16x32_bf16 v[200:203], v[40:43], v[72:75], v[200:203]
  ds_read_b128 v[56:59], v5 offset:4096
  v_mfma_f32_16x16x32_bf16 v[204:207], v[44:47], v[72:75], v[204:207]
  v_mfma_f32_16x16x32_bf16 v[84:87], v[92:95], v[72:75], v[84:87]
  s_waitcnt lgkmcnt(7)
  v_mfma_f32_16x16x32_bf16 v[220:223], v[44:47], v[76:79], v[220:223]
  ds_read_b64_tr_b16 v[72:73], v6 offset:5120
  v_mfma_f32_16x16x32_bf16 v[216:219], v[40:43], v[76:79], v[216:219]
  ds_read_b64_tr_b16 v[74:75], v6 offset:6400
  v_mfma_f32_16x16x32_bf16 v[212:215], v[36:39], v[76:79], v[212:215]
  ds_read_b128 v[60:63], v5 offset:6144
  v_mfma_f32_16x16x32_bf16 v[208:211], v[32:35], v[76:79], v[208:211]
  s_waitcnt lgkmcnt(7)
  v_mfma_f32_16x16x32_bf16 v[224:227], v[32:35], v[64:67], v[224:227]
  ds_read_b64_tr_b16 v[76:77], v6 offset:5152
  v_mfma_f32_16x16x32_bf16 v[228:231], v[36:39], v[64:67], v[228:231]
  ds_read_b64_tr_b16 v[78:79], v6 offset:6432
  v_mfma_f32_16x16x32_bf16 v[232:235], v[40:43], v[64:67], v[232:235]
  v_mfma_f32_16x16x32_bf16 v[236:239], v[44:47], v[64:67], v[236:239]
  s_waitcnt lgkmcnt(6)
  v_mfma_f32_16x16x32_bf16 v[252:255], v[44:47], v[68:71], v[252:255]
  ds_read_b64_tr_b16 v[64:65], v6 offset:5184
  v_mfma_f32_16x16x32_bf16 v[248:251], v[40:43], v[68:71], v[248:251]
  ds_read_b64_tr_b16 v[66:67], v6 offset:6464
  v_mfma_f32_16x16x32_bf16 v[244:247], v[36:39], v[68:71], v[244:247]
  v_mfma_f32_16x16x32_bf16 v[240:243], v[32:35], v[68:71], v[240:243]
  s_waitcnt lgkmcnt(5)
  v_mfma_f32_16x16x32_bf16 v[96:99], v[48:51], v[72:75], v[96:99]
  ds_read_b64_tr_b16 v[68:69], v6 offset:5216
  v_mfma_f32_16x16x32_bf16 v[100:103], v[52:55], v[72:75], v[100:103]
  ds_read_b64_tr_b16 v[70:71], v6 offset:6496
  v_mfma_f32_16x16x32_bf16 v[104:107], v[56:59], v[72:75], v[104:107]
  s_waitcnt lgkmcnt(6)
  v_mfma_f32_16x16x32_bf16 v[108:111], v[60:63], v[72:75], v[108:111]
  s_waitcnt lgkmcnt(4)
  v_mfma_f32_16x16x32_bf16 v[124:127], v[60:63], v[76:79], v[124:127]
  ds_read_b64_tr_b16 v[72:73], v6 offset:5248
  v_mfma_f32_16x16x32_bf16 v[120:123], v[56:59], v[76:79], v[120:123]
  ds_read_b64_tr_b16 v[74:75], v6 offset:6528
  v_mfma_f32_16x16x32_bf16 v[116:119], v[52:55], v[76:79], v[116:119]
  v_mfma_f32_16x16x32_bf16 v[112:115], v[48:51], v[76:79], v[112:115]
  s_waitcnt lgkmcnt(4)
  v_mfma_f32_16x16x32_bf16 v[128:131], v[48:51], v[64:67], v[128:131]
  ds_read_b64_tr_b16 v[76:77], v6 offset:15360
  v_mfma_f32_16x16x32_bf16 v[132:135], v[52:55], v[64:67], v[132:135]
  ds_read_b64_tr_b16 v[78:79], v6 offset:16640
  v_mfma_f32_16x16x32_bf16 v[136:139], v[56:59], v[64:67], v[136:139]
  v_mfma_f32_16x16x32_bf16 v[140:143], v[60:63], v[64:67], v[140:143]
  v_mfma_f32_16x16x32_bf16 v[80:83], v[92:95], v[64:67], v[80:83]
  s_waitcnt lgkmcnt(4)
  v_mfma_f32_16x16x32_bf16 v[156:159], v[60:63], v[68:71], v[156:159]
  ds_read_b64_tr_b16 v[64:65], v6 offset:15392
  v_mfma_f32_16x16x32_bf16 v[152:155], v[56:59], v[68:71], v[152:155]
  ds_read_b64_tr_b16 v[66:67], v6 offset:16672
  v_mfma_f32_16x16x32_bf16 v[148:151], v[52:55], v[68:71], v[148:151]
  v_mfma_f32_16x16x32_bf16 v[144:147], v[48:51], v[68:71], v[144:147]
  s_waitcnt lgkmcnt(4)
  v_mfma_f32_16x16x32_bf16 v[160:163], v[48:51], v[72:75], v[160:163]
  ds_read_b64_tr_b16 v[68:69], v6 offset:15424
  v_mfma_f32_16x16x32_bf16 v[164:167], v[52:55], v[72:75], v[164:167]
  ds_read_b64_tr_b16 v[70:71], v6 offset:16704
  v_mfma_f32_16x16x32_bf16 v[168:171], v[56:59], v[72:75], v[168:171]
  v_mfma_f32_16x16x32_bf16 v[172:175], v[60:63], v[72:75], v[172:175]
  s_waitcnt lgkmcnt(4)
  v_mfma_f32_16x16x32_bf16 v[188:191], v[60:63], v[76:79], v[188:191]
  ds_read_b64_tr_b16 v[72:73], v6 offset:15456
  v_mfma_f32_16x16x32_bf16 v[184:187], v[56:59], v[76:79], v[184:187]
  ds_read_b64_tr_b16 v[74:75], v6 offset:16736
  v_mfma_f32_16x16x32_bf16 v[180:183], v[52:55], v[76:79], v[180:183]
  v_mfma_f32_16x16x32_bf16 v[176:179], v[48:51], v[76:79], v[176:179]
  s_waitcnt lgkmcnt(4)
  v_mfma_f32_16x16x32_bf16 v[192:195], v[48:51], v[64:67], v[192:195]
  ds_read_b64_tr_b16 v[76:77], v6 offset:15488
  v_mfma_f32_16x16x32_bf16 v[196:199], v[52:55], v[64:67], v[196:199]
  ds_read_b64_tr_b16 v[78:79], v6 offset:16768
  v_mfma_f32_16x16x32_bf16 v[200:203], v[56:59], v[64:67], v[200:203]
  v_mfma_f32_16x16x32_bf16 v[204:207], v[60:63], v[64:67], v[204:207]
  v_mfma_f32_16x16x32_bf16 v[84:87], v[92:95], v[64:67], v[84:87]
  s_waitcnt lgkmcnt(4)
  v_mfma_f32_16x16x32_bf16 v[220:223], v[60:63], v[68:71], v[220:223]
  v_mfma_f32_16x16x32_bf16 v[216:219], v[56:59], v[68:71], v[216:219]
  v_mfma_f32_16x16x32_bf16 v[212:215], v[52:55], v[68:71], v[212:215]
  v_mfma_f32_16x16x32_bf16 v[208:211], v[48:51], v[68:71], v[208:211]
  s_waitcnt lgkmcnt(0)
  s_barrier
  v_add_u32 v4, s35, v2
  v_add_u32 v6, s35, v3
  v_xor_b32 v5, 64, v4
  s_add_u32 s35, s35, 53248
  s_cmp_eq_u32 s35, 159744
  s_cselect_b32 s35, 0, s35
  v_mfma_f32_16x16x32_bf16 v[224:227], v[48:51], v[72:75], v[224:227]
  ds_read_b128 v[32:35], v4 offset:0
  v_mfma_f32_16x16x32_bf16 v[228:231], v[52:55], v[72:75], v[228:231]
  ds_read_b128 v[36:39], v4 offset:2048
  v_mfma_f32_16x16x32_bf16 v[232:235], v[56:59], v[72:75], v[232:235]
  ds_read_b64_tr_b16 v[64:65], v6 offset:0
  v_mfma_f32_16x16x32_bf16 v[236:239], v[60:63], v[72:75], v[236:239]
  ds_read_b64_tr_b16 v[66:67], v6 offset:1280
  v_mfma_f32_16x16x32_bf16 v[252:255], v[60:63], v[76:79], v[252:255]
  ds_read_b128 v[40:43], v4 offset:4096
  v_mfma_f32_16x16x32_bf16 v[248:251], v[56:59], v[76:79], v[248:251]
  ds_read_b128 v[44:47], v4 offset:6144
  v_mfma_f32_16x16x32_bf16 v[244:247], v[52:55], v[76:79], v[244:247]
  ds_read_b64_tr_b16 v[68:69], v6 offset:32
  v_mfma_f32_16x16x32_bf16 v[240:243], v[48:51], v[76:79], v[240:243]
  ds_read_b64_tr_b16 v[70:71], v6 offset:1312
  s_sub_u32 s36, s36, 1
  s_cmp_lg_u32 s36, 0
  s_cbranch_scc1 L_cloop_ns2
  v_lshlrev_b32 v11, 2, v9
  v_add_u32 v11, 161792, v11
  v_cmp_eq_u32 vcc, 0, v10
  s_nop 5
  s_and_saveexec_b64 s[64:65], vcc
  ds_write_b32 v11, v80 offset:128
  ds_write_b32 v11, v84 offset:384
  s_mov_b64 exec, s[64:65]
  s_nop 3
  s_mov_b32 s36, s62
  s_branch L_cloopN_ns
L_ns_n2:
  s_mov_b32 s35, 0
  s_barrier
  v_add_u32 v4, s35, v2
  v_add_u32 v6, s35, v3
  v_xor_b32 v5, 64, v4
  s_add_u32 s35, s35, 53248
  s_cmp_eq_u32 s35, 159744
  s_cselect_b32 s35, 0, s35
  ds_read_b128 v[32:35], v4 offset:0
  ds_read_b128 v[36:39], v4 offset:2048
  ds_read_b64_tr_b16 v[64:65], v6 offset:0
  ds_read_b64_tr_b16 v[66:67], v6 offset:1280
  ds_read_b128 v[40:43], v4 offset:4096
  ds_read_b128 v[44:47], v4 offset:6144
  ds_read_b64_tr_b16 v[68:69], v6 offset:32
  ds_read_b64_tr_b16 v[70:71], v6 offset:1312
  s_cmp_lt_u32 s26, 2
  s_cselect_b32 s36, 2, 1
  s_sub_u32 s62, 10, s36
.p2align 6
L_cloop_ns3:
  s_waitcnt lgkmcnt(4)
  v_mfma_f32_16x16x32_bf16 v[96:99], v[32:35], v[64:67], v[96:99]
  ds_read_b64_tr_b16 v[72:73], v6 offset:64
  v_mfma_f32_16x16x32_bf16 v[100:103], v[36:39], v[64:67], v[100:103]
  ds_read_b64_tr_b16 v[74:75], v6 offset:1344
  s_waitcnt lgkmcnt(5)
  v_mfma_f32_16x16x32_bf16 v[104:107], v[40:43], v[64:67], v[104:107]
  ds_read_b64_tr_b16 v[76:77], v6 offset:96
  s_waitcnt lgkmcnt(5)
  v_mfma_f32_16x16x32_bf16 v[108:111], v[44:47], v[64:67], v[108:111]
  ds_read_b64_tr_b16 v[78:79], v6 offset:1376
  s_waitcnt lgkmcnt(4)
  v_mfma_f32_16x16x32_bf16 v[124:127], v[44:47], v[68:71], v[124:127]
  ds_read_b64_tr_b16 v[64:65], v6 offset:128
  v_mfma_f32_16x16x32_bf16 v[120:123], v[40:43], v[68:71], v[120:123]
  ds_read_b64_tr_b16 v[66:67], v6 offset:1408
  v_mfma_f32_16x16x32_bf16 v[116:119], v[36:39], v[68:71], v[116:119]
  v_mfma_f32_16x16x32_bf16 v[112:115], v[32:35], v[68:71], v[112:115]
  s_waitcnt lgkmcnt(4)
  v_mfma_f32_16x16x32_bf16 v[128:131], v[32:35], v[72:75], v[128:131]
  ds_read_b64_tr_b16 v[68:69], v6 offset:10240
  v_mfma_f32_16x16x32_bf16 v[132:135], v[36:39], v[72:75], v[132:135]
  ds_read_b64_tr_b16 v[70:71], v6 offset:11520
  v_mfma_f32_16x16x32_bf16 v[136:139], v[40:43], v[72:75], v[136:139]
  v_mfma_f32_16x16x32_bf16 v[140:143], v[44:47], v[72:75], v[140:143]
  s_waitcnt lgkmcnt(4)
  v_mfma_f32_16x16x32_bf16 v[156:159], v[44:47], v[76:79], v[156:159]
  ds_read_b64_tr_b16 v[72:73], v6 offset:10272
  v_mfma_f32_16x16x32_bf16 v[152:155], v[40:43], v[76:79], v[152:155]
  ds_read_b64_tr_b16 v[74:75], v6 offset:11552
  v_mfma_f32_16x16x32_bf16 v[148:151], v[36:39], v[76:79], v[148:151]
  v_mfma_f32_16x16x32_bf16 v[144:147], v[32:35], v[76:79], v[144:147]
  v_mfma_f32_16x16x32_bf16 v[80:83], v[92:95], v[76:79], v[80:83]
  s_waitcnt lgkmcnt(4)
  v_mfma_f32_16x16x32_bf16 v[160:163], v[32:35], v[64:67], v[160:163]
  ds_read_b64_tr_b16 v[76:77], v6 offset:10304
  v_mfma_f32_16x16x32_bf16 v[164:167], v[36:39], v[64:67], v[164:167]
  ds_read_b64_tr_b16 v[78:79], v6 offset:11584
  v_mfma_f32_16x16x32_bf16 v[168:171], v[40:43], v[64:67], v[168:171]
  ds_read_b128 v[48:51], v5 offset:0
  v_mfma_f32_16x16x32_bf16 v[172:175], v[44:47], v[64:67], v[172:175]
  s_waitcnt lgkmcnt(5)
  v_mfma_f32_16x16x32_bf16 v[188:191], v[44:47], v[68:71], v[188:191]
  ds_read_b64_tr_b16 v[64:65], v6 offset:10336
  v_mfma_f32_16x16x32_bf16 v[184:187], v[40:43], v[68:71], v[184:187]
  ds_read_b64_tr_b16 v[66:67], v6 offset:11616
  v_mfma_f32_16x16x32_bf16 v[180:183], v[36:39], v[68:71], v[180:183]
  ds_read_b128 v[52:55], v5 offset:2048
  v_mfma_f32_16x16x32_bf16 v[176:179], v[32:35], v[68:71], v[176:179]
  s_waitcnt lgkmcnt(6)
  v_mfma_f32_16x16x32_bf16 v[192:195], v[32:35], v[72:75], v[192:195]
  ds_read_b64_tr_b16 v[68:69], v6 offset:10368
  v_mfma_f32_16x16x32_bf16 v[196:199], v[36:39], v[72:75], v[196:199]
  ds_read_b64_tr_b16 v[70:71], v6 offset:11648
  v_mfma_f32_16x16x32_bf16 v[200:203], v[40:43], v[72:75], v[200:203]
  ds_read_b128 v[56:59], v5 offset:4096
  v_mfma_f32_16x16x32_bf16 v[204:207], v[44:47], v[72:75], v[204:207]
  s_waitcnt lgkmcnt(7)
  v_mfma_f32_16x16x32_bf16 v[220:223], v[44:47], v[76:79], v[220:223]
  ds_read_b64_tr_b16 v[72:73], v6 offset:5120
  v_mfma_f32_16x16x32_bf16 v[216:219], v[40:43], v[76:79], v[216:219]
  ds_read_b64_tr_b16 v[74:75], v6 offset:6400
  v_mfma_f32_16x16x32_bf16 v[212:215], v[36:39], v[76:79], v[212:215]
  ds_read_b128 v[60:63], v5 offset:6144
  v_mfma_f32_16x16x32_bf16 v[208:211], v[32:35], v[76:79], v[208:211]
  v_mfma_f32_16x16x32_bf16 v[84:87], v[92:95], v[76:79], v[84:87]
  s_waitcnt lgkmcnt(7)
  v_mfma_f32_16x16x32_bf16 v[224:227], v[32:35], v[64:67], v[224:227]
  ds_read_b64_tr_b16 v[76:77], v6 offset:5152
  v_mfma_f32_16x16x32_bf16 v[228:231], v[36:39], v[64:67], v[228:231]
  ds_read_b64_tr_b16 v[78:79], v6 offset:6432
  v_mfma_f32_16x16x32_bf16 v[232:235], v[40:43], v[64:67], v[232:235]
  v_mfma_f32_16x16x32_bf16 v[236:239], v[44:47], v[64:67], v[236:239]
  s_waitcnt lgkmcnt(6)
  v_mfma_f32_16x16x32_bf16 v[252:255], v[44:47], v[68:71], v[252:255]
  ds_read_b64_tr_b16 v[64:65], v6 offset:5184
  v_mfma_f32_16x16x32_bf16 v[248:251], v[40:43], v[68:71], v[248:251]
  ds_read_b64_tr_b16 v[66:67], v6 offset:6464
  v_mfma_f32_16x16x32_bf16 v[244:247], v[36:39], v[68:71], v[244:247]
  v_mfma_f32_16x16x32_bf16 v[240:243], v[32:35], v[68:71], v[240:243]
  s_waitcnt lgkmcnt(5)
  v_mfma_f32_16x16x32_bf16 v[96:99], v[48:51], v[72:75], v[96:99]
  ds_read_b64_tr_b16 v[68:69], v6 offset:5216
  v_mfma_f32_16x16x32_bf16 v[100:103], v[52:55], v[72:75], v[100:103]
  ds_read_b64_tr_b16 v[70:71], v6 offset:6496
  v_mfma_f32_16x16x32_bf16 v[104:107], v[56:59], v[72:75], v[104:107]
  s_waitcnt lgkmcnt(6)
  v_mfma_f32_16x16x32_bf16 v[108:111], v[60:63], v[72:75], v[108:111]
  s_waitcnt lgkmcnt(4)
  v_mfma_f32_16x16x32_bf16 v[124:127], v[60:63], v[76:79], v[124:127]
  ds_read_b64_tr_b16 v[72:73], v6 offset:5248
  v_mfma_f32_16x16x32_bf16 v[120:123], v[56:59], v[76:79], v[120:123]
  ds_read_b64_tr_b16 v[74:75], v6 offset:6528
  v_mfma_f32_16x16x32_bf16 v[116:119], v[52:55], v[76:79], v[116:119]
  v_mfma_f32_16x16x32_bf16 v[112:115], v[48:51], v[76:79], v[112:115]
  s_waitcnt lgkmcnt(4)
  v_mfma_f32_16x16x32_bf16 v[128:131], v[48:51], v[64:67], v[128:131]
  ds_read_b64_tr_b16 v[76:77], v6 offset:15360
  v_mfma_f32_16x16x32_bf16 v[132:135], v[52:55], v[64:67], v[132:135]
  ds_read_b64_tr_b16 v[78:79], v6 offset:16640
  v_mfma_f32_16x16x32_bf16 v[136:139], v[56:59], v[64:67], v[136:139]
  v_mfma_f32_16x16x32_bf16 v[140:143], v[60:63], v[64:67], v[140:143]
  s_waitcnt lgkmcnt(4)
  v_mfma_f32_16x16x32_bf16 v[156:159], v[60:63], v[68:71], v[156:159]
  ds_read_b64_tr_b16 v[64:65], v6 offset:15392
  v_mfma_f32_16x16x32_bf16 v[152:155], v[56:59], v[68:71], v[152:155]
  ds_read_b64_tr_b16 v[66:67], v6 offset:16672
  v_mfma_f32_16x16x32_bf16 v[148:151], v[52:55], v[68:71], v[148:151]
  v_mfma_f32_16x16x32_bf16 v[144:147], v[48:51], v[68:71], v[144:147]
  v_mfma_f32_16x16x32_bf16 v[80:83], v[92:95], v[68:71], v[80:83]
  s_waitcnt lgkmcnt(4)
  v_mfma_f32_16x16x32_bf16 v[160:163], v[48:51], v[72:75], v[160:163]
  ds_read_b64_tr_b16 v[68:69], v6 offset:15424
  v_mfma_f32_16x16x32_bf16 v[164:167], v[52:55], v[72:75], v[164:167]
  ds_read_b64_tr_b16 v[70:71], v6 offset:16704
  v_mfma_f32_16x16x32_bf16 v[168:171], v[56:59], v[72:75], v[168:171]
  v_mfma_f32_16x16x32_bf16 v[172:175], v[60:63], v[72:75], v[172:175]
  s_waitcnt lgkmcnt(4)
  v_mfma_f32_16x16x32_bf16 v[188:191], v[60:63], v[76:79], v[188:191]
  ds_read_b64_tr_b16 v[72:73], v6 offset:15456
  v_mfma_f32_16x16x32_bf16 v[184:187], v[56:59], v[76:79], v[184:187]
  ds_read_b64_tr_b16 v[74:75], v6 offset:16736
  v_mfma_f32_16x16x32_bf16 v[180:183], v[52:55], v[76:79], v[180:183]
  v_mfma_f32_16x16x32_bf16 v[176:179], v[48:51], v[76:79], v[176:179]
  s_waitcnt lgkmcnt(4)
  v_mfma_f32_16x16x32_bf16 v[192:195], v[48:51], v[64:67], v[192:195]
  ds_read_b64_tr_b16 v[76:77], v6 offset:15488
  v_mfma_f32_16x16x32_bf16 v[196:199], v[52:55], v[64:67], v[196:199]
  ds_read_b64_tr_b16 v[78:79], v6 offset:16768
  v_mfma_f32_16x16x32_bf16 v[200:203], v[56:59], v[64:67], v[200:203]
  v_mfma_f32_16x16x32_bf16 v[204:207], v[60:63], v[64:67], v[204:207]
  s_waitcnt lgkmcnt(4)
  v_mfma_f32_16x16x32_bf16 v[220:223], v[60:63], v[68:71], v[220:223]
  v_mfma_f32_16x16x32_bf16 v[216:219], v[56:59], v[68:71], v[216:219]
  v_mfma_f32_16x16x32_bf16 v[212:215], v[52:55], v[68:71], v[212:215]
  v_mfma_f32_16x16x32_bf16 v[208:211], v[48:51], v[68:71], v[208:211]
  v_mfma_f32_16x16x32_bf16 v[84:87], v[92:95], v[68:71], v[84:87]
  s_waitcnt lgkmcnt(0)
  s_barrier
  v_add_u32 v4, s35, v2
  v_add_u32 v6, s35, v3
  v_xor_b32 v5, 64, v4
  s_add_u32 s35, s35, 53248
  s_cmp_eq_u32 s35, 159744
  s_cselect_b32 s35, 0, s35
  v_mfma_f32_16x16x32_bf16 v[224:227], v[48:51], v[72:75], v[224:227]
  ds_read_b128 v[32:35], v4 offset:0
  v_mfma_f32_16x16x32_bf16 v[228:231], v[52:55], v[72:75], v[228:231]
  ds_read_b128 v[36:39], v4 offset:2048
  v_mfma_f32_16x16x32_bf16 v[232:235], v[56:59], v[72:75], v[232:235]
  ds_read_b64_tr_b16 v[64:65], v6 offset:0
  v_mfma_f32_16x16x32_bf16 v[236:239], v[60:63], v[72:75], v[236:239]
  ds_read_b64_tr_b16 v[66:67], v6 offset:1280
  v_mfma_f32_16x16x32_bf16 v[252:255], v[60:63], v[76:79], v[252:255]
  ds_read_b128 v[40:43], v4 offset:4096
  v_mfma_f32_16x16x32_bf16 v[248:251], v[56:59], v[76:79], v[248:251]
  ds_read_b128 v[44:47], v4 offset:6144
  v_mfma_f32_16x16x32_bf16 v[244:247], v[52:55], v[76:79], v[244:247]
  ds_read_b64_tr_b16 v[68:69], v6 offset:32
  v_mfma_f32_16x16x32_bf16 v[240:243], v[48:51], v[76:79], v[240:243]
  ds_read_b64_tr_b16 v[70:71], v6 offset:1312
  s_sub_u32 s36, s36, 1
  s_cmp_lg_u32 s36, 0
  s_cbranch_scc1 L_cloop_ns3
  v_lshlrev_b32 v11, 2, v9
  v_add_u32 v11, 161792, v11
  v_cmp_eq_u32 vcc, 0, v10
  s_nop 5
  s_and_saveexec_b64 s[64:65], vcc
  ds_write_b32 v11, v80 offset:192
  ds_write_b32 v11, v84 offset:448
  s_mov_b64 exec, s[64:65]
  s_nop 3
  s_mov_b32 s36, s62
  s_branch L_cloopN_ns
.p2align 6
L_cloopN_ns:
  s_waitcnt lgkmcnt(4)
  v_mfma_f32_16x16x32_bf16 v[96:99], v[32:35], v[64:67], v[96:99]
  ds_read_b64_tr_b16 v[72:73], v6 offset:64
  v_mfma_f32_16x16x32_bf16 v[100:103], v[36:39], v[64:67], v[100:103]
  ds_read_b64_tr_b16 v[74:75], v6 offset:1344
  s_waitcnt lgkmcnt(5)
  v_mfma_f32_16x16x32_bf16 v[104:107], v[40:43], v[64:67], v[104:107]
  ds_read_b64_tr_b16 v[76:77], v6 offset:96
  s_waitcnt lgkmcnt(5)
  v_mfma_f32_16x16x32_bf16 v[108:111], v[44:47], v[64:67], v[108:111]
  ds_read_b64_tr_b16 v[78:79], v6 offset:1376
  s_waitcnt lgkmcnt(4)
  v_mfma_f32_16x16x32_bf16 v[124:127], v[44:47], v[68:71], v[124:127]
  ds_read_b64_tr_b16 v[64:65], v6 offset:128
  v_mfma_f32_16x16x32_bf16 v[120:123], v[40:43], v[68:71], v[120:123]
  ds_read_b64_tr_b16 v[66:67], v6 offset:1408
  v_mfma_f32_16x16x32_bf16 v[116:119], v[36:39], v[68:71], v[116:119]
  v_mfma_f32_16x16x32_bf16 v[112:115], v[32:35], v[68:71], v[112:115]
  s_waitcnt lgkmcnt(4)
  v_mfma_f32_16x16x32_bf16 v[128:131], v[32:35], v[72:75], v[128:131]
  ds_read_b64_tr_b16 v[68:69], v6 offset:10240
  v_mfma_f32_16x16x32_bf16 v[132:135], v[36:39], v[72:75], v[132:135]
  ds_read_b64_tr_b16 v[70:71], v6 offset:11520
  v_mfma_f32_16x16x32_bf16 v[136:139], v[40:43], v[72:75], v[136:139]
  v_mfma_f32_16x16x32_bf16 v[140:143], v[44:47], v[72:75], v[140:143]
  s_waitcnt lgkmcnt(4)
  v_mfma_f32_16x16x32_bf16 v[156:159], v[44:47], v[76:79], v[156:159]
  ds_read_b64_tr_b16 v[72:73], v6 offset:10272
  v_mfma_f32_16x16x32_bf16 v[152:155], v[40:43], v[76:79], v[152:155]
  ds_read_b64_tr_b16 v[74:75], v6 offset:11552
  v_mfma_f32_16x16x32_bf16 v[148:151], v[36:39], v[76:79], v[148:151]
  v_mfma_f32_16x16x32_bf16 v[144:147], v[32:35], v[76:79], v[144:147]
  s_waitcnt lgkmcnt(4)
  v_mfma_f32_16x16x32_bf16 v[160:163], v[32:35], v[64:67], v[160:163]
  ds_read_b64_tr_b16 v[76:77], v6 offset:10304
  v_mfma_f32_16x16x32_bf16 v[164:167], v[36:39], v[64:67], v[164:167]
  ds_read_b64_tr_b16 v[78:79], v6 offset:11584
  v_mfma_f32_16x16x32_bf16 v[168:171], v[40:43], v[64:67], v[168:171]
  ds_read_b128 v[48:51], v5 offset:0
  v_mfma_f32_16x16x32_bf16 v[172:175], v[44:47], v[64:67], v[172:175]
  s_waitcnt lgkmcnt(5)
  v_mfma_f32_16x16x32_bf16 v[188:191], v[44:47], v[68:71], v[188:191]
  ds_read_b64_tr_b16 v[64:65], v6 offset:10336
  v_mfma_f32_16x16x32_bf16 v[184:187], v[40:43], v[68:71], v[184:187]
  ds_read_b64_tr_b16 v[66:67], v6 offset:11616
  v_mfma_f32_16x16x32_bf16 v[180:183], v[36:39], v[68:71], v[180:183]
  ds_read_b128 v[52:55], v5 offset:2048
  v_mfma_f32_16x16x32_bf16 v[176:179], v[32:35], v[68:71], v[176:179]
  s_waitcnt lgkmcnt(6)
  v_mfma_f32_16x16x32_bf16 v[192:195], v[32:35], v[72:75], v[192:195]
  ds_read_b64_tr_b16 v[68:69], v6 offset:10368
  v_mfma_f32_16x16x32_bf16 v[196:199], v[36:39], v[72:75], v[196:199]
  ds_read_b64_tr_b16 v[70:71], v6 offset:11648
  v_mfma_f32_16x16x32_bf16 v[200:203], v[40:43], v[72:75], v[200:203]
  ds_read_b128 v[56:59], v5 offset:4096
  v_mfma_f32_16x16x32_bf16 v[204:207], v[44:47], v[72:75], v[204:207]
  s_waitcnt lgkmcnt(7)
  v_mfma_f32_16x16x32_bf16 v[220:223], v[44:47], v[76:79], v[220:223]
  ds_read_b64_tr_b16 v[72:73], v6 offset:5120
  v_mfma_f32_16x16x32_bf16 v[216:219], v[40:43], v[76:79], v[216:219]
  ds_read_b64_tr_b16 v[74:75], v6 offset:6400
  v_mfma_f32_16x16x32_bf16 v[212:215], v[36:39], v[76:79], v[212:215]
  ds_read_b128 v[60:63], v5 offset:6144
  v_mfma_f32_16x16x32_bf16 v[208:211], v[32:35], v[76:79], v[208:211]
  s_waitcnt lgkmcnt(7)
  v_mfma_f32_16x16x32_bf16 v[224:227], v[32:35], v[64:67], v[224:227]
  ds_read_b64_tr_b16 v[76:77], v6 offset:5152
  v_mfma_f32_16x16x32_bf16 v[228:231], v[36:39], v[64:67], v[228:231]
  ds_read_b64_tr_b16 v[78:79], v6 offset:6432
  v_mfma_f32_16x16x32_bf16 v[232:235], v[40:43], v[64:67], v[232:235]
  v_mfma_f32_16x16x32_bf16 v[236:239], v[44:47], v[64:67], v[236:239]
  s_waitcnt lgkmcnt(6)
  v_mfma_f32_16x16x32_bf16 v[252:255], v[44:47], v[68:71], v[252:255]
  ds_read_b64_tr_b16 v[64:65], v6 offset:5184
  v_mfma_f32_16x16x32_bf16 v[248:251], v[40:43], v[68:71], v[248:251]
  ds_read_b64_tr_b16 v[66:67], v6 offset:6464
  v_mfma_f32_16x16x32_bf16 v[244:247], v[36:39], v[68:71], v[244:247]
  v_mfma_f32_16x16x32_bf16 v[240:243], v[32:35], v[68:71], v[240:243]
  s_waitcnt lgkmcnt(5)
  v_mfma_f32_16x16x32_bf16 v[96:99], v[48:51], v[72:75], v[96:99]
  ds_read_b64_tr_b16 v[68:69], v6 offset:5216
  v_mfma_f32_16x16x32_bf16 v[100:103], v[52:55], v[72:75], v[100:103]
  ds_read_b64_tr_b16 v[70:71], v6 offset:6496
  v_mfma_f32_16x16x32_bf16 v[104:107], v[56:59], v[72:75], v[104:107]
  s_waitcnt lgkmcnt(6)
  v_mfma_f32_16x16x32_bf16 v[108:111], v[60:63], v[72:75], v[108:111]
  s_waitcnt lgkmcnt(4)
  v_mfma_f32_16x16x32_bf16 v[124:127], v[60:63], v[76:79], v[124:127]
  ds_read_b64_tr_b16 v[72:73], v6 offset:5248
  v_mfma_f32_16x16x32_bf16 v[120:123], v[56:59], v[76:79], v[120:123]
  ds_read_b64_tr_b16 v[74:75], v6 offset:6528
  v_mfma_f32_16x16x32_bf16 v[116:119], v[52:55], v[76:79], v[116:119]
  v_mfma_f32_16x16x32_bf16 v[112:115], v[48:51], v[76:79], v[112:115]
  s_waitcnt lgkmcnt(4)
  v_mfma_f32_16x16x32_bf16 v[128:131], v[48:51], v[64:67], v[128:131]
  ds_read_b64_tr_b16 v[76:77], v6 offset:15360
  v_mfma_f32_16x16x32_bf16 v[132:135], v[52:55], v[64:67], v[132:135]
  ds_read_b64_tr_b16 v[78:79], v6 offset:16640
  v_mfma_f32_16x16x32_bf16 v[136:139], v[56:59], v[64:67], v[136:139]
  v_mfma_f32_16x16x32_bf16 v[140:143], v[60:63], v[64:67], v[140:143]
  s_waitcnt lgkmcnt(4)
  v_mfma_f32_16x16x32_bf16 v[156:159], v[60:63], v[68:71], v[156:159]
  ds_read_b64_tr_b16 v[64:65], v6 offset:15392
  v_mfma_f32_16x16x32_bf16 v[152:155], v[56:59], v[68:71], v[152:155]
  ds_read_b64_tr_b16 v[66:67], v6 offset:16672
  v_mfma_f32_16x16x32_bf16 v[148:151], v[52:55], v[68:71], v[148:151]
  v_mfma_f32_16x16x32_bf16 v[144:147], v[48:51], v[68:71], v[144:147]
  s_waitcnt lgkmcnt(4)
  v_mfma_f32_16x16x32_bf16 v[160:163], v[48:51], v[72:75], v[160:163]
  ds_read_b64_tr_b16 v[68:69], v6 offset:15424
  v_mfma_f32_16x16x32_bf16 v[164:167], v[52:55], v[72:75], v[164:167]
  ds_read_b64_tr_b16 v[70:71], v6 offset:16704
  v_mfma_f32_16x16x32_bf16 v[168:171], v[56:59], v[72:75], v[168:171]
  v_mfma_f32_16x16x32_bf16 v[172:175], v[60:63], v[72:75], v[172:175]
  s_waitcnt lgkmcnt(4)
  v_mfma_f32_16x16x32_bf16 v[188:191], v[60:63], v[76:79], v[188:191]
  ds_read_b64_tr_b16 v[72:73], v6 offset:15456
  v_mfma_f32_16x16x32_bf16 v[184:187], v[56:59], v[76:79], v[184:187]
  ds_read_b64_tr_b16 v[74:75], v6 offset:16736
  v_mfma_f32_16x16x32_bf16 v[180:183], v[52:55], v[76:79], v[180:183]
  v_mfma_f32_16x16x32_bf16 v[176:179], v[48:51], v[76:79], v[176:179]
  s_waitcnt lgkmcnt(4)
  v_mfma_f32_16x16x32_bf16 v[192:195], v[48:51], v[64:67], v[192:195]
  ds_read_b64_tr_b16 v[76:77], v6 offset:15488
  v_mfma_f32_16x16x32_bf16 v[196:199], v[52:55], v[64:67], v[196:199]
  ds_read_b64_tr_b16 v[78:79], v6 offset:16768
  v_mfma_f32_16x16x32_bf16 v[200:203], v[56:59], v[64:67], v[200:203]
  v_mfma_f32_16x16x32_bf16 v[204:207], v[60:63], v[64:67], v[204:207]
  s_waitcnt lgkmcnt(4)
  v_mfma_f32_16x16x32_bf16 v[220:223], v[60:63], v[68:71], v[220:223]
  v_mfma_f32_16x16x32_bf16 v[216:219], v[56:59], v[68:71], v[216:219]
  v_mfma_f32_16x16x32_bf16 v[212:215], v[52:55], v[68:71], v[212:215]
  v_mfma_f32_16x16x32_bf16 v[208:211], v[48:51], v[68:71], v[208:211]
  s_waitcnt lgkmcnt(0)
  s_barrier
  v_add_u32 v4, s35, v2
  v_add_u32 v6, s35, v3
  v_xor_b32 v5, 64, v4
  s_add_u32 s35, s35, 53248
  s_cmp_eq_u32 s35, 159744
  s_cselect_b32 s35, 0, s35
  v_mfma_f32_16x16x32_bf16 v[224:227], v[48:51], v[72:75], v[224:227]
  ds_read_b128 v[32:35], v4 offset:0
  v_mfma_f32_16x16x32_bf16 v[228:231], v[52:55], v[72:75], v[228:231]
  ds_read_b128 v[36:39], v4 offset:2048
  v_mfma_f32_16x16x32_bf16 v[232:235], v[56:59], v[72:75], v[232:235]
  ds_read_b64_tr_b16 v[64:65], v6 offset:0
  v_mfma_f32_16x16x32_bf16 v[236:239], v[60:63], v[72:75], v[236:239]
  ds_read_b64_tr_b16 v[66:67], v6 offset:1280
  v_mfma_f32_16x16x32_bf16 v[252:255], v[60:63], v[76:79], v[252:255]
  ds_read_b128 v[40:43], v4 offset:4096
  v_mfma_f32_16x16x32_bf16 v[248:251], v[56:59], v[76:79], v[248:251]
  ds_read_b128 v[44:47], v4 offset:6144
  v_mfma_f32_16x16x32_bf16 v[244:247], v[52:55], v[76:79], v[244:247]
  ds_read_b64_tr_b16 v[68:69], v6 offset:32
  v_mfma_f32_16x16x32_bf16 v[240:243], v[48:51], v[76:79], v[240:243]
  ds_read_b64_tr_b16 v[70:71], v6 offset:1312
  s_sub_u32 s36, s36, 1
  s_cmp_lg_u32 s36, 0
  s_cbranch_scc1 L_cloopN_ns
  s_waitcnt lgkmcnt(0)
L_ns_done:
  s_barrier
  s_lshl_b32 s37, s28, 8
  v_lshlrev_b32 v11, 4, v10
  v_add_u32 v11, s37, v11
  v_add_u32 v11, 159744, v11
  v_lshlrev_b32 v12, 2, v9
  v_add_u32 v12, 161792, v12
  ds_read_b128 v[16:19], v11
  ds_read_b128 v[32:35], v11 offset:1024
  ds_read_b32 v48, v12 offset:0
  ds_read_b32 v49, v12 offset:64
  ds_read_b32 v50, v12 offset:128
  ds_read_b32 v51, v12 offset:192
  ds_read_b32 v52, v12 offset:256
  ds_read_b32 v53, v12 offset:320
  ds_read_b32 v54, v12 offset:384
  ds_read_b32 v55, v12 offset:448
  ds_read_b32 v56, v12 offset:512
  ds_read_b32 v57, v12 offset:576
  s_waitcnt lgkmcnt(6)
  ds_read_b128 v[20:23], v11 offset:64
  ds_read_b128 v[36:39], v11 offset:1088
  ds_read_b128 v[24:27], v11 offset:128
  ds_read_b128 v[40:43], v11 offset:1152
  ds_read_b128 v[28:31], v11 offset:192
  ds_read_b128 v[44:47], v11 offset:1216
  s_waitcnt lgkmcnt(6)
L_kv_b0:
  v_pk_fma_f32 v[96:97], v[16:17], v[48:49], v[96:97] op_sel:[0,0,0] op_sel_hi:[1,0,1] neg_lo:[0,1,0] neg_hi:[0,1,0]
  v_pk_fma_f32 v[98:99], v[18:19], v[48:49], v[98:99] op_sel:[0,0,0] op_sel_hi:[1,0,1] neg_lo:[0,1,0] neg_hi:[0,1,0]
  v_pk_fma_f32 v[112:113], v[16:17], v[48:49], v[112:113] op_sel:[0,1,0] op_sel_hi:[1,1,1] neg_lo:[0,1,0] neg_hi:[0,1,0]
  v_pk_fma_f32 v[114:115], v[18:19], v[48:49], v[114:115] op_sel:[0,1,0] op_sel_hi:[1,1,1] neg_lo:[0,1,0] neg_hi:[0,1,0]
  v_pk_fma_f32 v[128:129], v[16:17], v[50:51], v[128:129] op_sel:[0,0,0] op_sel_hi:[1,0,1] neg_lo:[0,1,0] neg_hi:[0,1,0]
  v_pk_fma_f32 v[130:131], v[18:19], v[50:51], v[130:131] op_sel:[0,0,0] op_sel_hi:[1,0,1] neg_lo:[0,1,0] neg_hi:[0,1,0]
  v_pk_fma_f32 v[144:145], v[16:17], v[50:51], v[144:145] op_sel:[0,1,0] op_sel_hi:[1,1,1] neg_lo:[0,1,0] neg_hi:[0,1,0]
  v_pk_fma_f32 v[146:147], v[18:19], v[50:51], v[146:147] op_sel:[0,1,0] op_sel_hi:[1,1,1] neg_lo:[0,1,0] neg_hi:[0,1,0]
  v_pk_fma_f32 v[160:161], v[16:17], v[52:53], v[160:161] op_sel:[0,0,0] op_sel_hi:[1,0,1] neg_lo:[0,1,0] neg_hi:[0,1,0]
  v_pk_fma_f32 v[162:163], v[18:19], v[52:53], v[162:163] op_sel:[0,0,0] op_sel_hi:[1,0,1] neg_lo:[0,1,0] neg_hi:[0,1,0]
  v_pk_fma_f32 v[176:177], v[16:17], v[52:53], v[176:177] op_sel:[0,1,0] op_sel_hi:[1,1,1] neg_lo:[0,1,0] neg_hi:[0,1,0]
  v_pk_fma_f32 v[178:179], v[18:19], v[52:53], v[178:179] op_sel:[0,1,0] op_sel_hi:[1,1,1] neg_lo:[0,1,0] neg_hi:[0,1,0]
  v_pk_fma_f32 v[192:193], v[16:17], v[54:55], v[192:193] op_sel:[0,0,0] op_sel_hi:[1,0,1] neg_lo:[0,1,0] neg_hi:[0,1,0]
  v_pk_fma_f32 v[194:195], v[18:19], v[54:55], v[194:195] op_sel:[0,0,0] op_sel_hi:[1,0,1] neg_lo:[0,1,0] neg_hi:[0,1,0]
  v_pk_fma_f32 v[208:209], v[16:17], v[54:55], v[208:209] op_sel:[0,1,0] op_sel_hi:[1,1,1] neg_lo:[0,1,0] neg_hi:[0,1,0]
  v_pk_fma_f32 v[210:211], v[18:19], v[54:55], v[210:211] op_sel:[0,1,0] op_sel_hi:[1,1,1] neg_lo:[0,1,0] neg_hi:[0,1,0]
  v_pk_fma_f32 v[224:225], v[16:17], v[56:57], v[224:225] op_sel:[0,0,0] op_sel_hi:[1,0,1] neg_lo:[0,1,0] neg_hi:[0,1,0]
  v_pk_fma_f32 v[226:227], v[18:19], v[56:57], v[226:227] op_sel:[0,0,0] op_sel_hi:[1,0,1] neg_lo:[0,1,0] neg_hi:[0,1,0]
  v_pk_fma_f32 v[240:241], v[16:17], v[56:57], v[240:241] op_sel:[0,1,0] op_sel_hi:[1,1,1] neg_lo:[0,1,0] neg_hi:[0,1,0]
  v_pk_fma_f32 v[242:243], v[18:19], v[56:57], v[242:243] op_sel:[0,1,0] op_sel_hi:[1,1,1] neg_lo:[0,1,0] neg_hi:[0,1,0]
  v_pk_fma_f32 v[96:97], v[96:97], v[32:33], s[40:41]
  v_pk_fma_f32 v[98:99], v[98:99], v[34:35], s[40:41]
  v_pk_fma_f32 v[112:113], v[112:113], v[32:33], s[40:41]
  v_pk_fma_f32 v[114:115], v[114:115], v[34:35], s[40:41]
  v_pk_fma_f32 v[128:129], v[128:129], v[32:33], s[40:41]
  v_pk_fma_f32 v[130:131], v[130:131], v[34:35], s[40:41]
  v_pk_fma_f32 v[144:145], v[144:145], v[32:33], s[40:41]
  v_pk_fma_f32 v[146:147], v[146:147], v[34:35], s[40:41]
  v_pk_fma_f32 v[160:161], v[160:161], v[32:33], s[40:41]
  v_pk_fma_f32 v[162:163], v[162:163], v[34:35], s[40:41]
  v_pk_mul_f32 v[176:177], v[176:177], v[32:33]
  v_pk_mul_f32 v[178:179], v[178:179], v[34:35]
  v_pk_mul_f32 v[192:193], v[192:193], v[32:33]
  v_pk_mul_f32 v[194:195], v[194:195], v[34:35]
  v_pk_mul_f32 v[208:209], v[208:209], v[32:33]
  v_pk_mul_f32 v[210:211], v[210:211], v[34:35]
  v_pk_mul_f32 v[224:225], v[224:225], v[32:33]
  v_pk_mul_f32 v[226:227], v[226:227], v[34:35]
  v_pk_mul_f32 v[240:241], v[240:241], v[32:33]
  v_pk_mul_f32 v[242:243], v[242:243], v[34:35]
  v_pk_mul_f32 v[60:61], v[96:97], s[42:43]
  v_pk_mul_f32 v[62:63], v[98:99], s[42:43]
  v_pk_mul_f32 v[64:65], v[112:113], s[42:43]
  v_pk_mul_f32 v[66:67], v[114:115], s[42:43]
  v_pk_mul_f32 v[68:69], v[128:129], s[42:43]
  v_pk_mul_f32 v[70:71], v[130:131], s[42:43]
  v_pk_mul_f32 v[72:73], v[144:145], s[42:43]
  v_pk_mul_f32 v[74:75], v[146:147], s[42:43]
  v_pk_mul_f32 v[76:77], v[160:161], s[42:43]
  v_pk_mul_f32 v[78:79], v[162:163], s[42:43]
  v_exp_f32_e64 v60, v60 clamp
  v_exp_f32_e64 v61, v61 clamp
  v_exp_f32_e64 v62, v62 clamp
  v_exp_f32_e64 v63, v63 clamp
  v_exp_f32_e64 v64, v64 clamp
  v_exp_f32_e64 v65, v65 clamp
  v_exp_f32_e64 v66, v66 clamp
  v_exp_f32_e64 v67, v67 clamp
  v_exp_f32_e64 v68, v68 clamp
  v_exp_f32_e64 v69, v69 clamp
  v_exp_f32_e64 v70, v70 clamp
  v_exp_f32_e64 v71, v71 clamp
  v_exp_f32_e64 v72, v72 clamp
  v_exp_f32_e64 v73, v73 clamp
  v_exp_f32_e64 v74, v74 clamp
  v_exp_f32_e64 v75, v75 clamp
  v_exp_f32_e64 v76, v76 clamp
  v_exp_f32_e64 v77, v77 clamp
  v_exp_f32_e64 v78, v78 clamp
  v_exp_f32_e64 v79, v79 clamp
  v_max_f32 v96, s40, v96
  v_max_f32 v97, s40, v97
  v_max_f32 v98, s40, v98
  v_max_f32 v99, s40, v99
  v_max_f32 v112, s40, v112
  v_max_f32 v113, s40, v113
  v_max_f32 v114, s40, v114
  v_max_f32 v115, s40, v115
  v_max_f32 v128, s40, v128
  v_max_f32 v129, s40, v129
  v_max_f32 v130, s40, v130
  v_max_f32 v131, s40, v131
  v_max_f32 v144, s40, v144
  v_max_f32 v145, s40, v145
  v_max_f32 v146, s40, v146
  v_max_f32 v147, s40, v147
  v_max_f32 v160, s40, v160
  v_max_f32 v161, s40, v161
  v_max_f32 v162, s40, v162
  v_max_f32 v163, s40, v163
  v_pk_add_f32 v[96:97], v[96:97], v[60:61]
  v_pk_add_f32 v[98:99], v[98:99], v[62:63]
  v_pk_add_f32 v[112:113], v[112:113], v[64:65]
  v_pk_add_f32 v[114:115], v[114:115], v[66:67]
  v_pk_add_f32 v[128:129], v[128:129], v[68:69]
  v_pk_add_f32 v[130:131], v[130:131], v[70:71]
  v_pk_add_f32 v[144:145], v[144:145], v[72:73]
  v_pk_add_f32 v[146:147], v[146:147], v[74:75]
  v_pk_add_f32 v[160:161], v[160:161], v[76:77]
  v_pk_add_f32 v[162:163], v[162:163], v[78:79]
  v_cvt_pk_bf16_f32 v96, v96, v97
  v_cvt_pk_bf16_f32 v97, v98, v99
  v_cvt_pk_bf16_f32 v112, v112, v113
  v_cvt_pk_bf16_f32 v113, v114, v115
  v_cvt_pk_bf16_f32 v128, v128, v129
  v_cvt_pk_bf16_f32 v129, v130, v131
  v_cvt_pk_bf16_f32 v144, v144, v145
  v_cvt_pk_bf16_f32 v145, v146, v147
  v_cvt_pk_bf16_f32 v160, v160, v161
  v_cvt_pk_bf16_f32 v161, v162, v163
  v_cvt_pk_bf16_f32 v176, v176, v177
  v_cvt_pk_bf16_f32 v177, v178, v179
  v_cvt_pk_bf16_f32 v192, v192, v193
  v_cvt_pk_bf16_f32 v193, v194, v195
  v_cvt_pk_bf16_f32 v208, v208, v209
  v_cvt_pk_bf16_f32 v209, v210, v211
  v_cvt_pk_bf16_f32 v224, v224, v225
  v_cvt_pk_bf16_f32 v225, v226, v227
  v_cvt_pk_bf16_f32 v240, v240, v241
  v_cvt_pk_bf16_f32 v241, v242, v243
  s_cbranch_execz L_dry_ret
L_kv_b1:
  s_waitcnt lgkmcnt(0)
  v_pk_fma_f32 v[100:101], v[20:21], v[48:49], v[100:101] op_sel:[0,0,0] op_sel_hi:[1,0,1] neg_lo:[0,1,0] neg_hi:[0,1,0]
  v_pk_fma_f32 v[102:103], v[22:23], v[48:49], v[102:103] op_sel:[0,0,0] op_sel_hi:[1,0,1] neg_lo:[0,1,0] neg_hi:[0,1,0]
  v_pk_fma_f32 v[116:117], v[20:21], v[48:49], v[116:117] op_sel:[0,1,0] op_sel_hi:[1,1,1] neg_lo:[0,1,0] neg_hi:[0,1,0]
  v_pk_fma_f32 v[118:119], v[22:23], v[48:49], v[118:119] op_sel:[0,1,0] op_sel_hi:[1,1,1] neg_lo:[0,1,0] neg_hi:[0,1,0]
  v_pk_fma_f32 v[132:133], v[20:21], v[50:51], v[132:133] op_sel:[0,0,0] op_sel_hi:[1,0,1] neg_lo:[0,1,0] neg_hi:[0,1,0]
  v_pk_fma_f32 v[134:135], v[22:23], v[50:51], v[134:135] op_sel:[0,0,0] op_sel_hi:[1,0,1] neg_lo:[0,1,0] neg_hi:[0,1,0]
  v_pk_fma_f32 v[148:149], v[20:21], v[50:51], v[148:149] op_sel:[0,1,0] op_sel_hi:[1,1,1] neg_lo:[0,1,0] neg_hi:[0,1,0]
  v_pk_fma_f32 v[150:151], v[22:23], v[50:51], v[150:151] op_sel:[0,1,0] op_sel_hi:[1,1,1] neg_lo:[0,1,0] neg_hi:[0,1,0]
  v_pk_fma_f32 v[164:165], v[20:21], v[52:53], v[164:165] op_sel:[0,0,0] op_sel_hi:[1,0,1] neg_lo:[0,1,0] neg_hi:[0,1,0]
  v_pk_fma_f32 v[166:167], v[22:23], v[52:53], v[166:167] op_sel:[0,0,0] op_sel_hi:[1,0,1] neg_lo:[0,1,0] neg_hi:[0,1,0]
  v_pk_fma_f32 v[180:181], v[20:21], v[52:53], v[180:181] op_sel:[0,1,0] op_sel_hi:[1,1,1] neg_lo:[0,1,0] neg_hi:[0,1,0]
  v_pk_fma_f32 v[182:183], v[22:23], v[52:53], v[182:183] op_sel:[0,1,0] op_sel_hi:[1,1,1] neg_lo:[0,1,0] neg_hi:[0,1,0]
  v_pk_fma_f32 v[196:197], v[20:21], v[54:55], v[196:197] op_sel:[0,0,0] op_sel_hi:[1,0,1] neg_lo:[0,1,0] neg_hi:[0,1,0]
  v_pk_fma_f32 v[198:199], v[22:23], v[54:55], v[198:199] op_sel:[0,0,0] op_sel_hi:[1,0,1] neg_lo:[0,1,0] neg_hi:[0,1,0]
  v_pk_fma_f32 v[212:213], v[20:21], v[54:55], v[212:213] op_sel:[0,1,0] op_sel_hi:[1,1,1] neg_lo:[0,1,0] neg_hi:[0,1,0]
  v_pk_fma_f32 v[214:215], v[22:23], v[54:55], v[214:215] op_sel:[0,1,0] op_sel_hi:[1,1,1] neg_lo:[0,1,0] neg_hi:[0,1,0]
  v_pk_fma_f32 v[228:229], v[20:21], v[56:57], v[228:229] op_sel:[0,0,0] op_sel_hi:[1,0,1] neg_lo:[0,1,0] neg_hi:[0,1,0]
  v_pk_fma_f32 v[230:231], v[22:23], v[56:57], v[230:231] op_sel:[0,0,0] op_sel_hi:[1,0,1] neg_lo:[0,1,0] neg_hi:[0,1,0]
  v_pk_fma_f32 v[244:245], v[20:21], v[56:57], v[244:245] op_sel:[0,1,0] op_sel_hi:[1,1,1] neg_lo:[0,1,0] neg_hi:[0,1,0]
  v_pk_fma_f32 v[246:247], v[22:23], v[56:57], v[246:247] op_sel:[0,1,0] op_sel_hi:[1,1,1] neg_lo:[0,1,0] neg_hi:[0,1,0]
  v_pk_fma_f32 v[100:101], v[100:101], v[36:37], s[40:41]
  v_pk_fma_f32 v[102:103], v[102:103], v[38:39], s[40:41]
  v_pk_fma_f32 v[116:117], v[116:117], v[36:37], s[40:41]
  v_pk_fma_f32 v[118:119], v[118:119], v[38:39], s[40:41]
  v_pk_fma_f32 v[132:133], v[132:133], v[36:37], s[40:41]
  v_pk_fma_f32 v[134:135], v[134:135], v[38:39], s[40:41]
  v_pk_fma_f32 v[148:149], v[148:149], v[36:37], s[40:41]
  v_pk_fma_f32 v[150:151], v[150:151], v[38:39], s[40:41]
  v_pk_fma_f32 v[164:165], v[164:165], v[36:37], s[40:41]
  v_pk_fma_f32 v[166:167], v[166:167], v[38:39], s[40:41]
  v_pk_mul_f32 v[180:181], v[180:181], v[36:37]
  v_pk_mul_f32 v[182:183], v[182:183], v[38:39]
  v_pk_mul_f32 v[196:197], v[196:197], v[36:37]
  v_pk_mul_f32 v[198:199], v[198:199], v[38:39]
  v_pk_mul_f32 v[212:213], v[212:213], v[36:37]
  v_pk_mul_f32 v[214:215], v[214:215], v[38:39]
  v_pk_mul_f32 v[228:229], v[228:229], v[36:37]
  v_pk_mul_f32 v[230:231], v[230:231], v[38:39]
  v_pk_mul_f32 v[244:245], v[244:245], v[36:37]
  v_pk_mul_f32 v[246:247], v[246:247], v[38:39]
  v_pk_mul_f32 v[60:61], v[100:101], s[42:43]
  v_pk_mul_f32 v[62:63], v[102:103], s[42:43]
  v_pk_mul_f32 v[64:65], v[116:117], s[42:43]
  v_pk_mul_f32 v[66:67], v[118:119], s[42:43]
  v_pk_mul_f32 v[68:69], v[132:133], s[42:43]
  v_pk_mul_f32 v[70:71], v[134:135], s[42:43]
  v_pk_mul_f32 v[72:73], v[148:149], s[42:43]
  v_pk_mul_f32 v[74:75], v[150:151], s[42:43]
  v_pk_mul_f32 v[76:77], v[164:165], s[42:43]
  v_pk_mul_f32 v[78:79], v[166:167], s[42:43]
  v_exp_f32_e64 v60, v60 clamp
  v_exp_f32_e64 v61, v61 clamp
  v_exp_f32_e64 v62, v62 clamp
  v_exp_f32_e64 v63, v63 clamp
  v_exp_f32_e64 v64, v64 clamp
  v_exp_f32_e64 v65, v65 clamp
  v_exp_f32_e64 v66, v66 clamp
  v_exp_f32_e64 v67, v67 clamp
  v_exp_f32_e64 v68, v68 clamp
  v_exp_f32_e64 v69, v69 clamp
  v_exp_f32_e64 v70, v70 clamp
  v_exp_f32_e64 v71, v71 clamp
  v_exp_f32_e64 v72, v72 clamp
  v_exp_f32_e64 v73, v73 clamp
  v_exp_f32_e64 v74, v74 clamp
  v_exp_f32_e64 v75, v75 clamp
  v_exp_f32_e64 v76, v76 clamp
  v_exp_f32_e64 v77, v77 clamp
  v_exp_f32_e64 v78, v78 clamp
  v_exp_f32_e64 v79, v79 clamp
  v_max_f32 v100, s40, v100
  v_max_f32 v101, s40, v101
  v_max_f32 v102, s40, v102
  v_max_f32 v103, s40, v103
  v_max_f32 v116, s40, v116
  v_max_f32 v117, s40, v117
  v_max_f32 v118, s40, v118
  v_max_f32 v119, s40, v119
  v_max_f32 v132, s40, v132
  v_max_f32 v133, s40, v133
  v_max_f32 v134, s40, v134
  v_max_f32 v135, s40, v135
  v_max_f32 v148, s40, v148
  v_max_f32 v149, s40, v149
  v_max_f32 v150, s40, v150
  v_max_f32 v151, s40, v151
  v_max_f32 v164, s40, v164
  v_max_f32 v165, s40, v165
  v_max_f32 v166, s40, v166
  v_max_f32 v167, s40, v167
  v_pk_add_f32 v[100:101], v[100:101], v[60:61]
  v_pk_add_f32 v[102:103], v[102:103], v[62:63]
  v_pk_add_f32 v[116:117], v[116:117], v[64:65]
  v_pk_add_f32 v[118:119], v[118:119], v[66:67]
  v_pk_add_f32 v[132:133], v[132:133], v[68:69]
  v_pk_add_f32 v[134:135], v[134:135], v[70:71]
  v_pk_add_f32 v[148:149], v[148:149], v[72:73]
  v_pk_add_f32 v[150:151], v[150:151], v[74:75]
  v_pk_add_f32 v[164:165], v[164:165], v[76:77]
  v_pk_add_f32 v[166:167], v[166:167], v[78:79]
  v_cvt_pk_bf16_f32 v98, v100, v101
  v_cvt_pk_bf16_f32 v99, v102, v103
  v_cvt_pk_bf16_f32 v114, v116, v117
  v_cvt_pk_bf16_f32 v115, v118, v119
  v_cvt_pk_bf16_f32 v130, v132, v133
  v_cvt_pk_bf16_f32 v131, v134, v135
  v_cvt_pk_bf16_f32 v146, v148, v149
  v_cvt_pk_bf16_f32 v147, v150, v151
  v_cvt_pk_bf16_f32 v162, v164, v165
  v_cvt_pk_bf16_f32 v163, v166, v167
  v_cvt_pk_bf16_f32 v178, v180, v181
  v_cvt_pk_bf16_f32 v179, v182, v183
  v_cvt_pk_bf16_f32 v194, v196, v197
  v_cvt_pk_bf16_f32 v195, v198, v199
  v_cvt_pk_bf16_f32 v210, v212, v213
  v_cvt_pk_bf16_f32 v211, v214, v215
  v_cvt_pk_bf16_f32 v226, v228, v229
  v_cvt_pk_bf16_f32 v227, v230, v231
  v_cvt_pk_bf16_f32 v242, v244, v245
  v_cvt_pk_bf16_f32 v243, v246, v247
  s_cbranch_execz L_dry_ret
L_kv_b2:
  v_pk_fma_f32 v[104:105], v[24:25], v[48:49], v[104:105] op_sel:[0,0,0] op_sel_hi:[1,0,1] neg_lo:[0,1,0] neg_hi:[0,1,0]
  v_pk_fma_f32 v[106:107], v[26:27], v[48:49], v[106:107] op_sel:[0,0,0] op_sel_hi:[1,0,1] neg_lo:[0,1,0] neg_hi:[0,1,0]
  v_pk_fma_f32 v[120:121], v[24:25], v[48:49], v[120:121] op_sel:[0,1,0] op_sel_hi:[1,1,1] neg_lo:[0,1,0] neg_hi:[0,1,0]
  v_pk_fma_f32 v[122:123], v[26:27], v[48:49], v[122:123] op_sel:[0,1,0] op_sel_hi:[1,1,1] neg_lo:[0,1,0] neg_hi:[0,1,0]
  v_pk_fma_f32 v[136:137], v[24:25], v[50:51], v[136:137] op_sel:[0,0,0] op_sel_hi:[1,0,1] neg_lo:[0,1,0] neg_hi:[0,1,0]
  v_pk_fma_f32 v[138:139], v[26:27], v[50:51], v[138:139] op_sel:[0,0,0] op_sel_hi:[1,0,1] neg_lo:[0,1,0] neg_hi:[0,1,0]
  v_pk_fma_f32 v[152:153], v[24:25], v[50:51], v[152:153] op_sel:[0,1,0] op_sel_hi:[1,1,1] neg_lo:[0,1,0] neg_hi:[0,1,0]
  v_pk_fma_f32 v[154:155], v[26:27], v[50:51], v[154:155] op_sel:[0,1,0] op_sel_hi:[1,1,1] neg_lo:[0,1,0] neg_hi:[0,1,0]
  v_pk_fma_f32 v[168:169], v[24:25], v[52:53], v[168:169] op_sel:[0,0,0] op_sel_hi:[1,0,1] neg_lo:[0,1,0] neg_hi:[0,1,0]
  v_pk_fma_f32 v[170:171], v[26:27], v[52:53], v[170:171] op_sel:[0,0,0] op_sel_hi:[1,0,1] neg_lo:[0,1,0] neg_hi:[0,1,0]
  v_pk_fma_f32 v[184:185], v[24:25], v[52:53], v[184:185] op_sel:[0,1,0] op_sel_hi:[1,1,1] neg_lo:[0,1,0] neg_hi:[0,1,0]
  v_pk_fma_f32 v[186:187], v[26:27], v[52:53], v[186:187] op_sel:[0,1,0] op_sel_hi:[1,1,1] neg_lo:[0,1,0] neg_hi:[0,1,0]
  v_pk_fma_f32 v[200:201], v[24:25], v[54:55], v[200:201] op_sel:[0,0,0] op_sel_hi:[1,0,1] neg_lo:[0,1,0] neg_hi:[0,1,0]
  v_pk_fma_f32 v[202:203], v[26:27], v[54:55], v[202:203] op_sel:[0,0,0] op_sel_hi:[1,0,1] neg_lo:[0,1,0] neg_hi:[0,1,0]
  v_pk_fma_f32 v[216:217], v[24:25], v[54:55], v[216:217] op_sel:[0,1,0] op_sel_hi:[1,1,1] neg_lo:[0,1,0] neg_hi:[0,1,0]
  v_pk_fma_f32 v[218:219], v[26:27], v[54:55], v[218:219] op_sel:[0,1,0] op_sel_hi:[1,1,1] neg_lo:[0,1,0] neg_hi:[0,1,0]
  v_pk_fma_f32 v[232:233], v[24:25], v[56:57], v[232:233] op_sel:[0,0,0] op_sel_hi:[1,0,1] neg_lo:[0,1,0] neg_hi:[0,1,0]
  v_pk_fma_f32 v[234:235], v[26:27], v[56:57], v[234:235] op_sel:[0,0,0] op_sel_hi:[1,0,1] neg_lo:[0,1,0] neg_hi:[0,1,0]
  v_pk_fma_f32 v[248:249], v[24:25], v[56:57], v[248:249] op_sel:[0,1,0] op_sel_hi:[1,1,1] neg_lo:[0,1,0] neg_hi:[0,1,0]
  v_pk_fma_f32 v[250:251], v[26:27], v[56:57], v[250:251] op_sel:[0,1,0] op_sel_hi:[1,1,1] neg_lo:[0,1,0] neg_hi:[0,1,0]
  v_pk_fma_f32 v[104:105], v[104:105], v[40:41], s[40:41]
  v_pk_fma_f32 v[106:107], v[106:107], v[42:43], s[40:41]
  v_pk_fma_f32 v[120:121], v[120:121], v[40:41], s[40:41]
  v_pk_fma_f32 v[122:123], v[122:123], v[42:43], s[40:41]
  v_pk_fma_f32 v[136:137], v[136:137], v[40:41], s[40:41]
  v_pk_fma_f32 v[138:139], v[138:139], v[42:43], s[40:41]
  v_pk_fma_f32 v[152:153], v[152:153], v[40:41], s[40:41]
  v_pk_fma_f32 v[154:155], v[154:155], v[42:43], s[40:41]
  v_pk_fma_f32 v[168:169], v[168:169], v[40:41], s[40:41]
  v_pk_fma_f32 v[170:171], v[170:171], v[42:43], s[40:41]
  v_pk_mul_f32 v[184:185], v[184:185], v[40:41]
  v_pk_mul_f32 v[186:187], v[186:187], v[42:43]
  v_pk_mul_f32 v[200:201], v[200:201], v[40:41]
  v_pk_mul_f32 v[202:203], v[202:203], v[42:43]
  v_pk_mul_f32 v[216:217], v[216:217], v[40:41]
  v_pk_mul_f32 v[218:219], v[218:219], v[42:43]
  v_pk_mul_f32 v[232:233], v[232:233], v[40:41]
  v_pk_mul_f32 v[234:235], v[234:235], v[42:43]
  v_pk_mul_f32 v[248:249], v[248:249], v[40:41]
  v_pk_mul_f32 v[250:251], v[250:251], v[42:43]
  v_pk_mul_f32 v[60:61], v[104:105], s[42:43]
  v_pk_mul_f32 v[62:63], v[106:107], s[42:43]
  v_pk_mul_f32 v[64:65], v[120:121], s[42:43]
  v_pk_mul_f32 v[66:67], v[122:123], s[42:43]
  v_pk_mul_f32 v[68:69], v[136:137], s[42:43]
  v_pk_mul_f32 v[70:71], v[138:139], s[42:43]
  v_pk_mul_f32 v[72:73], v[152:153], s[42:43]
  v_pk_mul_f32 v[74:75], v[154:155], s[42:43]
  v_pk_mul_f32 v[76:77], v[168:169], s[42:43]
  v_pk_mul_f32 v[78:79], v[170:171], s[42:43]
  v_exp_f32_e64 v60, v60 clamp
  v_exp_f32_e64 v61, v61 clamp
  v_exp_f32_e64 v62, v62 clamp
  v_mfma_f32_16x16x32_bf16 v[100:103], v[176:179], v[96:99], 0
  v_exp_f32_e64 v63, v63 clamp
  v_exp_f32_e64 v64, v64 clamp
  v_exp_f32_e64 v65, v65 clamp
  v_mfma_f32_16x16x32_bf16 v[116:119], v[176:179], v[112:115], 0
  v_exp_f32_e64 v66, v66 clamp
  v_exp_f32_e64 v67, v67 clamp
  v_exp_f32_e64 v68, v68 clamp
  v_mfma_f32_16x16x32_bf16 v[132:135], v[192:195], v[96:99], 0
  v_exp_f32_e64 v69, v69 clamp
  v_exp_f32_e64 v70, v70 clamp
  v_exp_f32_e64 v71, v71 clamp
  v_mfma_f32_16x16x32_bf16 v[148:151], v[192:195], v[112:115], 0
  v_exp_f32_e64 v72, v72 clamp
  v_exp_f32_e64 v73, v73 clamp
  v_exp_f32_e64 v74, v74 clamp
  v_mfma_f32_16x16x32_bf16 v[164:167], v[192:195], v[128:131], 0
  v_exp_f32_e64 v75, v75 clamp
  v_exp_f32_e64 v76, v76 clamp
  v_exp_f32_e64 v77, v77 clamp
  v_mfma_f32_16x16x32_bf16 v[180:183], v[208:211], v[112:115], 0
  v_exp_f32_e64 v78, v78 clamp
  v_exp_f32_e64 v79, v79 clamp
  v_max_f32 v104, s40, v104
  v_mfma_f32_16x16x32_bf16 v[196:199], v[208:211], v[128:131], 0
  v_max_f32 v105, s40, v105
  v_max_f32 v106, s40, v106
  v_max_f32 v107, s40, v107
  v_mfma_f32_16x16x32_bf16 v[212:215], v[208:211], v[144:147], 0
  v_max_f32 v120, s40, v120
  v_max_f32 v121, s40, v121
  v_max_f32 v122, s40, v122
  v_mfma_f32_16x16x32_bf16 v[228:231], v[224:227], v[128:131], 0
  v_max_f32 v123, s40, v123
  v_max_f32 v136, s40, v136
  v_max_f32 v137, s40, v137
  v_mfma_f32_16x16x32_bf16 v[244:247], v[224:227], v[144:147], 0
  v_max_f32 v138, s40, v138
  v_max_f32 v139, s40, v139
  v_max_f32 v152, s40, v152
  v_mfma_f32_16x16x32_bf16 v[80:83], v[224:227], v[160:163], 0
  v_max_f32 v153, s40, v153
  v_max_f32 v154, s40, v154
  v_max_f32 v155, s40, v155
  v_mfma_f32_16x16x32_bf16 v[84:87], v[240:243], v[144:147], 0
  v_max_f32 v168, s40, v168
  v_max_f32 v169, s40, v169
  v_max_f32 v170, s40, v170
  v_mfma_f32_16x16x32_bf16 v[88:91], v[240:243], v[160:163], 0
  v_max_f32 v171, s40, v171
  v_pk_add_f32 v[104:105], v[104:105], v[60:61]
  v_pk_add_f32 v[106:107], v[106:107], v[62:63]
  v_pk_add_f32 v[120:121], v[120:121], v[64:65]
  v_pk_add_f32 v[122:123], v[122:123], v[66:67]
  v_pk_add_f32 v[136:137], v[136:137], v[68:69]
  v_pk_add_f32 v[138:139], v[138:139], v[70:71]
  v_pk_add_f32 v[152:153], v[152:153], v[72:73]
  v_pk_add_f32 v[154:155], v[154:155], v[74:75]
  v_pk_add_f32 v[168:169], v[168:169], v[76:77]
  v_pk_add_f32 v[170:171], v[170:171], v[78:79]
  v_cvt_pk_bf16_f32 v104, v104, v105
  v_cvt_pk_bf16_f32 v105, v106, v107
  v_cvt_pk_bf16_f32 v120, v120, v121
  v_cvt_pk_bf16_f32 v121, v122, v123
  v_cvt_pk_bf16_f32 v136, v136, v137
  v_cvt_pk_bf16_f32 v137, v138, v139
  v_cvt_pk_bf16_f32 v152, v152, v153
  v_cvt_pk_bf16_f32 v153, v154, v155
  v_cvt_pk_bf16_f32 v168, v168, v169
  v_cvt_pk_bf16_f32 v169, v170, v171
  v_cvt_pk_bf16_f32 v184, v184, v185
  v_cvt_pk_bf16_f32 v185, v186, v187
  v_cvt_pk_bf16_f32 v200, v200, v201
  v_cvt_pk_bf16_f32 v201, v202, v203
  v_cvt_pk_bf16_f32 v216, v216, v217
  v_cvt_pk_bf16_f32 v217, v218, v219
  v_cvt_pk_bf16_f32 v232, v232, v233
  v_cvt_pk_bf16_f32 v233, v234, v235
  v_cvt_pk_bf16_f32 v248, v248, v249
  v_cvt_pk_bf16_f32 v249, v250, v251
  s_cbranch_execz L_dry_ret
L_kv_b3:
  v_pk_fma_f32 v[108:109], v[28:29], v[48:49], v[108:109] op_sel:[0,0,0] op_sel_hi:[1,0,1] neg_lo:[0,1,0] neg_hi:[0,1,0]
  v_pk_fma_f32 v[110:111], v[30:31], v[48:49], v[110:111] op_sel:[0,0,0] op_sel_hi:[1,0,1] neg_lo:[0,1,0] neg_hi:[0,1,0]
  v_pk_fma_f32 v[124:125], v[28:29], v[48:49], v[124:125] op_sel:[0,1,0] op_sel_hi:[1,1,1] neg_lo:[0,1,0] neg_hi:[0,1,0]
  v_pk_fma_f32 v[126:127], v[30:31], v[48:49], v[126:127] op_sel:[0,1,0] op_sel_hi:[1,1,1] neg_lo:[0,1,0] neg_hi:[0,1,0]
  v_pk_fma_f32 v[140:141], v[28:29], v[50:51], v[140:141] op_sel:[0,0,0] op_sel_hi:[1,0,1] neg_lo:[0,1,0] neg_hi:[0,1,0]
  v_pk_fma_f32 v[142:143], v[30:31], v[50:51], v[142:143] op_sel:[0,0,0] op_sel_hi:[1,0,1] neg_lo:[0,1,0] neg_hi:[0,1,0]
  v_pk_fma_f32 v[156:157], v[28:29], v[50:51], v[156:157] op_sel:[0,1,0] op_sel_hi:[1,1,1] neg_lo:[0,1,0] neg_hi:[0,1,0]
  v_pk_fma_f32 v[158:159], v[30:31], v[50:51], v[158:159] op_sel:[0,1,0] op_sel_hi:[1,1,1] neg_lo:[0,1,0] neg_hi:[0,1,0]
  v_pk_fma_f32 v[172:173], v[28:29], v[52:53], v[172:173] op_sel:[0,0,0] op_sel_hi:[1,0,1] neg_lo:[0,1,0] neg_hi:[0,1,0]
  v_pk_fma_f32 v[174:175], v[30:31], v[52:53], v[174:175] op_sel:[0,0,0] op_sel_hi:[1,0,1] neg_lo:[0,1,0] neg_hi:[0,1,0]
  v_pk_fma_f32 v[188:189], v[28:29], v[52:53], v[188:189] op_sel:[0,1,0] op_sel_hi:[1,1,1] neg_lo:[0,1,0] neg_hi:[0,1,0]
  v_pk_fma_f32 v[190:191], v[30:31], v[52:53], v[190:191] op_sel:[0,1,0] op_sel_hi:[1,1,1] neg_lo:[0,1,0] neg_hi:[0,1,0]
  v_pk_fma_f32 v[204:205], v[28:29], v[54:55], v[204:205] op_sel:[0,0,0] op_sel_hi:[1,0,1] neg_lo:[0,1,0] neg_hi:[0,1,0]
  v_pk_fma_f32 v[206:207], v[30:31], v[54:55], v[206:207] op_sel:[0,0,0] op_sel_hi:[1,0,1] neg_lo:[0,1,0] neg_hi:[0,1,0]
  v_pk_fma_f32 v[220:221], v[28:29], v[54:55], v[220:221] op_sel:[0,1,0] op_sel_hi:[1,1,1] neg_lo:[0,1,0] neg_hi:[0,1,0]
  v_pk_fma_f32 v[222:223], v[30:31], v[54:55], v[222:223] op_sel:[0,1,0] op_sel_hi:[1,1,1] neg_lo:[0,1,0] neg_hi:[0,1,0]
  v_pk_fma_f32 v[236:237], v[28:29], v[56:57], v[236:237] op_sel:[0,0,0] op_sel_hi:[1,0,1] neg_lo:[0,1,0] neg_hi:[0,1,0]
  v_pk_fma_f32 v[238:239], v[30:31], v[56:57], v[238:239] op_sel:[0,0,0] op_sel_hi:[1,0,1] neg_lo:[0,1,0] neg_hi:[0,1,0]
  v_pk_fma_f32 v[252:253], v[28:29], v[56:57], v[252:253] op_sel:[0,1,0] op_sel_hi:[1,1,1] neg_lo:[0,1,0] neg_hi:[0,1,0]
  v_pk_fma_f32 v[254:255], v[30:31], v[56:57], v[254:255] op_sel:[0,1,0] op_sel_hi:[1,1,1] neg_lo:[0,1,0] neg_hi:[0,1,0]
  v_pk_fma_f32 v[108:109], v[108:109], v[44:45], s[40:41]
  v_pk_fma_f32 v[110:111], v[110:111], v[46:47], s[40:41]
  v_pk_fma_f32 v[124:125], v[124:125], v[44:45], s[40:41]
  v_pk_fma_f32 v[126:127], v[126:127], v[46:47], s[40:41]
  v_pk_fma_f32 v[140:141], v[140:141], v[44:45], s[40:41]
  v_pk_fma_f32 v[142:143], v[142:143], v[46:47], s[40:41]
  v_pk_fma_f32 v[156:157], v[156:157], v[44:45], s[40:41]
  v_pk_fma_f32 v[158:159], v[158:159], v[46:47], s[40:41]
  v_pk_fma_f32 v[172:173], v[172:173], v[44:45], s[40:41]
  v_pk_fma_f32 v[174:175], v[174:175], v[46:47], s[40:41]
  v_pk_mul_f32 v[188:189], v[188:189], v[44:45]
  v_pk_mul_f32 v[190:191], v[190:191], v[46:47]
  v_pk_mul_f32 v[204:205], v[204:205], v[44:45]
  v_pk_mul_f32 v[206:207], v[206:207], v[46:47]
  v_pk_mul_f32 v[220:221], v[220:221], v[44:45]
  v_pk_mul_f32 v[222:223], v[222:223], v[46:47]
  v_pk_mul_f32 v[236:237], v[236:237], v[44:45]
  v_pk_mul_f32 v[238:239], v[238:239], v[46:47]
  v_pk_mul_f32 v[252:253], v[252:253], v[44:45]
  v_pk_mul_f32 v[254:255], v[254:255], v[46:47]
  v_pk_mul_f32 v[60:61], v[108:109], s[42:43]
  v_pk_mul_f32 v[62:63], v[110:111], s[42:43]
  v_pk_mul_f32 v[64:65], v[124:125], s[42:43]
  v_pk_mul_f32 v[66:67], v[126:127], s[42:43]
  v_pk_mul_f32 v[68:69], v[140:141], s[42:43]
  v_pk_mul_f32 v[70:71], v[142:143], s[42:43]
  v_pk_mul_f32 v[72:73], v[156:157], s[42:43]
  v_pk_mul_f32 v[74:75], v[158:159], s[42:43]
  v_pk_mul_f32 v[76:77], v[172:173], s[42:43]
  v_pk_mul_f32 v[78:79], v[174:175], s[42:43]
  v_exp_f32_e64 v60, v60 clamp
  v_exp_f32_e64 v61, v61 clamp
  v_exp_f32_e64 v62, v62 clamp
  v_exp_f32_e64 v63, v63 clamp
  v_exp_f32_e64 v64, v64 clamp
  v_exp_f32_e64 v65, v65 clamp
  v_exp_f32_e64 v66, v66 clamp
  v_exp_f32_e64 v67, v67 clamp
  v_exp_f32_e64 v68, v68 clamp
  v_exp_f32_e64 v69, v69 clamp
  v_exp_f32_e64 v70, v70 clamp
  v_exp_f32_e64 v71, v71 clamp
  v_exp_f32_e64 v72, v72 clamp
  v_exp_f32_e64 v73, v73 clamp
  v_exp_f32_e64 v74, v74 clamp
  v_exp_f32_e64 v75, v75 clamp
  v_exp_f32_e64 v76, v76 clamp
  v_exp_f32_e64 v77, v77 clamp
  v_exp_f32_e64 v78, v78 clamp
  v_exp_f32_e64 v79, v79 clamp
  v_max_f32 v108, s40, v108
  v_max_f32 v109, s40, v109
  v_max_f32 v110, s40, v110
  v_max_f32 v111, s40, v111
  v_max_f32 v124, s40, v124
  v_max_f32 v125, s40, v125
  v_max_f32 v126, s40, v126
  v_max_f32 v127, s40, v127
  v_max_f32 v140, s40, v140
  v_max_f32 v141, s40, v141
  v_max_f32 v142, s40, v142
  v_max_f32 v143, s40, v143
  v_max_f32 v156, s40, v156
  v_max_f32 v157, s40, v157
  v_max_f32 v158, s40, v158
  v_max_f32 v159, s40, v159
  v_max_f32 v172, s40, v172
  v_max_f32 v173, s40, v173
  v_max_f32 v174, s40, v174
  v_max_f32 v175, s40, v175
  v_pk_add_f32 v[108:109], v[108:109], v[60:61]
  v_pk_add_f32 v[110:111], v[110:111], v[62:63]
  v_pk_add_f32 v[124:125], v[124:125], v[64:65]
  v_pk_add_f32 v[126:127], v[126:127], v[66:67]
  v_pk_add_f32 v[140:141], v[140:141], v[68:69]
  v_pk_add_f32 v[142:143], v[142:143], v[70:71]
  v_pk_add_f32 v[156:157], v[156:157], v[72:73]
  v_pk_add_f32 v[158:159], v[158:159], v[74:75]
  v_pk_add_f32 v[172:173], v[172:173], v[76:77]
  v_pk_add_f32 v[174:175], v[174:175], v[78:79]
  v_cvt_pk_bf16_f32 v106, v108, v109
  v_cvt_pk_bf16_f32 v107, v110, v111
  v_cvt_pk_bf16_f32 v122, v124, v125
  v_cvt_pk_bf16_f32 v123, v126, v127
  v_cvt_pk_bf16_f32 v138, v140, v141
  v_cvt_pk_bf16_f32 v139, v142, v143
  v_cvt_pk_bf16_f32 v154, v156, v157
  v_cvt_pk_bf16_f32 v155, v158, v159
  v_cvt_pk_bf16_f32 v170, v172, v173
  v_cvt_pk_bf16_f32 v171, v174, v175
  v_cvt_pk_bf16_f32 v186, v188, v189
  v_cvt_pk_bf16_f32 v187, v190, v191
  v_cvt_pk_bf16_f32 v202, v204, v205
  v_cvt_pk_bf16_f32 v203, v206, v207
  v_cvt_pk_bf16_f32 v218, v220, v221
  v_cvt_pk_bf16_f32 v219, v222, v223
  v_cvt_pk_bf16_f32 v234, v236, v237
  v_cvt_pk_bf16_f32 v235, v238, v239
  v_cvt_pk_bf16_f32 v250, v252, v253
  v_cvt_pk_bf16_f32 v251, v254, v255
  s_nop 1
  v_mfma_f32_16x16x32_bf16 v[108:111], v[92:95], v[96:99], 0
  v_mfma_f32_16x16x32_bf16 v[124:127], v[92:95], v[112:115], 0
  v_mfma_f32_16x16x32_bf16 v[140:143], v[92:95], v[128:131], 0
  v_mfma_f32_16x16x32_bf16 v[156:159], v[92:95], v[144:147], 0
  v_mfma_f32_16x16x32_bf16 v[172:175], v[92:95], v[160:163], 0
  v_mfma_f32_16x16x32_bf16 v[100:103], v[184:187], v[104:107], v[100:103]
  v_mfma_f32_16x16x32_bf16 v[116:119], v[184:187], v[120:123], v[116:119]
  v_mfma_f32_16x16x32_bf16 v[132:135], v[200:203], v[104:107], v[132:135]
  v_mfma_f32_16x16x32_bf16 v[148:151], v[200:203], v[120:123], v[148:151]
  v_mfma_f32_16x16x32_bf16 v[164:167], v[200:203], v[136:139], v[164:167]
  v_mfma_f32_16x16x32_bf16 v[180:183], v[216:219], v[120:123], v[180:183]
  v_mfma_f32_16x16x32_bf16 v[196:199], v[216:219], v[136:139], v[196:199]
  v_mfma_f32_16x16x32_bf16 v[212:215], v[216:219], v[152:155], v[212:215]
  v_mfma_f32_16x16x32_bf16 v[228:231], v[232:235], v[136:139], v[228:231]
  v_mfma_f32_16x16x32_bf16 v[244:247], v[232:235], v[152:155], v[244:247]
  v_mfma_f32_16x16x32_bf16 v[80:83], v[232:235], v[168:171], v[80:83]
  v_mfma_f32_16x16x32_bf16 v[84:87], v[248:251], v[152:155], v[84:87]
  v_mfma_f32_16x16x32_bf16 v[88:91], v[248:251], v[168:171], v[88:91]
  v_mfma_f32_16x16x32_bf16 v[108:111], v[92:95], v[104:107], v[108:111]
  v_mfma_f32_16x16x32_bf16 v[124:127], v[92:95], v[120:123], v[124:127]
  v_mfma_f32_16x16x32_bf16 v[140:143], v[92:95], v[136:139], v[140:143]
  v_mfma_f32_16x16x32_bf16 v[156:159], v[92:95], v[152:155], v[156:159]
  v_mfma_f32_16x16x32_bf16 v[172:175], v[92:95], v[168:171], v[172:175]
  s_mul_i32 s37, s28, 18432
  v_lshlrev_b32 v11, 4, v8
  v_add_u32 v11, s37, v11
  v_add_u32 v11, 0, v11
  s_cbranch_execz L_dry_ret
  s_nop 2
  ds_write_b128 v11, v[100:103] offset:0
  ds_write_b128 v11, v[116:119] offset:1024
  ds_write_b128 v11, v[132:135] offset:2048
  ds_write_b128 v11, v[148:151] offset:3072
  ds_write_b128 v11, v[164:167] offset:4096
  ds_write_b128 v11, v[180:183] offset:5120
  ds_write_b128 v11, v[196:199] offset:6144
  ds_write_b128 v11, v[212:215] offset:7168
  ds_write_b128 v11, v[228:231] offset:8192
  ds_write_b128 v11, v[244:247] offset:9216
  ds_write_b128 v11, v[80:83] offset:10240
  ds_write_b128 v11, v[84:87] offset:11264
  s_waitcnt lgkmcnt(4)
  ds_write_b128 v11, v[88:91] offset:12288
  s_nop 3
  ds_write_b128 v11, v[108:111] offset:13312
  ds_write_b128 v11, v[124:127] offset:14336
  ds_write_b128 v11, v[140:143] offset:15360
  ds_write_b128 v11, v[156:159] offset:16384
  ds_write_b128 v11, v[172:175] offset:17408
L_kv_final:
  v_mov_b32 v42, 0x7ffffff0
  s_add_u32 s36, s28, 0
  s_cmp_ge_u32 s36, 13
  s_cbranch_scc1 L_kva_z0
  s_lshl_b32 s37, s36, 2
  s_mov_b32 s92, 572592384
  s_mov_b32 s93, 279347
  s_lshr_b64 s[92:93], s[92:93], s37
  s_and_b32 s38, s92, 15
  s_mov_b32 s92, 840044560
  s_mov_b32 s93, 275506
  s_lshr_b64 s[92:93], s[92:93], s37
  s_and_b32 s39, s92, 15
  s_lshl_b32 s38, s38, 2
  s_lshl_b32 s39, s39, 4
  v_add_u32 v11, s38, v10
  v_mul_u32_u24 v12, 52, v11
  v_lshrrev_b32 v12, 8, v12
  v_lshlrev_b32 v11, 2, v11
  v_sub_u32 v11, v11, v12
  v_mul_u32_u24 v11, 80, v11
  v_add_u32 v13, s39, v9
  v_mul_u32_u24 v14, 205, v13
  v_lshrrev_b32 v14, 12, v14
  v_cmp_eq_u32 vcc, v12, v14
  v_lshlrev_b32 v13, 2, v13
  v_add_u32 v11, v11, v13
  v_mov_b32 v12, 0x7ffffff0
  v_cndmask_b32 v40, v12, v11, vcc
  s_branch L_kva_d0
L_kva_z0:
  s_sub_u32 s37, s36, 13
  s_lshl_b32 s37, s37, 6
  v_lshlrev_b32 v11, 2, v9
  v_add_u32 v11, s37, v11
  v_add_u32 v11, 6400, v11
  v_cmp_eq_u32 vcc, 0, v10
  v_mov_b32 v12, 0x7ffffff0
  s_nop 0
  v_cndmask_b32 v40, v12, v11, vcc
L_kva_d0:
  s_add_u32 s36, s28, 8
  s_cmp_ge_u32 s36, 13
  s_cbranch_scc1 L_kva_z1
  s_lshl_b32 s37, s36, 2
  s_mov_b32 s92, 572592384
  s_mov_b32 s93, 279347
  s_lshr_b64 s[92:93], s[92:93], s37
  s_and_b32 s38, s92, 15
  s_mov_b32 s92, 840044560
  s_mov_b32 s93, 275506
  s_lshr_b64 s[92:93], s[92:93], s37
  s_and_b32 s39, s92, 15
  s_lshl_b32 s38, s38, 2
  s_lshl_b32 s39, s39, 4
  v_add_u32 v11, s38, v10
  v_mul_u32_u24 v12, 52, v11
  v_lshrrev_b32 v12, 8, v12
  v_lshlrev_b32 v11, 2, v11
  v_sub_u32 v11, v11, v12
  v_mul_u32_u24 v11, 80, v11
  v_add_u32 v13, s39, v9
  v_mul_u32_u24 v14, 205, v13
  v_lshrrev_b32 v14, 12, v14
  v_cmp_eq_u32 vcc, v12, v14
  v_lshlrev_b32 v13, 2, v13
  v_add_u32 v11, v11, v13
  v_mov_b32 v12, 0x7ffffff0
  v_cndmask_b32 v41, v12, v11, vcc
  s_branch L_kva_d1
L_kva_z1:
  s_sub_u32 s37, s36, 13
  s_lshl_b32 s37, s37, 6
  v_lshlrev_b32 v11, 2, v9
  v_add_u32 v11, s37, v11
  v_add_u32 v11, 6400, v11
  v_cmp_eq_u32 vcc, 0, v10
  v_mov_b32 v12, 0x7ffffff0
  s_nop 0
  v_cndmask_b32 v41, v12, v11, vcc
L_kva_d1:
  s_add_u32 s36, s28, 16
  s_cmp_lt_u32 s36, 18
  s_cbranch_scc0 L_kva_skip
  s_cmp_ge_u32 s36, 13
  s_cbranch_scc1 L_kva_z2
  s_lshl_b32 s37, s36, 2
  s_mov_b32 s92, 572592384
  s_mov_b32 s93, 279347
  s_lshr_b64 s[92:93], s[92:93], s37
  s_and_b32 s38, s92, 15
  s_mov_b32 s92, 840044560
  s_mov_b32 s93, 275506
  s_lshr_b64 s[92:93], s[92:93], s37
  s_and_b32 s39, s92, 15
  s_lshl_b32 s38, s38, 2
  s_lshl_b32 s39, s39, 4
  v_add_u32 v11, s38, v10
  v_mul_u32_u24 v12, 52, v11
  v_lshrrev_b32 v12, 8, v12
  v_lshlrev_b32 v11, 2, v11
  v_sub_u32 v11, v11, v12
  v_mul_u32_u24 v11, 80, v11
  v_add_u32 v13, s39, v9
  v_mul_u32_u24 v14, 205, v13
  v_lshrrev_b32 v14, 12, v14
  v_cmp_eq_u32 vcc, v12, v14
  v_lshlrev_b32 v13, 2, v13
  v_add_u32 v11, v11, v13
  v_mov_b32 v12, 0x7ffffff0
  v_cndmask_b32 v42, v12, v11, vcc
  s_branch L_kva_d2
L_kva_z2:
  s_sub_u32 s37, s36, 13
  s_lshl_b32 s37, s37, 6
  v_lshlrev_b32 v11, 2, v9
  v_add_u32 v11, s37, v11
  v_add_u32 v11, 6400, v11
  v_cmp_eq_u32 vcc, 0, v10
  v_mov_b32 v12, 0x7ffffff0
  s_nop 0
  v_cndmask_b32 v42, v12, v11, vcc
L_kva_d2:
L_kva_skip:
  s_mul_i32 s63, s30, 6720
  s_add_u32 s63, s63, 8912896
  s_lshl_b32 s37, s28, 10
  v_lshlrev_b32 v16, 4, v8
  v_add_u32 v16, s37, v16
  v_add_u32 v16, 0, v16
  v_add_u32 v17, 36864, v16
  s_waitcnt lgkmcnt(0)
  s_barrier
  ds_read_b128 v[44:47], v16 offset:0
  ds_read_b128 v[48:51], v16 offset:18432
  ds_read_b128 v[52:55], v17 offset:0
  ds_read_b128 v[56:59], v17 offset:18432
  ds_read_b128 v[60:63], v16 offset:8192
  ds_read_b128 v[64:67], v16 offset:26624
  ds_read_b128 v[68:71], v17 offset:8192
  ds_read_b128 v[72:75], v17 offset:26624
  s_cmp_lt_u32 s28, 2
  s_cbranch_scc0 L_kvf_no2
  ds_read_b128 v[76:79], v16 offset:16384
  ds_read_b128 v[80:83], v16 offset:34816
  ds_read_b128 v[84:87], v17 offset:16384
  ds_read_b128 v[88:91], v17 offset:34816
L_kvf_no2:
  s_waitcnt lgkmcnt(0)
  v_add_f32 v44, v44, v48
  v_add_f32 v45, v45, v49
  v_add_f32 v52, v52, v56
  v_add_f32 v53, v53, v57
  v_add_f32 v46, v46, v50
  v_add_f32 v47, v47, v51
  v_add_f32 v54, v54, v58
  v_add_f32 v55, v55, v59
  v_add_f32 v44, v44, v52
  v_add_f32 v45, v45, v53
  v_add_f32 v46, v46, v54
  v_add_f32 v47, v47, v55
  buffer_atomic_add_f32 v44, v40, s[20:23], s63 offen offset:0
  buffer_atomic_add_f32 v45, v40, s[20:23], s63 offen offset:80
  buffer_atomic_add_f32 v46, v40, s[20:23], s63 offen offset:160
  buffer_atomic_add_f32 v47, v40, s[20:23], s63 offen offset:240
  s_cmp_lt_u32 s28, 5
  s_cbranch_scc0 L_kvf_z1
  v_add_f32 v60, v60, v64
  v_add_f32 v61, v61, v65
  v_add_f32 v68, v68, v72
  v_add_f32 v69, v69, v73
  v_add_f32 v62, v62, v66
  v_add_f32 v63, v63, v67
  v_add_f32 v70, v70, v74
  v_add_f32 v71, v71, v75
  v_add_f32 v60, v60, v68
  v_add_f32 v61, v61, v69
  v_add_f32 v62, v62, v70
  v_add_f32 v63, v63, v71
  buffer_atomic_add_f32 v60, v41, s[20:23], s63 offen offset:0
  buffer_atomic_add_f32 v61, v41, s[20:23], s63 offen offset:80
  buffer_atomic_add_f32 v62, v41, s[20:23], s63 offen offset:160
  buffer_atomic_add_f32 v63, v41, s[20:23], s63 offen offset:240
  s_branch L_kvf_t2
L_kvf_z1:
  v_add_f32 v60, v60, v64
  v_add_f32 v68, v68, v72
  v_add_f32 v60, v60, v68
  buffer_atomic_add_f32 v60, v41, s[20:23], s63 offen
L_kvf_t2:
  s_cmp_lt_u32 s28, 2
  s_cbranch_scc0 L_k1_end2
  v_add_f32 v76, v76, v80
  v_add_f32 v84, v84, v88
  v_add_f32 v76, v76, v84
  buffer_atomic_add_f32 v76, v42, s[20:23], s63 offen
L_k1_end2:
  s_endpgm
L_k1_end:
  s_endpgm
.globl k2_kernel
.p2align 8
.type k2_kernel,@function
k2_kernel:
  s_cmp_ge_u32 s2, 256
  s_cbranch_scc1 L_k2_end
  s_load_dwordx2 s[4:5], s[0:1], 0
  s_load_dwordx2 s[50:51], s[0:1], 56
  s_load_dwordx2 s[52:53], s[0:1], 72
  v_lshrrev_b32 v4, 6, v0
  v_and_b32 v1, 63, v0
  v_readfirstlane_b32 s42, v4
  v_and_b32 v2, 15, v1
  v_lshrrev_b32 v3, 4, v1
  s_and_b32 s32, s2, 7
  s_lshr_b32 s33, s2, 3
  s_lshr_b32 s28, s32, 1
  s_lshl_b32 s28, s28, 3
  s_and_b32 s34, s33, 7
  s_add_u32 s28, s28, s34
  s_and_b32 s29, s32, 1
  s_lshl_b32 s29, s29, 2
  s_lshr_b32 s34, s33, 3
  s_add_u32 s29, s29, s34
  s_and_b32 s30, s42, 3
  s_mul_i32 s31, s42, 20480
  v_lshlrev_b32 v9, 4, v1
  s_mov_b32 s22, 12128256
  s_mov_b32 s23, 0x20000
  s_mov_b32 s10, 2621440
  s_mov_b32 s11, 0x20000
  s_mov_b32 s26, 2621440
  s_mov_b32 s27, 0x20000
  s_cmp_lt_u32 s42, 4
  s_cbranch_scc0 L_k2_F
  s_mul_i32 s45, s28, 81920
  s_mul_i32 s32, s30, 5120
  s_add_u32 s45, s45, s32
  s_add_u32 s45, s45, 0
  s_mul_i32 s40, s30, 204800
  s_mul_i32 s32, s29, 5120
  s_add_u32 s40, s40, s32
  s_add_u32 s40, s40, 10977280
  s_waitcnt lgkmcnt(0)
  s_mov_b32 s20, s52
  s_mov_b32 s21, s53
  s_mov_b32 s8, s4
  s_mov_b32 s9, s5
  s_mov_b32 s24, s50
  s_mov_b32 s25, s51
  s_mul_i32 s32, s30, 13440
  s_add_u32 s32, s32, 8912896
  s_add_u32 m0, s31, 0
  s_add_u32 s34, s32, 0
  buffer_load_dwordx4 v9, s[20:23], s34 offen lds
  s_add_u32 m0, s31, 1024
  s_add_u32 s34, s32, 1024
  buffer_load_dwordx4 v9, s[20:23], s34 offen lds
  s_add_u32 m0, s31, 2048
  s_add_u32 s34, s32, 2048
  buffer_load_dwordx4 v9, s[20:23], s34 offen lds
  s_add_u32 m0, s31, 3072
  s_add_u32 s34, s32, 3072
  buffer_load_dwordx4 v9, s[20:23], s34 offen lds
  s_add_u32 m0, s31, 4096
  s_add_u32 s34, s32, 4096
  buffer_load_dwordx4 v9, s[20:23], s34 offen lds
  s_add_u32 m0, s31, 5120
  s_add_u32 s34, s32, 5120
  buffer_load_dwordx4 v9, s[20:23], s34 offen lds
  s_add_u32 m0, s31, 6144
  s_add_u32 s34, s32, 6144
  buffer_load_dwordx4 v9, s[20:23], s34 offen lds
  s_add_u32 m0, s31, 7168
  s_add_u32 s34, s32, 7168
  buffer_load_dwordx4 v9, s[20:23], s34 offen lds
  s_add_u32 m0, s31, 8192
  s_add_u32 s34, s32, 8192
  buffer_load_dwordx4 v9, s[20:23], s34 offen lds
  s_add_u32 m0, s31, 9216
  s_add_u32 s34, s32, 9216
  buffer_load_dwordx4 v9, s[20:23], s34 offen lds
  s_add_u32 m0, s31, 10240
  s_add_u32 s34, s32, 10240
  buffer_load_dwordx4 v9, s[20:23], s34 offen lds
  s_add_u32 m0, s31, 11264
  s_add_u32 s34, s32, 11264
  buffer_load_dwordx4 v9, s[20:23], s34 offen lds
  s_add_u32 m0, s31, 12288
  s_add_u32 s34, s32, 12288
  buffer_load_dwordx4 v9, s[20:23], s34 offen lds
  v_cmp_gt_u32 vcc, 8, v1
  s_and_saveexec_b64 s[36:37], vcc
  s_add_u32 m0, s31, 13312
  s_add_u32 s34, s32, 13312
  buffer_load_dwordx4 v9, s[20:23], s34 offen lds
  s_mov_b64 exec, s[36:37]
  buffer_load_dwordx4 v[176:179], v9, s[20:23], s45 offen offset:0
  buffer_load_dwordx4 v[180:183], v9, s[20:23], s45 offen offset:1024
  buffer_load_dwordx4 v[184:187], v9, s[20:23], s45 offen offset:2048
  buffer_load_dwordx4 v[188:191], v9, s[20:23], s45 offen offset:3072
  s_add_u32 s32, s45, 4096
  buffer_load_dwordx4 v[192:195], v9, s[20:23], s32 offen
  s_add_u32 s45, s45, 20480
  buffer_load_dwordx4 v[196:199], v9, s[20:23], s45 offen offset:0
  buffer_load_dwordx4 v[200:203], v9, s[20:23], s45 offen offset:1024
  buffer_load_dwordx4 v[204:207], v9, s[20:23], s45 offen offset:2048
  buffer_load_dwordx4 v[208:211], v9, s[20:23], s45 offen offset:3072
  s_add_u32 s32, s45, 4096
  buffer_load_dwordx4 v[212:215], v9, s[20:23], s32 offen
  s_add_u32 s45, s45, 20480
  v_mov_b32 v240, 0
  v_mov_b32 v241, 0
  v_mov_b32 v242, 0
  v_mov_b32 v243, 0
  v_add_u32 v12, s31, v9
  v_cmp_gt_u32 vcc, 44, v1
  s_and_saveexec_b64 s[36:37], vcc
  ds_write_b128 v12, v[240:243] offset:13440
  s_mov_b64 exec, s[36:37]
  v_lshlrev_b32 v15, 4, v3
  v_add_u32 v12, 0, v2
  v_mul_u32_u24 v128, 205, v12
  v_lshrrev_b32 v128, 12, v128
  v_sub_u32 v12, v12, v128
  v_mul_u32_u24 v12, 80, v12
  v_lshrrev_b32 v13, 2, v128
  v_mul_u32_u24 v13, 320, v13
  v_add3_u32 v12, v12, v13, v15
  v_add_u32 v138, s31, v12
  v_add_u32 v12, 16, v2
  v_mul_u32_u24 v129, 205, v12
  v_lshrrev_b32 v129, 12, v129
  v_sub_u32 v12, v12, v129
  v_mul_u32_u24 v12, 80, v12
  v_lshrrev_b32 v13, 2, v129
  v_mul_u32_u24 v13, 320, v13
  v_add3_u32 v12, v12, v13, v15
  v_add_u32 v139, s31, v12
  v_add_u32 v12, 32, v2
  v_mul_u32_u24 v130, 205, v12
  v_lshrrev_b32 v130, 12, v130
  v_sub_u32 v12, v12, v130
  v_mul_u32_u24 v12, 80, v12
  v_lshrrev_b32 v13, 2, v130
  v_mul_u32_u24 v13, 320, v13
  v_add3_u32 v12, v12, v13, v15
  v_add_u32 v140, s31, v12
  v_add_u32 v12, 48, v2
  v_mul_u32_u24 v131, 205, v12
  v_lshrrev_b32 v131, 12, v131
  v_sub_u32 v12, v12, v131
  v_mul_u32_u24 v12, 80, v12
  v_lshrrev_b32 v13, 2, v131
  v_mul_u32_u24 v13, 320, v13
  v_add3_u32 v12, v12, v13, v15
  v_add_u32 v141, s31, v12
  v_add_u32 v12, 64, v2
  v_mul_u32_u24 v132, 205, v12
  v_lshrrev_b32 v132, 12, v132
  v_sub_u32 v12, v12, v132
  v_mul_u32_u24 v12, 80, v12
  v_lshrrev_b32 v13, 2, v132
  v_mul_u32_u24 v13, 320, v13
  v_add3_u32 v12, v12, v13, v15
  v_add_u32 v142, s31, v12
  v_add_u32 v12, 80, v2
  v_mul_u32_u24 v133, 205, v12
  v_lshrrev_b32 v133, 12, v133
  v_sub_u32 v12, v12, v133
  v_mul_u32_u24 v12, 80, v12
  v_lshrrev_b32 v13, 2, v133
  v_mul_u32_u24 v13, 320, v13
  v_add3_u32 v12, v12, v13, v15
  v_add_u32 v143, s31, v12
  v_add_u32 v12, 96, v2
  v_mul_u32_u24 v134, 205, v12
  v_lshrrev_b32 v134, 12, v134
  v_sub_u32 v12, v12, v134
  v_mul_u32_u24 v12, 80, v12
  v_lshrrev_b32 v13, 2, v134
  v_mul_u32_u24 v13, 320, v13
  v_add3_u32 v12, v12, v13, v15
  v_add_u32 v144, s31, v12
  v_add_u32 v12, 112, v2
  v_mul_u32_u24 v135, 205, v12
  v_lshrrev_b32 v135, 12, v135
  v_sub_u32 v12, v12, v135
  v_mul_u32_u24 v12, 80, v12
  v_lshrrev_b32 v13, 2, v135
  v_mul_u32_u24 v13, 320, v13
  v_add3_u32 v12, v12, v13, v15
  v_add_u32 v145, s31, v12
  v_add_u32 v12, 128, v2
  v_mul_u32_u24 v136, 205, v12
  v_lshrrev_b32 v136, 12, v136
  v_sub_u32 v12, v12, v136
  v_mul_u32_u24 v12, 80, v12
  v_lshrrev_b32 v13, 2, v136
  v_mul_u32_u24 v13, 320, v13
  v_add3_u32 v12, v12, v13, v15
  v_add_u32 v146, s31, v12
  v_add_u32 v12, 144, v2
  v_mul_u32_u24 v137, 205, v12
  v_lshrrev_b32 v137, 12, v137
  v_sub_u32 v12, v12, v137
  v_mul_u32_u24 v12, 80, v12
  v_lshrrev_b32 v13, 2, v137
  v_mul_u32_u24 v13, 320, v13
  v_add3_u32 v12, v12, v13, v15
  v_add_u32 v147, s31, v12
  v_add_u32 v12, 0, v3
  v_mul_u32_u24 v148, 52, v12
  v_lshrrev_b32 v148, 8, v148
  v_lshrrev_b32 v13, 2, v148
  v_mul_u32_u24 v13, 6400, v13
  v_add3_u32 v13, v13, v15, s31
  v_add_u32 v158, 6400, v13
  v_add_u32 v12, 4, v3
  v_mul_u32_u24 v149, 52, v12
  v_lshrrev_b32 v149, 8, v149
  v_lshrrev_b32 v13, 2, v149
  v_mul_u32_u24 v13, 6400, v13
  v_add3_u32 v13, v13, v15, s31
  v_add_u32 v159, 6400, v13
  v_add_u32 v12, 8, v3
  v_mul_u32_u24 v150, 52, v12
  v_lshrrev_b32 v150, 8, v150
  v_lshrrev_b32 v13, 2, v150
  v_mul_u32_u24 v13, 6400, v13
  v_add3_u32 v13, v13, v15, s31
  v_add_u32 v160, 6400, v13
  v_add_u32 v12, 12, v3
  v_mul_u32_u24 v151, 52, v12
  v_lshrrev_b32 v151, 8, v151
  v_lshrrev_b32 v13, 2, v151
  v_mul_u32_u24 v13, 6400, v13
  v_add3_u32 v13, v13, v15, s31
  v_add_u32 v161, 6400, v13
  v_add_u32 v12, 16, v3
  v_mul_u32_u24 v152, 52, v12
  v_lshrrev_b32 v152, 8, v152
  v_lshrrev_b32 v13, 2, v152
  v_mul_u32_u24 v13, 6400, v13
  v_add3_u32 v13, v13, v15, s31
  v_add_u32 v162, 6400, v13
  v_add_u32 v12, 20, v3
  v_mul_u32_u24 v153, 52, v12
  v_lshrrev_b32 v153, 8, v153
  v_lshrrev_b32 v13, 2, v153
  v_mul_u32_u24 v13, 6400, v13
  v_add3_u32 v13, v13, v15, s31
  v_add_u32 v163, 6400, v13
  v_add_u32 v12, 24, v3
  v_mul_u32_u24 v154, 52, v12
  v_lshrrev_b32 v154, 8, v154
  v_lshrrev_b32 v13, 2, v154
  v_mul_u32_u24 v13, 6400, v13
  v_add3_u32 v13, v13, v15, s31
  v_add_u32 v164, 6400, v13
  v_add_u32 v12, 28, v3
  v_mul_u32_u24 v155, 52, v12
  v_lshrrev_b32 v155, 8, v155
  v_lshrrev_b32 v13, 2, v155
  v_mul_u32_u24 v13, 6400, v13
  v_add3_u32 v13, v13, v15, s31
  v_add_u32 v165, 6400, v13
  v_add_u32 v12, 32, v3
  v_mul_u32_u24 v156, 52, v12
  v_lshrrev_b32 v156, 8, v156
  v_lshrrev_b32 v13, 2, v156
  v_mul_u32_u24 v13, 6400, v13
  v_add3_u32 v13, v13, v15, s31
  v_add_u32 v166, 6400, v13
  v_add_u32 v12, 36, v3
  v_mul_u32_u24 v157, 52, v12
  v_lshrrev_b32 v157, 8, v157
  v_lshrrev_b32 v13, 2, v157
  v_mul_u32_u24 v13, 6400, v13
  v_add3_u32 v13, v13, v15, s31
  v_add_u32 v167, 6400, v13
  v_and_b32 v12, 3, v2
  v_lshlrev_b32 v12, 2, v12
  v_lshrrev_b32 v13, 2, v2
  v_add3_u32 v12, v12, v13, 0
  v_mul_u32_u24 v168, 52, v12
  v_lshrrev_b32 v168, 8, v168
  v_and_b32 v12, 3, v2
  v_lshlrev_b32 v12, 2, v12
  v_lshrrev_b32 v13, 2, v2
  v_add3_u32 v12, v12, v13, 16
  v_mul_u32_u24 v169, 52, v12
  v_lshrrev_b32 v169, 8, v169
  v_and_b32 v12, 3, v2
  v_lshlrev_b32 v12, 2, v12
  v_lshrrev_b32 v13, 2, v2
  v_add3_u32 v12, v12, v13, 32
  v_mul_u32_u24 v170, 52, v12
  v_lshrrev_b32 v170, 8, v170
  s_add_u32 s32, s31, 13440
  v_mov_b32 v11, s32
  s_waitcnt vmcnt(0)
  s_waitcnt lgkmcnt(0)
  v_cmp_eq_u32 s[48:49], v128, v148
  v_cmp_eq_u32 s[50:51], v128, v149
  v_cmp_eq_u32 s[52:53], v129, v148
  v_cmp_eq_u32 s[54:55], v129, v149
  v_cndmask_b32 v12, v11, v138, s[48:49]
  ds_read_b128 v[240:243], v12 offset:0
  v_cmp_eq_u32 s[48:49], v129, v150
  v_cndmask_b32 v13, v11, v138, s[50:51]
  ds_read_b128 v[244:247], v13 offset:64
  v_cmp_eq_u32 s[50:51], v129, v151
  v_cndmask_b32 v12, v11, v139, s[52:53]
  ds_read_b128 v[248:251], v12 offset:0
  v_cmp_eq_u32 s[52:53], v130, v148
  v_cndmask_b32 v13, v11, v139, s[54:55]
  ds_read_b128 v[252:255], v13 offset:64
  s_waitcnt lgkmcnt(2)
  v_cvt_pk_bf16_f32 v20, v240, v241
  v_cvt_pk_bf16_f32 v21, v242, v243
  v_cvt_pk_bf16_f32 v22, v244, v245
  v_cvt_pk_bf16_f32 v23, v246, v247
  v_cmp_eq_u32 s[54:55], v130, v149
  v_cndmask_b32 v12, v11, v139, s[48:49]
  ds_read_b128 v[240:243], v12 offset:128
  v_cmp_eq_u32 s[48:49], v130, v150
  v_cndmask_b32 v13, v11, v139, s[50:51]
  ds_read_b128 v[244:247], v13 offset:192
  s_waitcnt lgkmcnt(2)
  v_cvt_pk_bf16_f32 v24, v248, v249
  v_cvt_pk_bf16_f32 v25, v250, v251
  v_cvt_pk_bf16_f32 v26, v252, v253
  v_cvt_pk_bf16_f32 v27, v254, v255
  v_cmp_eq_u32 s[50:51], v130, v151
  v_cndmask_b32 v12, v11, v140, s[52:53]
  ds_read_b128 v[248:251], v12 offset:0
  v_cmp_eq_u32 s[52:53], v131, v150
  v_cndmask_b32 v13, v11, v140, s[54:55]
  ds_read_b128 v[252:255], v13 offset:64
  s_waitcnt lgkmcnt(2)
  v_cvt_pk_bf16_f32 v28, v240, v241
  v_cvt_pk_bf16_f32 v29, v242, v243
  v_cvt_pk_bf16_f32 v30, v244, v245
  v_cvt_pk_bf16_f32 v31, v246, v247
  v_cmp_eq_u32 s[54:55], v131, v151
  v_cndmask_b32 v12, v11, v140, s[48:49]
  ds_read_b128 v[240:243], v12 offset:128
  v_cmp_eq_u32 s[48:49], v131, v152
  v_cndmask_b32 v13, v11, v140, s[50:51]
  ds_read_b128 v[244:247], v13 offset:192
  s_waitcnt lgkmcnt(2)
  v_cvt_pk_bf16_f32 v32, v248, v249
  v_cvt_pk_bf16_f32 v33, v250, v251
  v_cvt_pk_bf16_f32 v34, v252, v253
  v_cvt_pk_bf16_f32 v35, v254, v255
  v_cmp_eq_u32 s[50:51], v131, v153
  v_cndmask_b32 v12, v11, v141, s[52:53]
  ds_read_b128 v[248:251], v12 offset:128
  v_cmp_eq_u32 s[52:53], v132, v150
  v_cndmask_b32 v13, v11, v141, s[54:55]
  ds_read_b128 v[252:255], v13 offset:192
  s_waitcnt lgkmcnt(2)
  v_cvt_pk_bf16_f32 v36, v240, v241
  v_cvt_pk_bf16_f32 v37, v242, v243
  v_cvt_pk_bf16_f32 v38, v244, v245
  v_cvt_pk_bf16_f32 v39, v246, v247
  v_cmp_eq_u32 s[54:55], v132, v151
  v_cndmask_b32 v12, v11, v141, s[48:49]
  ds_read_b128 v[240:243], v12 offset:256
  v_cmp_eq_u32 s[48:49], v132, v152
  v_cndmask_b32 v13, v11, v141, s[50:51]
  ds_read_b128 v[244:247], v13 offset:320
  s_waitcnt lgkmcnt(2)
  v_cvt_pk_bf16_f32 v40, v248, v249
  v_cvt_pk_bf16_f32 v41, v250, v251
  v_cvt_pk_bf16_f32 v42, v252, v253
  v_cvt_pk_bf16_f32 v43, v254, v255
  v_cmp_eq_u32 s[50:51], v132, v153
  v_cndmask_b32 v12, v11, v142, s[52:53]
  ds_read_b128 v[248:251], v12 offset:128
  v_cmp_eq_u32 s[52:53], v133, v152
  v_cndmask_b32 v13, v11, v142, s[54:55]
  ds_read_b128 v[252:255], v13 offset:192
  s_waitcnt lgkmcnt(2)
  v_cvt_pk_bf16_f32 v44, v240, v241
  v_cvt_pk_bf16_f32 v45, v242, v243
  v_cvt_pk_bf16_f32 v46, v244, v245
  v_cvt_pk_bf16_f32 v47, v246, v247
  v_cmp_eq_u32 s[54:55], v133, v153
  v_cndmask_b32 v12, v11, v142, s[48:49]
  ds_read_b128 v[240:243], v12 offset:256
  v_cmp_eq_u32 s[48:49], v133, v154
  v_cndmask_b32 v13, v11, v142, s[50:51]
  ds_read_b128 v[244:247], v13 offset:320
  s_waitcnt lgkmcnt(2)
  v_cvt_pk_bf16_f32 v48, v248, v249
  v_cvt_pk_bf16_f32 v49, v250, v251
  v_cvt_pk_bf16_f32 v50, v252, v253
  v_cvt_pk_bf16_f32 v51, v254, v255
  v_cmp_eq_u32 s[50:51], v133, v155
  v_cndmask_b32 v12, v11, v143, s[52:53]
  ds_read_b128 v[248:251], v12 offset:256
  v_cmp_eq_u32 s[52:53], v134, v152
  v_cndmask_b32 v13, v11, v143, s[54:55]
  ds_read_b128 v[252:255], v13 offset:320
  s_waitcnt lgkmcnt(2)
  v_cvt_pk_bf16_f32 v52, v240, v241
  v_cvt_pk_bf16_f32 v53, v242, v243
  v_cvt_pk_bf16_f32 v54, v244, v245
  v_cvt_pk_bf16_f32 v55, v246, v247
  v_cmp_eq_u32 s[54:55], v134, v153
  v_cndmask_b32 v12, v11, v143, s[48:49]
  ds_read_b128 v[240:243], v12 offset:384
  v_cmp_eq_u32 s[48:49], v134, v154
  v_cndmask_b32 v13, v11, v143, s[50:51]
  ds_read_b128 v[244:247], v13 offset:448
  s_waitcnt lgkmcnt(2)
  v_cvt_pk_bf16_f32 v56, v248, v249
  v_cvt_pk_bf16_f32 v57, v250, v251
  v_cvt_pk_bf16_f32 v58, v252, v253
  v_cvt_pk_bf16_f32 v59, v254, v255
  v_cmp_eq_u32 s[50:51], v134, v155
  v_cndmask_b32 v12, v11, v144, s[52:53]
  ds_read_b128 v[248:251], v12 offset:256
  v_cmp_eq_u32 s[52:53], v135, v154
  v_cndmask_b32 v13, v11, v144, s[54:55]
  ds_read_b128 v[252:255], v13 offset:320
  s_waitcnt lgkmcnt(2)
  v_cvt_pk_bf16_f32 v60, v240, v241
  v_cvt_pk_bf16_f32 v61, v242, v243
  v_cvt_pk_bf16_f32 v62, v244, v245
  v_cvt_pk_bf16_f32 v63, v246, v247
  v_cmp_eq_u32 s[54:55], v135, v155
  v_cndmask_b32 v12, v11, v144, s[48:49]
  ds_read_b128 v[240:243], v12 offset:384
  v_cmp_eq_u32 s[48:49], v135, v156
  v_cndmask_b32 v13, v11, v144, s[50:51]
  ds_read_b128 v[244:247], v13 offset:448
  s_waitcnt lgkmcnt(2)
  v_cvt_pk_bf16_f32 v64, v248, v249
  v_cvt_pk_bf16_f32 v65, v250, v251
  v_cvt_pk_bf16_f32 v66, v252, v253
  v_cvt_pk_bf16_f32 v67, v254, v255
  v_cmp_eq_u32 s[50:51], v135, v157
  v_cndmask_b32 v12, v11, v145, s[52:53]
  ds_read_b128 v[248:251], v12 offset:384
  v_cmp_eq_u32 s[52:53], v136, v154
  v_cndmask_b32 v13, v11, v145, s[54:55]
  ds_read_b128 v[252:255], v13 offset:448
  s_waitcnt lgkmcnt(2)
  v_cvt_pk_bf16_f32 v68, v240, v241
  v_cvt_pk_bf16_f32 v69, v242, v243
  v_cvt_pk_bf16_f32 v70, v244, v245
  v_cvt_pk_bf16_f32 v71, v246, v247
  v_cmp_eq_u32 s[54:55], v136, v155
  v_cndmask_b32 v12, v11, v145, s[48:49]
  ds_read_b128 v[240:243], v12 offset:512
  v_cmp_eq_u32 s[48:49], v136, v156
  v_cndmask_b32 v13, v11, v145, s[50:51]
  ds_read_b128 v[244:247], v13 offset:576
  s_waitcnt lgkmcnt(2)
  v_cvt_pk_bf16_f32 v72, v248, v249
  v_cvt_pk_bf16_f32 v73, v250, v251
  v_cvt_pk_bf16_f32 v74, v252, v253
  v_cvt_pk_bf16_f32 v75, v254, v255
  v_cmp_eq_u32 s[50:51], v136, v157
  v_cndmask_b32 v12, v11, v146, s[52:53]
  ds_read_b128 v[248:251], v12 offset:384
  v_cmp_eq_u32 s[52:53], v137, v156
  v_cndmask_b32 v13, v11, v146, s[54:55]
  ds_read_b128 v[252:255], v13 offset:448
  s_waitcnt lgkmcnt(2)
  v_cvt_pk_bf16_f32 v76, v240, v241
  v_cvt_pk_bf16_f32 v77, v242, v243
  v_cvt_pk_bf16_f32 v78, v244, v245
  v_cvt_pk_bf16_f32 v79, v246, v247
  v_cmp_eq_u32 s[54:55], v137, v157
  v_cndmask_b32 v12, v11, v146, s[48:49]
  ds_read_b128 v[240:243], v12 offset:512
  v_cmp_eq_u32 s[48:49], v168, v148
  v_cndmask_b32 v13, v11, v146, s[50:51]
  ds_read_b128 v[244:247], v13 offset:576
  s_waitcnt lgkmcnt(2)
  v_cvt_pk_bf16_f32 v80, v248, v249
  v_cvt_pk_bf16_f32 v81, v250, v251
  v_cvt_pk_bf16_f32 v82, v252, v253
  v_cvt_pk_bf16_f32 v83, v254, v255
  v_cmp_eq_u32 s[50:51], v168, v149
  v_cndmask_b32 v12, v11, v147, s[52:53]
  ds_read_b128 v[248:251], v12 offset:512
  v_cmp_eq_u32 s[52:53], v168, v150
  v_cndmask_b32 v13, v11, v147, s[54:55]
  ds_read_b128 v[252:255], v13 offset:576
  s_waitcnt lgkmcnt(2)
  v_cvt_pk_bf16_f32 v84, v240, v241
  v_cvt_pk_bf16_f32 v85, v242, v243
  v_cvt_pk_bf16_f32 v86, v244, v245
  v_cvt_pk_bf16_f32 v87, v246, v247
  v_cmp_eq_u32 s[54:55], v168, v151
  v_cndmask_b32 v12, v11, v158, s[48:49]
  ds_read_b128 v[240:243], v12 offset:0
  v_cmp_eq_u32 s[48:49], v168, v152
  v_cndmask_b32 v13, v11, v159, s[50:51]
  ds_read_b128 v[244:247], v13 offset:64
  s_waitcnt lgkmcnt(2)
  v_cvt_pk_bf16_f32 v88, v248, v249
  v_cvt_pk_bf16_f32 v89, v250, v251
  v_cvt_pk_bf16_f32 v90, v252, v253
  v_cvt_pk_bf16_f32 v91, v254, v255
  v_cmp_eq_u32 s[50:51], v168, v153
  v_cndmask_b32 v12, v11, v160, s[52:53]
  ds_read_b128 v[248:251], v12 offset:128
  v_cmp_eq_u32 s[52:53], v169, v150
  v_cndmask_b32 v13, v11, v161, s[54:55]
  ds_read_b128 v[252:255], v13 offset:192
  s_waitcnt lgkmcnt(2)
  v_cvt_pk_bf16_f32 v92, v240, v241
  v_cvt_pk_bf16_f32 v93, v242, v243
  v_cvt_pk_bf16_f32 v94, v244, v245
  v_cvt_pk_bf16_f32 v95, v246, v247
  v_cmp_eq_u32 s[54:55], v169, v151
  v_cndmask_b32 v12, v11, v162, s[48:49]
  ds_read_b128 v[240:243], v12 offset:256
  v_cmp_eq_u32 s[48:49], v169, v152
  v_cndmask_b32 v13, v11, v163, s[50:51]
  ds_read_b128 v[244:247], v13 offset:320
  s_waitcnt lgkmcnt(2)
  v_cvt_pk_bf16_f32 v96, v248, v249
  v_cvt_pk_bf16_f32 v97, v250, v251
  v_cvt_pk_bf16_f32 v98, v252, v253
  v_cvt_pk_bf16_f32 v99, v254, v255
  v_cmp_eq_u32 s[50:51], v169, v153
  v_cndmask_b32 v12, v11, v160, s[52:53]
  ds_read_b128 v[248:251], v12 offset:128
  v_cmp_eq_u32 s[52:53], v169, v154
  v_cndmask_b32 v13, v11, v161, s[54:55]
  ds_read_b128 v[252:255], v13 offset:192
  s_waitcnt lgkmcnt(2)
  v_cvt_pk_bf16_f32 v100, v240, v241
  v_cvt_pk_bf16_f32 v101, v242, v243
  v_cvt_pk_bf16_f32 v102, v244, v245
  v_cvt_pk_bf16_f32 v103, v246, v247
  v_cmp_eq_u32 s[54:55], v169, v155
  v_cndmask_b32 v12, v11, v162, s[48:49]
  ds_read_b128 v[240:243], v12 offset:256
  v_cmp_eq_u32 s[48:49], v169, v156
  v_cndmask_b32 v13, v11, v163, s[50:51]
  ds_read_b128 v[244:247], v13 offset:320
  s_waitcnt lgkmcnt(2)
  v_cvt_pk_bf16_f32 v104, v248, v249
  v_cvt_pk_bf16_f32 v105, v250, v251
  v_cvt_pk_bf16_f32 v106, v252, v253
  v_cvt_pk_bf16_f32 v107, v254, v255
  v_cmp_eq_u32 s[50:51], v169, v157
  v_cndmask_b32 v12, v11, v164, s[52:53]
  ds_read_b128 v[248:251], v12 offset:384
  v_cmp_eq_u32 s[52:53], v170, v154
  v_cndmask_b32 v13, v11, v165, s[54:55]
  ds_read_b128 v[252:255], v13 offset:448
  s_waitcnt lgkmcnt(2)
  v_cvt_pk_bf16_f32 v108, v240, v241
  v_cvt_pk_bf16_f32 v109, v242, v243
  v_cvt_pk_bf16_f32 v110, v244, v245
  v_cvt_pk_bf16_f32 v111, v246, v247
  v_cmp_eq_u32 s[54:55], v170, v155
  v_cndmask_b32 v12, v11, v166, s[48:49]
  ds_read_b128 v[240:243], v12 offset:512
  v_cmp_eq_u32 s[48:49], v170, v156
  v_cndmask_b32 v13, v11, v167, s[50:51]
  ds_read_b128 v[244:247], v13 offset:576
  s_waitcnt lgkmcnt(2)
  v_cvt_pk_bf16_f32 v112, v248, v249
  v_cvt_pk_bf16_f32 v113, v250, v251
  v_cvt_pk_bf16_f32 v114, v252, v253
  v_cvt_pk_bf16_f32 v115, v254, v255
  v_cmp_eq_u32 s[50:51], v170, v157
  v_cndmask_b32 v12, v11, v164, s[52:53]
  ds_read_b128 v[248:251], v12 offset:384
  s_nop 0
  v_cndmask_b32 v13, v11, v165, s[54:55]
  ds_read_b128 v[252:255], v13 offset:448
  s_waitcnt lgkmcnt(2)
  v_cvt_pk_bf16_f32 v116, v240, v241
  v_cvt_pk_bf16_f32 v117, v242, v243
  v_cvt_pk_bf16_f32 v118, v244, v245
  v_cvt_pk_bf16_f32 v119, v246, v247
  s_nop 0
  v_cndmask_b32 v12, v11, v166, s[48:49]
  ds_read_b128 v[240:243], v12 offset:512
  s_nop 0
  v_cndmask_b32 v13, v11, v167, s[50:51]
  ds_read_b128 v[244:247], v13 offset:576
  s_waitcnt lgkmcnt(2)
  v_cvt_pk_bf16_f32 v120, v248, v249
  v_cvt_pk_bf16_f32 v121, v250, v251
  v_cvt_pk_bf16_f32 v122, v252, v253
  v_cvt_pk_bf16_f32 v123, v254, v255
  s_waitcnt lgkmcnt(0)
  v_cvt_pk_bf16_f32 v124, v240, v241
  v_cvt_pk_bf16_f32 v125, v242, v243
  v_cvt_pk_bf16_f32 v126, v244, v245
  v_cvt_pk_bf16_f32 v127, v246, v247
  s_mov_b32 s46, 0x358637bd
  v_add_u32 v14, s31, v9
  v_mfma_f32_16x16x32_bf16 v[216:219], v[92:95], v[176:179], 0
  v_mfma_f32_16x16x32_bf16 v[220:223], v[104:107], v[180:183], 0
  v_mfma_f32_16x16x32_bf16 v[224:227], v[120:123], v[188:191], 0
  v_mfma_f32_16x16x32_bf16 v[128:131], v[20:23], v[176:179], 0
  v_mfma_f32_16x16x32_bf16 v[132:135], v[24:27], v[176:179], 0
  v_mfma_f32_16x16x32_bf16 v[136:139], v[32:35], v[176:179], 0
  v_mfma_f32_16x16x32_bf16 v[140:143], v[40:43], v[180:183], 0
  v_mfma_f32_16x16x32_bf16 v[216:219], v[96:99], v[180:183], v[216:219]
  v_mfma_f32_16x16x32_bf16 v[220:223], v[108:111], v[184:187], v[220:223]
  v_mfma_f32_16x16x32_bf16 v[224:227], v[124:127], v[192:195], v[224:227]
  v_mfma_f32_16x16x32_bf16 v[144:147], v[48:51], v[180:183], 0
  v_mfma_f32_16x16x32_bf16 v[148:151], v[56:59], v[184:187], 0
  v_mfma_f32_16x16x32_bf16 v[152:155], v[64:67], v[184:187], 0
  v_mfma_f32_16x16x32_bf16 v[156:159], v[72:75], v[188:191], 0
  v_mfma_f32_16x16x32_bf16 v[216:219], v[100:103], v[184:187], v[216:219]
  v_mfma_f32_16x16x32_bf16 v[220:223], v[112:115], v[188:191], v[220:223]
  v_mfma_f32_16x16x32_bf16 v[160:163], v[80:83], v[188:191], 0
  v_mfma_f32_16x16x32_bf16 v[164:167], v[88:91], v[192:195], 0
  v_mfma_f32_16x16x32_bf16 v[132:135], v[28:31], v[180:183], v[132:135]
  v_mfma_f32_16x16x32_bf16 v[136:139], v[36:39], v[180:183], v[136:139]
  v_mfma_f32_16x16x32_bf16 v[140:143], v[44:47], v[184:187], v[140:143]
  v_mfma_f32_16x16x32_bf16 v[220:223], v[116:119], v[192:195], v[220:223]
  v_mfma_f32_16x16x32_bf16 v[144:147], v[52:55], v[184:187], v[144:147]
  v_mfma_f32_16x16x32_bf16 v[148:151], v[60:63], v[188:191], v[148:151]
  v_mfma_f32_16x16x32_bf16 v[152:155], v[68:71], v[188:191], v[152:155]
  v_mfma_f32_16x16x32_bf16 v[156:159], v[76:79], v[192:195], v[156:159]
  v_mfma_f32_16x16x32_bf16 v[160:163], v[84:87], v[192:195], v[160:163]
  buffer_load_dwordx4 v[176:179], v9, s[20:23], s45 offen offset:0
  buffer_load_dwordx4 v[180:183], v9, s[20:23], s45 offen offset:1024
  buffer_load_dwordx4 v[184:187], v9, s[20:23], s45 offen offset:2048
  buffer_load_dwordx4 v[188:191], v9, s[20:23], s45 offen offset:3072
  s_add_u32 s32, s45, 4096
  buffer_load_dwordx4 v[192:195], v9, s[20:23], s32 offen
  s_add_u32 s45, s45, 20480
  s_nop 7
  v_add_f32 v228, s46, v216
  v_add_f32 v229, s46, v217
  v_add_f32 v230, s46, v218
  v_add_f32 v231, s46, v219
  v_add_f32 v232, s46, v220
  v_add_f32 v233, s46, v221
  v_add_f32 v234, s46, v222
  v_add_f32 v235, s46, v223
  v_add_f32 v236, s46, v224
  v_add_f32 v237, s46, v225
  v_rcp_f32 v228, v228
  v_rcp_f32 v229, v229
  v_rcp_f32 v230, v230
  v_rcp_f32 v231, v231
  v_rcp_f32 v232, v232
  v_rcp_f32 v233, v233
  v_rcp_f32 v234, v234
  v_rcp_f32 v235, v235
  v_rcp_f32 v236, v236
  v_rcp_f32 v237, v237
  s_nop 1
  v_mul_f32 v128, v128, v228
  v_mul_f32 v129, v129, v228
  v_mul_f32 v130, v130, v228
  v_mul_f32 v131, v131, v228
  v_mul_f32 v132, v132, v229
  v_mul_f32 v133, v133, v229
  v_mul_f32 v134, v134, v229
  v_mul_f32 v135, v135, v229
  v_cvt_pk_bf16_f32 v128, v128, v129
  v_cvt_pk_bf16_f32 v129, v130, v131
  v_cvt_pk_bf16_f32 v130, v132, v133
  v_cvt_pk_bf16_f32 v131, v134, v135
  ds_write_b128 v14, v[128:131] offset:0
  v_mul_f32 v136, v136, v230
  v_mul_f32 v137, v137, v230
  v_mul_f32 v138, v138, v230
  v_mul_f32 v139, v139, v230
  v_mul_f32 v140, v140, v231
  v_mul_f32 v141, v141, v231
  v_mul_f32 v142, v142, v231
  v_mul_f32 v143, v143, v231
  v_cvt_pk_bf16_f32 v136, v136, v137
  v_cvt_pk_bf16_f32 v137, v138, v139
  v_cvt_pk_bf16_f32 v138, v140, v141
  v_cvt_pk_bf16_f32 v139, v142, v143
  ds_write_b128 v14, v[136:139] offset:1024
  v_mul_f32 v144, v144, v232
  v_mul_f32 v145, v145, v232
  v_mul_f32 v146, v146, v232
  v_mul_f32 v147, v147, v232
  v_mul_f32 v148, v148, v233
  v_mul_f32 v149, v149, v233
  v_mul_f32 v150, v150, v233
  v_mul_f32 v151, v151, v233
  v_cvt_pk_bf16_f32 v144, v144, v145
  v_cvt_pk_bf16_f32 v145, v146, v147
  v_cvt_pk_bf16_f32 v146, v148, v149
  v_cvt_pk_bf16_f32 v147, v150, v151
  ds_write_b128 v14, v[144:147] offset:2048
  v_mul_f32 v152, v152, v234
  v_mul_f32 v153, v153, v234
  v_mul_f32 v154, v154, v234
  v_mul_f32 v155, v155, v234
  v_mul_f32 v156, v156, v235
  v_mul_f32 v157, v157, v235
  v_mul_f32 v158, v158, v235
  v_mul_f32 v159, v159, v235
  v_cvt_pk_bf16_f32 v152, v152, v153
  v_cvt_pk_bf16_f32 v153, v154, v155
  v_cvt_pk_bf16_f32 v154, v156, v157
  v_cvt_pk_bf16_f32 v155, v158, v159
  ds_write_b128 v14, v[152:155] offset:3072
  v_mul_f32 v160, v160, v236
  v_mul_f32 v161, v161, v236
  v_mul_f32 v162, v162, v236
  v_mul_f32 v163, v163, v236
  v_mul_f32 v164, v164, v237
  v_mul_f32 v165, v165, v237
  v_mul_f32 v166, v166, v237
  v_mul_f32 v167, v167, v237
  v_cvt_pk_bf16_f32 v160, v160, v161
  v_cvt_pk_bf16_f32 v161, v162, v163
  v_cvt_pk_bf16_f32 v162, v164, v165
  v_cvt_pk_bf16_f32 v163, v166, v167
  ds_write_b128 v14, v[160:163] offset:4096
  v_mfma_f32_16x16x32_bf16 v[216:219], v[92:95], v[196:199], 0
  v_mfma_f32_16x16x32_bf16 v[220:223], v[104:107], v[200:203], 0
  v_mfma_f32_16x16x32_bf16 v[224:227], v[120:123], v[208:211], 0
  v_mfma_f32_16x16x32_bf16 v[128:131], v[20:23], v[196:199], 0
  v_mfma_f32_16x16x32_bf16 v[132:135], v[24:27], v[196:199], 0
  v_mfma_f32_16x16x32_bf16 v[136:139], v[32:35], v[196:199], 0
  v_mfma_f32_16x16x32_bf16 v[140:143], v[40:43], v[200:203], 0
  v_mfma_f32_16x16x32_bf16 v[216:219], v[96:99], v[200:203], v[216:219]
  v_mfma_f32_16x16x32_bf16 v[220:223], v[108:111], v[204:207], v[220:223]
  v_mfma_f32_16x16x32_bf16 v[224:227], v[124:127], v[212:215], v[224:227]
  v_mfma_f32_16x16x32_bf16 v[144:147], v[48:51], v[200:203], 0
  v_mfma_f32_16x16x32_bf16 v[148:151], v[56:59], v[204:207], 0
  v_mfma_f32_16x16x32_bf16 v[152:155], v[64:67], v[204:207], 0
  v_mfma_f32_16x16x32_bf16 v[156:159], v[72:75], v[208:211], 0
  v_mfma_f32_16x16x32_bf16 v[216:219], v[100:103], v[204:207], v[216:219]
  v_mfma_f32_16x16x32_bf16 v[220:223], v[112:115], v[208:211], v[220:223]
  v_mfma_f32_16x16x32_bf16 v[160:163], v[80:83], v[208:211], 0
  v_mfma_f32_16x16x32_bf16 v[164:167], v[88:91], v[212:215], 0
  v_mfma_f32_16x16x32_bf16 v[132:135], v[28:31], v[200:203], v[132:135]
  v_mfma_f32_16x16x32_bf16 v[136:139], v[36:39], v[200:203], v[136:139]
  v_mfma_f32_16x16x32_bf16 v[140:143], v[44:47], v[204:207], v[140:143]
  v_mfma_f32_16x16x32_bf16 v[220:223], v[116:119], v[212:215], v[220:223]
  v_mfma_f32_16x16x32_bf16 v[144:147], v[52:55], v[204:207], v[144:147]
  v_mfma_f32_16x16x32_bf16 v[148:151], v[60:63], v[208:211], v[148:151]
  v_mfma_f32_16x16x32_bf16 v[152:155], v[68:71], v[208:211], v[152:155]
  v_mfma_f32_16x16x32_bf16 v[156:159], v[76:79], v[212:215], v[156:159]
  v_mfma_f32_16x16x32_bf16 v[160:163], v[84:87], v[212:215], v[160:163]
  buffer_load_dwordx4 v[196:199], v9, s[20:23], s45 offen offset:0
  buffer_load_dwordx4 v[200:203], v9, s[20:23], s45 offen offset:1024
  buffer_load_dwordx4 v[204:207], v9, s[20:23], s45 offen offset:2048
  buffer_load_dwordx4 v[208:211], v9, s[20:23], s45 offen offset:3072
  s_add_u32 s32, s45, 4096
  buffer_load_dwordx4 v[212:215], v9, s[20:23], s32 offen
  s_add_u32 s45, s45, 20480
  s_nop 7
  v_add_f32 v228, s46, v216
  v_add_f32 v229, s46, v217
  v_add_f32 v230, s46, v218
  v_add_f32 v231, s46, v219
  v_add_f32 v232, s46, v220
  v_add_f32 v233, s46, v221
  v_add_f32 v234, s46, v222
  v_add_f32 v235, s46, v223
  v_add_f32 v236, s46, v224
  v_add_f32 v237, s46, v225
  v_rcp_f32 v228, v228
  v_rcp_f32 v229, v229
  v_rcp_f32 v230, v230
  v_rcp_f32 v231, v231
  v_rcp_f32 v232, v232
  v_rcp_f32 v233, v233
  v_rcp_f32 v234, v234
  v_rcp_f32 v235, v235
  v_rcp_f32 v236, v236
  v_rcp_f32 v237, v237
  s_nop 1
  v_mul_f32 v128, v128, v228
  v_mul_f32 v129, v129, v228
  v_mul_f32 v130, v130, v228
  v_mul_f32 v131, v131, v228
  v_mul_f32 v132, v132, v229
  v_mul_f32 v133, v133, v229
  v_mul_f32 v134, v134, v229
  v_mul_f32 v135, v135, v229
  v_cvt_pk_bf16_f32 v128, v128, v129
  v_cvt_pk_bf16_f32 v129, v130, v131
  v_cvt_pk_bf16_f32 v130, v132, v133
  v_cvt_pk_bf16_f32 v131, v134, v135
  ds_write_b128 v14, v[128:131] offset:5120
  v_mul_f32 v136, v136, v230
  v_mul_f32 v137, v137, v230
  v_mul_f32 v138, v138, v230
  v_mul_f32 v139, v139, v230
  v_mul_f32 v140, v140, v231
  v_mul_f32 v141, v141, v231
  v_mul_f32 v142, v142, v231
  v_mul_f32 v143, v143, v231
  v_cvt_pk_bf16_f32 v136, v136, v137
  v_cvt_pk_bf16_f32 v137, v138, v139
  v_cvt_pk_bf16_f32 v138, v140, v141
  v_cvt_pk_bf16_f32 v139, v142, v143
  ds_write_b128 v14, v[136:139] offset:6144
  v_mul_f32 v144, v144, v232
  v_mul_f32 v145, v145, v232
  v_mul_f32 v146, v146, v232
  v_mul_f32 v147, v147, v232
  v_mul_f32 v148, v148, v233
  v_mul_f32 v149, v149, v233
  v_mul_f32 v150, v150, v233
  v_mul_f32 v151, v151, v233
  v_cvt_pk_bf16_f32 v144, v144, v145
  v_cvt_pk_bf16_f32 v145, v146, v147
  v_cvt_pk_bf16_f32 v146, v148, v149
  v_cvt_pk_bf16_f32 v147, v150, v151
  ds_write_b128 v14, v[144:147] offset:7168
  v_mul_f32 v152, v152, v234
  v_mul_f32 v153, v153, v234
  v_mul_f32 v154, v154, v234
  v_mul_f32 v155, v155, v234
  v_mul_f32 v156, v156, v235
  v_mul_f32 v157, v157, v235
  v_mul_f32 v158, v158, v235
  v_mul_f32 v159, v159, v235
  v_cvt_pk_bf16_f32 v152, v152, v153
  v_cvt_pk_bf16_f32 v153, v154, v155
  v_cvt_pk_bf16_f32 v154, v156, v157
  v_cvt_pk_bf16_f32 v155, v158, v159
  ds_write_b128 v14, v[152:155] offset:8192
  v_mul_f32 v160, v160, v236
  v_mul_f32 v161, v161, v236
  v_mul_f32 v162, v162, v236
  v_mul_f32 v163, v163, v236
  v_mul_f32 v164, v164, v237
  v_mul_f32 v165, v165, v237
  v_mul_f32 v166, v166, v237
  v_mul_f32 v167, v167, v237
  v_cvt_pk_bf16_f32 v160, v160, v161
  v_cvt_pk_bf16_f32 v161, v162, v163
  v_cvt_pk_bf16_f32 v162, v164, v165
  v_cvt_pk_bf16_f32 v163, v166, v167
  ds_write_b128 v14, v[160:163] offset:9216
  s_waitcnt vmcnt(5)
  v_mfma_f32_16x16x32_bf16 v[216:219], v[92:95], v[176:179], 0
  v_mfma_f32_16x16x32_bf16 v[220:223], v[104:107], v[180:183], 0
  v_mfma_f32_16x16x32_bf16 v[224:227], v[120:123], v[188:191], 0
  v_mfma_f32_16x16x32_bf16 v[128:131], v[20:23], v[176:179], 0
  v_mfma_f32_16x16x32_bf16 v[132:135], v[24:27], v[176:179], 0
  v_mfma_f32_16x16x32_bf16 v[136:139], v[32:35], v[176:179], 0
  v_mfma_f32_16x16x32_bf16 v[140:143], v[40:43], v[180:183], 0
  v_mfma_f32_16x16x32_bf16 v[216:219], v[96:99], v[180:183], v[216:219]
  v_mfma_f32_16x16x32_bf16 v[220:223], v[108:111], v[184:187], v[220:223]
  v_mfma_f32_16x16x32_bf16 v[224:227], v[124:127], v[192:195], v[224:227]
  v_mfma_f32_16x16x32_bf16 v[144:147], v[48:51], v[180:183], 0
  v_mfma_f32_16x16x32_bf16 v[148:151], v[56:59], v[184:187], 0
  v_mfma_f32_16x16x32_bf16 v[152:155], v[64:67], v[184:187], 0
  v_mfma_f32_16x16x32_bf16 v[156:159], v[72:75], v[188:191], 0
  v_mfma_f32_16x16x32_bf16 v[216:219], v[100:103], v[184:187], v[216:219]
  v_mfma_f32_16x16x32_bf16 v[220:223], v[112:115], v[188:191], v[220:223]
  v_mfma_f32_16x16x32_bf16 v[160:163], v[80:83], v[188:191], 0
  v_mfma_f32_16x16x32_bf16 v[164:167], v[88:91], v[192:195], 0
  v_mfma_f32_16x16x32_bf16 v[132:135], v[28:31], v[180:183], v[132:135]
  v_mfma_f32_16x16x32_bf16 v[136:139], v[36:39], v[180:183], v[136:139]
  v_mfma_f32_16x16x32_bf16 v[140:143], v[44:47], v[184:187], v[140:143]
  v_mfma_f32_16x16x32_bf16 v[220:223], v[116:119], v[192:195], v[220:223]
  v_mfma_f32_16x16x32_bf16 v[144:147], v[52:55], v[184:187], v[144:147]
  v_mfma_f32_16x16x32_bf16 v[148:151], v[60:63], v[188:191], v[148:151]
  v_mfma_f32_16x16x32_bf16 v[152:155], v[68:71], v[188:191], v[152:155]
  v_mfma_f32_16x16x32_bf16 v[156:159], v[76:79], v[192:195], v[156:159]
  v_mfma_f32_16x16x32_bf16 v[160:163], v[84:87], v[192:195], v[160:163]
  s_nop 7
  v_add_f32 v228, s46, v216
  v_add_f32 v229, s46, v217
  v_add_f32 v230, s46, v218
  v_add_f32 v231, s46, v219
  v_add_f32 v232, s46, v220
  v_add_f32 v233, s46, v221
  v_add_f32 v234, s46, v222
  v_add_f32 v235, s46, v223
  v_add_f32 v236, s46, v224
  v_add_f32 v237, s46, v225
  v_rcp_f32 v228, v228
  v_rcp_f32 v229, v229
  v_rcp_f32 v230, v230
  v_rcp_f32 v231, v231
  v_rcp_f32 v232, v232
  v_rcp_f32 v233, v233
  v_rcp_f32 v234, v234
  v_rcp_f32 v235, v235
  v_rcp_f32 v236, v236
  v_rcp_f32 v237, v237
  s_nop 1
  v_mul_f32 v128, v128, v228
  v_mul_f32 v129, v129, v228
  v_mul_f32 v130, v130, v228
  v_mul_f32 v131, v131, v228
  v_mul_f32 v132, v132, v229
  v_mul_f32 v133, v133, v229
  v_mul_f32 v134, v134, v229
  v_mul_f32 v135, v135, v229
  v_cvt_pk_bf16_f32 v128, v128, v129
  v_cvt_pk_bf16_f32 v129, v130, v131
  v_cvt_pk_bf16_f32 v130, v132, v133
  v_cvt_pk_bf16_f32 v131, v134, v135
  ds_write_b128 v14, v[128:131] offset:10240
  v_mul_f32 v136, v136, v230
  v_mul_f32 v137, v137, v230
  v_mul_f32 v138, v138, v230
  v_mul_f32 v139, v139, v230
  v_mul_f32 v140, v140, v231
  v_mul_f32 v141, v141, v231
  v_mul_f32 v142, v142, v231
  v_mul_f32 v143, v143, v231
  v_cvt_pk_bf16_f32 v136, v136, v137
  v_cvt_pk_bf16_f32 v137, v138, v139
  v_cvt_pk_bf16_f32 v138, v140, v141
  v_cvt_pk_bf16_f32 v139, v142, v143
  ds_write_b128 v14, v[136:139] offset:11264
  v_mul_f32 v144, v144, v232
  v_mul_f32 v145, v145, v232
  v_mul_f32 v146, v146, v232
  v_mul_f32 v147, v147, v232
  v_mul_f32 v148, v148, v233
  v_mul_f32 v149, v149, v233
  v_mul_f32 v150, v150, v233
  v_mul_f32 v151, v151, v233
  v_cvt_pk_bf16_f32 v144, v144, v145
  v_cvt_pk_bf16_f32 v145, v146, v147
  v_cvt_pk_bf16_f32 v146, v148, v149
  v_cvt_pk_bf16_f32 v147, v150, v151
  ds_write_b128 v14, v[144:147] offset:12288
  v_mul_f32 v152, v152, v234
  v_mul_f32 v153, v153, v234
  v_mul_f32 v154, v154, v234
  v_mul_f32 v155, v155, v234
  v_mul_f32 v156, v156, v235
  v_mul_f32 v157, v157, v235
  v_mul_f32 v158, v158, v235
  v_mul_f32 v159, v159, v235
  v_cvt_pk_bf16_f32 v152, v152, v153
  v_cvt_pk_bf16_f32 v153, v154, v155
  v_cvt_pk_bf16_f32 v154, v156, v157
  v_cvt_pk_bf16_f32 v155, v158, v159
  ds_write_b128 v14, v[152:155] offset:13312
  v_mul_f32 v160, v160, v236
  v_mul_f32 v161, v161, v236
  v_mul_f32 v162, v162, v236
  v_mul_f32 v163, v163, v236
  v_mul_f32 v164, v164, v237
  v_mul_f32 v165, v165, v237
  v_mul_f32 v166, v166, v237
  v_mul_f32 v167, v167, v237
  v_cvt_pk_bf16_f32 v160, v160, v161
  v_cvt_pk_bf16_f32 v161, v162, v163
  v_cvt_pk_bf16_f32 v162, v164, v165
  v_cvt_pk_bf16_f32 v163, v166, v167
  ds_write_b128 v14, v[160:163] offset:14336
  s_waitcnt vmcnt(0)
  v_mfma_f32_16x16x32_bf16 v[216:219], v[92:95], v[196:199], 0
  v_mfma_f32_16x16x32_bf16 v[220:223], v[104:107], v[200:203], 0
  v_mfma_f32_16x16x32_bf16 v[224:227], v[120:123], v[208:211], 0
  v_mfma_f32_16x16x32_bf16 v[128:131], v[20:23], v[196:199], 0
  v_mfma_f32_16x16x32_bf16 v[132:135], v[24:27], v[196:199], 0
  v_mfma_f32_16x16x32_bf16 v[136:139], v[32:35], v[196:199], 0
  v_mfma_f32_16x16x32_bf16 v[140:143], v[40:43], v[200:203], 0
  v_mfma_f32_16x16x32_bf16 v[216:219], v[96:99], v[200:203], v[216:219]
  v_mfma_f32_16x16x32_bf16 v[220:223], v[108:111], v[204:207], v[220:223]
  v_mfma_f32_16x16x32_bf16 v[224:227], v[124:127], v[212:215], v[224:227]
  v_mfma_f32_16x16x32_bf16 v[144:147], v[48:51], v[200:203], 0
  v_mfma_f32_16x16x32_bf16 v[148:151], v[56:59], v[204:207], 0
  v_mfma_f32_16x16x32_bf16 v[152:155], v[64:67], v[204:207], 0
  v_mfma_f32_16x16x32_bf16 v[156:159], v[72:75], v[208:211], 0
  v_mfma_f32_16x16x32_bf16 v[216:219], v[100:103], v[204:207], v[216:219]
  v_mfma_f32_16x16x32_bf16 v[220:223], v[112:115], v[208:211], v[220:223]
  v_mfma_f32_16x16x32_bf16 v[160:163], v[80:83], v[208:211], 0
  v_mfma_f32_16x16x32_bf16 v[164:167], v[88:91], v[212:215], 0
  v_mfma_f32_16x16x32_bf16 v[132:135], v[28:31], v[200:203], v[132:135]
  v_mfma_f32_16x16x32_bf16 v[136:139], v[36:39], v[200:203], v[136:139]
  v_mfma_f32_16x16x32_bf16 v[140:143], v[44:47], v[204:207], v[140:143]
  v_mfma_f32_16x16x32_bf16 v[220:223], v[116:119], v[212:215], v[220:223]
  v_mfma_f32_16x16x32_bf16 v[144:147], v[52:55], v[204:207], v[144:147]
  v_mfma_f32_16x16x32_bf16 v[148:151], v[60:63], v[208:211], v[148:151]
  v_mfma_f32_16x16x32_bf16 v[152:155], v[68:71], v[208:211], v[152:155]
  v_mfma_f32_16x16x32_bf16 v[156:159], v[76:79], v[212:215], v[156:159]
  v_mfma_f32_16x16x32_bf16 v[160:163], v[84:87], v[212:215], v[160:163]
  buffer_load_dwordx4 v[20:23], v9, s[20:23], s40 offen offset:0
  buffer_load_dwordx4 v[24:27], v9, s[20:23], s40 offen offset:1024
  buffer_load_dwordx4 v[28:31], v9, s[20:23], s40 offen offset:2048
  buffer_load_dwordx4 v[32:35], v9, s[20:23], s40 offen offset:3072
  s_add_u32 s32, s40, 4096
  buffer_load_dwordx4 v[36:39], v9, s[20:23], s32 offen
  s_add_u32 s40, s40, 40960
  buffer_load_dwordx4 v[40:43], v9, s[20:23], s40 offen offset:0
  buffer_load_dwordx4 v[44:47], v9, s[20:23], s40 offen offset:1024
  buffer_load_dwordx4 v[48:51], v9, s[20:23], s40 offen offset:2048
  buffer_load_dwordx4 v[52:55], v9, s[20:23], s40 offen offset:3072
  s_add_u32 s32, s40, 4096
  buffer_load_dwordx4 v[56:59], v9, s[20:23], s32 offen
  s_add_u32 s40, s40, 40960
  buffer_load_dwordx4 v[60:63], v9, s[20:23], s40 offen offset:0
  buffer_load_dwordx4 v[64:67], v9, s[20:23], s40 offen offset:1024
  buffer_load_dwordx4 v[68:71], v9, s[20:23], s40 offen offset:2048
  buffer_load_dwordx4 v[72:75], v9, s[20:23], s40 offen offset:3072
  s_add_u32 s32, s40, 4096
  buffer_load_dwordx4 v[76:79], v9, s[20:23], s32 offen
  s_add_u32 s40, s40, 40960
  s_nop 7
  v_add_f32 v228, s46, v216
  v_add_f32 v229, s46, v217
  v_add_f32 v230, s46, v218
  v_add_f32 v231, s46, v219
  v_add_f32 v232, s46, v220
  v_add_f32 v233, s46, v221
  v_add_f32 v234, s46, v222
  v_add_f32 v235, s46, v223
  v_add_f32 v236, s46, v224
  v_add_f32 v237, s46, v225
  v_rcp_f32 v228, v228
  v_rcp_f32 v229, v229
  v_rcp_f32 v230, v230
  v_rcp_f32 v231, v231
  v_rcp_f32 v232, v232
  v_rcp_f32 v233, v233
  v_rcp_f32 v234, v234
  v_rcp_f32 v235, v235
  v_rcp_f32 v236, v236
  v_rcp_f32 v237, v237
  s_nop 1
  v_mul_f32 v128, v128, v228
  v_mul_f32 v129, v129, v228
  v_mul_f32 v130, v130, v228
  v_mul_f32 v131, v131, v228
  v_mul_f32 v132, v132, v229
  v_mul_f32 v133, v133, v229
  v_mul_f32 v134, v134, v229
  v_mul_f32 v135, v135, v229
  v_cvt_pk_bf16_f32 v128, v128, v129
  v_cvt_pk_bf16_f32 v129, v130, v131
  v_cvt_pk_bf16_f32 v130, v132, v133
  v_cvt_pk_bf16_f32 v131, v134, v135
  ds_write_b128 v14, v[128:131] offset:15360
  v_mul_f32 v136, v136, v230
  v_mul_f32 v137, v137, v230
  v_mul_f32 v138, v138, v230
  v_mul_f32 v139, v139, v230
  v_mul_f32 v140, v140, v231
  v_mul_f32 v141, v141, v231
  v_mul_f32 v142, v142, v231
  v_mul_f32 v143, v143, v231
  v_cvt_pk_bf16_f32 v136, v136, v137
  v_cvt_pk_bf16_f32 v137, v138, v139
  v_cvt_pk_bf16_f32 v138, v140, v141
  v_cvt_pk_bf16_f32 v139, v142, v143
  ds_write_b128 v14, v[136:139] offset:16384
  v_mul_f32 v144, v144, v232
  v_mul_f32 v145, v145, v232
  v_mul_f32 v146, v146, v232
  v_mul_f32 v147, v147, v232
  v_mul_f32 v148, v148, v233
  v_mul_f32 v149, v149, v233
  v_mul_f32 v150, v150, v233
  v_mul_f32 v151, v151, v233
  v_cvt_pk_bf16_f32 v144, v144, v145
  v_cvt_pk_bf16_f32 v145, v146, v147
  v_cvt_pk_bf16_f32 v146, v148, v149
  v_cvt_pk_bf16_f32 v147, v150, v151
  ds_write_b128 v14, v[144:147] offset:17408
  v_mul_f32 v152, v152, v234
  v_mul_f32 v153, v153, v234
  v_mul_f32 v154, v154, v234
  v_mul_f32 v155, v155, v234
  v_mul_f32 v156, v156, v235
  v_mul_f32 v157, v157, v235
  v_mul_f32 v158, v158, v235
  v_mul_f32 v159, v159, v235
  v_cvt_pk_bf16_f32 v152, v152, v153
  v_cvt_pk_bf16_f32 v153, v154, v155
  v_cvt_pk_bf16_f32 v154, v156, v157
  v_cvt_pk_bf16_f32 v155, v158, v159
  ds_write_b128 v14, v[152:155] offset:18432
  v_mul_f32 v160, v160, v236
  v_mul_f32 v161, v161, v236
  v_mul_f32 v162, v162, v236
  v_mul_f32 v163, v163, v236
  v_mul_f32 v164, v164, v237
  v_mul_f32 v165, v165, v237
  v_mul_f32 v166, v166, v237
  v_mul_f32 v167, v167, v237
  v_cvt_pk_bf16_f32 v160, v160, v161
  v_cvt_pk_bf16_f32 v161, v162, v163
  v_cvt_pk_bf16_f32 v162, v164, v165
  v_cvt_pk_bf16_f32 v163, v166, v167
  ds_write_b128 v14, v[160:163] offset:19456
  s_nop 1
  buffer_load_dwordx4 v[128:131], v9, s[20:23], s40 offen offset:0
  buffer_load_dwordx4 v[132:135], v9, s[20:23], s40 offen offset:1024
  buffer_load_dwordx4 v[136:139], v9, s[20:23], s40 offen offset:2048
  buffer_load_dwordx4 v[140:143], v9, s[20:23], s40 offen offset:3072
  s_add_u32 s32, s40, 4096
  buffer_load_dwordx4 v[144:147], v9, s[20:23], s32 offen
  s_add_u32 s40, s40, 40960
  buffer_load_dwordx4 v[148:151], v9, s[20:23], s40 offen offset:0
  buffer_load_dwordx4 v[152:155], v9, s[20:23], s40 offen offset:1024
  buffer_load_dwordx4 v[156:159], v9, s[20:23], s40 offen offset:2048
  buffer_load_dwordx4 v[160:163], v9, s[20:23], s40 offen offset:3072
  s_add_u32 s32, s40, 4096
  buffer_load_dwordx4 v[164:167], v9, s[20:23], s32 offen
  s_add_u32 s40, s40, 40960
  ds_read_b128 v[80:83], v14 offset:0
  ds_read_b128 v[84:87], v14 offset:5120
  ds_read_b128 v[88:91], v14 offset:10240
  ds_read_b128 v[92:95], v14 offset:15360
  s_waitcnt vmcnt(20)
  s_waitcnt lgkmcnt(0)
  v_mfma_f32_16x16x32_bf16 v[176:179], v[20:23], v[80:83], 0
  ds_read_b128 v[96:99], v14 offset:1024
  v_mfma_f32_16x16x32_bf16 v[180:183], v[20:23], v[84:87], 0
  v_mfma_f32_16x16x32_bf16 v[184:187], v[20:23], v[88:91], 0
  v_mfma_f32_16x16x32_bf16 v[188:191], v[20:23], v[92:95], 0
  v_mfma_f32_16x16x32_bf16 v[204:207], v[24:27], v[92:95], 0
  v_mfma_f32_16x16x32_bf16 v[200:203], v[24:27], v[88:91], 0
  ds_read_b128 v[100:103], v14 offset:6144
  v_mfma_f32_16x16x32_bf16 v[196:199], v[24:27], v[84:87], 0
  v_mfma_f32_16x16x32_bf16 v[192:195], v[24:27], v[80:83], 0
  v_mfma_f32_16x16x32_bf16 v[208:211], v[28:31], v[80:83], 0
  v_mfma_f32_16x16x32_bf16 v[212:215], v[28:31], v[84:87], 0
  v_mfma_f32_16x16x32_bf16 v[216:219], v[28:31], v[88:91], 0
  ds_read_b128 v[104:107], v14 offset:11264
  v_mfma_f32_16x16x32_bf16 v[220:223], v[28:31], v[92:95], 0
  v_mfma_f32_16x16x32_bf16 v[236:239], v[32:35], v[92:95], 0
  v_mfma_f32_16x16x32_bf16 v[232:235], v[32:35], v[88:91], 0
  v_mfma_f32_16x16x32_bf16 v[228:231], v[32:35], v[84:87], 0
  v_mfma_f32_16x16x32_bf16 v[224:227], v[32:35], v[80:83], 0
  ds_read_b128 v[108:111], v14 offset:16384
  v_mfma_f32_16x16x32_bf16 v[240:243], v[36:39], v[80:83], 0
  v_mfma_f32_16x16x32_bf16 v[244:247], v[36:39], v[84:87], 0
  v_mfma_f32_16x16x32_bf16 v[248:251], v[36:39], v[88:91], 0
  v_mfma_f32_16x16x32_bf16 v[252:255], v[36:39], v[92:95], 0
  s_waitcnt vmcnt(15)
  s_waitcnt lgkmcnt(0)
  v_mfma_f32_16x16x32_bf16 v[176:179], v[40:43], v[96:99], v[176:179]
  ds_read_b128 v[80:83], v14 offset:2048
  v_mfma_f32_16x16x32_bf16 v[180:183], v[40:43], v[100:103], v[180:183]
  ds_read_b128 v[84:87], v14 offset:7168
  v_mfma_f32_16x16x32_bf16 v[184:187], v[40:43], v[104:107], v[184:187]
  v_mfma_f32_16x16x32_bf16 v[188:191], v[40:43], v[108:111], v[188:191]
  ds_read_b128 v[88:91], v14 offset:12288
  v_mfma_f32_16x16x32_bf16 v[204:207], v[44:47], v[108:111], v[204:207]
  ds_read_b128 v[92:95], v14 offset:17408
  v_mfma_f32_16x16x32_bf16 v[200:203], v[44:47], v[104:107], v[200:203]
  v_mfma_f32_16x16x32_bf16 v[196:199], v[44:47], v[100:103], v[196:199]
  s_mul_i32 s40, s30, 40960
  s_mul_i32 s32, s29, 5120
  s_add_u32 s40, s40, s32
  s_add_u32 s40, s40, 10813440
  buffer_load_dwordx4 v[20:23], v9, s[20:23], s40 offen offset:0
  v_mfma_f32_16x16x32_bf16 v[192:195], v[44:47], v[96:99], v[192:195]
  buffer_load_dwordx4 v[24:27], v9, s[20:23], s40 offen offset:1024
  v_mfma_f32_16x16x32_bf16 v[208:211], v[48:51], v[96:99], v[208:211]
  v_mfma_f32_16x16x32_bf16 v[212:215], v[48:51], v[100:103], v[212:215]
  buffer_load_dwordx4 v[28:31], v9, s[20:23], s40 offen offset:2048
  v_mfma_f32_16x16x32_bf16 v[216:219], v[48:51], v[104:107], v[216:219]
  buffer_load_dwordx4 v[32:35], v9, s[20:23], s40 offen offset:3072
  v_mfma_f32_16x16x32_bf16 v[220:223], v[48:51], v[108:111], v[220:223]
  v_mfma_f32_16x16x32_bf16 v[236:239], v[52:55], v[108:111], v[236:239]
  s_add_u32 s32, s40, 4096
  buffer_load_dwordx4 v[36:39], v9, s[20:23], s32 offen
  s_add_u32 s40, s40, 40960
  v_mfma_f32_16x16x32_bf16 v[232:235], v[52:55], v[104:107], v[232:235]
  s_mul_i32 s41, s28, 196608
  s_mul_i32 s32, s30, 1024
  s_add_u32 s41, s41, s32
  s_add_u32 s41, s41, 2666496
  s_add_u32 s32, s41, 0
  buffer_load_dwordx4 v[112:115], v9, s[20:23], s32 offen
  v_mfma_f32_16x16x32_bf16 v[228:231], v[52:55], v[100:103], v[228:231]
  v_mfma_f32_16x16x32_bf16 v[224:227], v[52:55], v[96:99], v[224:227]
  s_add_u32 s32, s41, 49152
  buffer_load_dwordx4 v[116:119], v9, s[20:23], s32 offen
  v_mfma_f32_16x16x32_bf16 v[240:243], v[56:59], v[96:99], v[240:243]
  s_add_u32 s32, s41, 98304
  buffer_load_dwordx4 v[120:123], v9, s[20:23], s32 offen
  v_mfma_f32_16x16x32_bf16 v[244:247], v[56:59], v[100:103], v[244:247]
  v_mfma_f32_16x16x32_bf16 v[248:251], v[56:59], v[104:107], v[248:251]
  s_add_u32 s32, s41, 147456
  buffer_load_dwordx4 v[124:127], v9, s[20:23], s32 offen
  s_add_u32 s41, s41, 1024
  v_mfma_f32_16x16x32_bf16 v[252:255], v[56:59], v[108:111], v[252:255]
  s_waitcnt vmcnt(19)
  s_waitcnt lgkmcnt(0)
  v_mfma_f32_16x16x32_bf16 v[176:179], v[60:63], v[80:83], v[176:179]
  ds_read_b128 v[96:99], v14 offset:3072
  v_mfma_f32_16x16x32_bf16 v[180:183], v[60:63], v[84:87], v[180:183]
  v_mfma_f32_16x16x32_bf16 v[184:187], v[60:63], v[88:91], v[184:187]
  v_mfma_f32_16x16x32_bf16 v[188:191], v[60:63], v[92:95], v[188:191]
  v_mfma_f32_16x16x32_bf16 v[204:207], v[64:67], v[92:95], v[204:207]
  v_mfma_f32_16x16x32_bf16 v[200:203], v[64:67], v[88:91], v[200:203]
  ds_read_b128 v[100:103], v14 offset:8192
  v_mfma_f32_16x16x32_bf16 v[196:199], v[64:67], v[84:87], v[196:199]
  v_mfma_f32_16x16x32_bf16 v[192:195], v[64:67], v[80:83], v[192:195]
  v_mfma_f32_16x16x32_bf16 v[208:211], v[68:71], v[80:83], v[208:211]
  v_mfma_f32_16x16x32_bf16 v[212:215], v[68:71], v[84:87], v[212:215]
  v_mfma_f32_16x16x32_bf16 v[216:219], v[68:71], v[88:91], v[216:219]
  ds_read_b128 v[104:107], v14 offset:13312
  v_mfma_f32_16x16x32_bf16 v[220:223], v[68:71], v[92:95], v[220:223]
  v_mfma_f32_16x16x32_bf16 v[236:239], v[72:75], v[92:95], v[236:239]
  v_mfma_f32_16x16x32_bf16 v[232:235], v[72:75], v[88:91], v[232:235]
  v_mfma_f32_16x16x32_bf16 v[228:231], v[72:75], v[84:87], v[228:231]
  v_mfma_f32_16x16x32_bf16 v[224:227], v[72:75], v[80:83], v[224:227]
  ds_read_b128 v[108:111], v14 offset:18432
  v_mfma_f32_16x16x32_bf16 v[240:243], v[76:79], v[80:83], v[240:243]
  v_mfma_f32_16x16x32_bf16 v[244:247], v[76:79], v[84:87], v[244:247]
  v_mfma_f32_16x16x32_bf16 v[248:251], v[76:79], v[88:91], v[248:251]
  v_mfma_f32_16x16x32_bf16 v[252:255], v[76:79], v[92:95], v[252:255]
  s_waitcnt vmcnt(14)
  s_waitcnt lgkmcnt(0)
  v_mfma_f32_16x16x32_bf16 v[176:179], v[128:131], v[96:99], v[176:179]
  ds_read_b128 v[80:83], v14 offset:4096
  v_mfma_f32_16x16x32_bf16 v[180:183], v[128:131], v[100:103], v[180:183]
  v_mfma_f32_16x16x32_bf16 v[184:187], v[128:131], v[104:107], v[184:187]
  v_mfma_f32_16x16x32_bf16 v[188:191], v[128:131], v[108:111], v[188:191]
  v_mfma_f32_16x16x32_bf16 v[204:207], v[132:135], v[108:111], v[204:207]
  v_mfma_f32_16x16x32_bf16 v[200:203], v[132:135], v[104:107], v[200:203]
  ds_read_b128 v[84:87], v14 offset:9216
  v_mfma_f32_16x16x32_bf16 v[196:199], v[132:135], v[100:103], v[196:199]
  v_mfma_f32_16x16x32_bf16 v[192:195], v[132:135], v[96:99], v[192:195]
  v_mfma_f32_16x16x32_bf16 v[208:211], v[136:139], v[96:99], v[208:211]
  v_mfma_f32_16x16x32_bf16 v[212:215], v[136:139], v[100:103], v[212:215]
  v_mfma_f32_16x16x32_bf16 v[216:219], v[136:139], v[104:107], v[216:219]
  ds_read_b128 v[88:91], v14 offset:14336
  v_mfma_f32_16x16x32_bf16 v[220:223], v[136:139], v[108:111], v[220:223]
  v_mfma_f32_16x16x32_bf16 v[236:239], v[140:143], v[108:111], v[236:239]
  v_mfma_f32_16x16x32_bf16 v[232:235], v[140:143], v[104:107], v[232:235]
  v_mfma_f32_16x16x32_bf16 v[228:231], v[140:143], v[100:103], v[228:231]
  v_mfma_f32_16x16x32_bf16 v[224:227], v[140:143], v[96:99], v[224:227]
  ds_read_b128 v[92:95], v14 offset:19456
  v_mfma_f32_16x16x32_bf16 v[240:243], v[144:147], v[96:99], v[240:243]
  v_mfma_f32_16x16x32_bf16 v[244:247], v[144:147], v[100:103], v[244:247]
  v_mfma_f32_16x16x32_bf16 v[248:251], v[144:147], v[104:107], v[248:251]
  v_mfma_f32_16x16x32_bf16 v[252:255], v[144:147], v[108:111], v[252:255]
  s_waitcnt vmcnt(9)
  s_waitcnt lgkmcnt(0)
  v_mfma_f32_16x16x32_bf16 v[176:179], v[148:151], v[80:83], v[176:179]
  v_mfma_f32_16x16x32_bf16 v[180:183], v[148:151], v[84:87], v[180:183]
  v_mfma_f32_16x16x32_bf16 v[184:187], v[148:151], v[88:91], v[184:187]
  v_mfma_f32_16x16x32_bf16 v[188:191], v[148:151], v[92:95], v[188:191]
  v_mfma_f32_16x16x32_bf16 v[204:207], v[152:155], v[92:95], v[204:207]
  v_mfma_f32_16x16x32_bf16 v[200:203], v[152:155], v[88:91], v[200:203]
  v_mfma_f32_16x16x32_bf16 v[196:199], v[152:155], v[84:87], v[196:199]
  v_mfma_f32_16x16x32_bf16 v[192:195], v[152:155], v[80:83], v[192:195]
  v_mfma_f32_16x16x32_bf16 v[208:211], v[156:159], v[80:83], v[208:211]
  v_mfma_f32_16x16x32_bf16 v[212:215], v[156:159], v[84:87], v[212:215]
  v_mfma_f32_16x16x32_bf16 v[216:219], v[156:159], v[88:91], v[216:219]
  v_mfma_f32_16x16x32_bf16 v[220:223], v[156:159], v[92:95], v[220:223]
  v_mfma_f32_16x16x32_bf16 v[236:239], v[160:163], v[92:95], v[236:239]
  v_mfma_f32_16x16x32_bf16 v[232:235], v[160:163], v[88:91], v[232:235]
  v_mfma_f32_16x16x32_bf16 v[228:231], v[160:163], v[84:87], v[228:231]
  v_mfma_f32_16x16x32_bf16 v[224:227], v[160:163], v[80:83], v[224:227]
  v_mfma_f32_16x16x32_bf16 v[240:243], v[164:167], v[80:83], v[240:243]
  v_mfma_f32_16x16x32_bf16 v[244:247], v[164:167], v[84:87], v[244:247]
  v_mfma_f32_16x16x32_bf16 v[248:251], v[164:167], v[88:91], v[248:251]
  v_mfma_f32_16x16x32_bf16 v[252:255], v[164:167], v[92:95], v[252:255]
  s_waitcnt vmcnt(0)
  v_mfma_f32_16x16x32_bf16 v[176:179], v[20:23], v[112:115], v[176:179]
  v_mfma_f32_16x16x32_bf16 v[180:183], v[20:23], v[116:119], v[180:183]
  v_mfma_f32_16x16x32_bf16 v[184:187], v[20:23], v[120:123], v[184:187]
  v_mfma_f32_16x16x32_bf16 v[188:191], v[20:23], v[124:127], v[188:191]
  v_mfma_f32_16x16x32_bf16 v[204:207], v[24:27], v[124:127], v[204:207]
  v_mfma_f32_16x16x32_bf16 v[200:203], v[24:27], v[120:123], v[200:203]
  v_mfma_f32_16x16x32_bf16 v[196:199], v[24:27], v[116:119], v[196:199]
  v_mfma_f32_16x16x32_bf16 v[192:195], v[24:27], v[112:115], v[192:195]
  v_mfma_f32_16x16x32_bf16 v[208:211], v[28:31], v[112:115], v[208:211]
  v_mfma_f32_16x16x32_bf16 v[212:215], v[28:31], v[116:119], v[212:215]
  v_mfma_f32_16x16x32_bf16 v[216:219], v[28:31], v[120:123], v[216:219]
  v_mfma_f32_16x16x32_bf16 v[220:223], v[28:31], v[124:127], v[220:223]
  v_mfma_f32_16x16x32_bf16 v[236:239], v[32:35], v[124:127], v[236:239]
  v_mfma_f32_16x16x32_bf16 v[232:235], v[32:35], v[120:123], v[232:235]
  v_mfma_f32_16x16x32_bf16 v[228:231], v[32:35], v[116:119], v[228:231]
  v_mfma_f32_16x16x32_bf16 v[224:227], v[32:35], v[112:115], v[224:227]
  v_mfma_f32_16x16x32_bf16 v[240:243], v[36:39], v[112:115], v[240:243]
  v_mfma_f32_16x16x32_bf16 v[244:247], v[36:39], v[116:119], v[244:247]
  v_mfma_f32_16x16x32_bf16 v[248:251], v[36:39], v[120:123], v[248:251]
  v_mfma_f32_16x16x32_bf16 v[252:255], v[36:39], v[124:127], v[252:255]
  s_branch L_k2_R
L_k2_F:
  v_add_u32 v16, 0, v9
  v_add_u32 v17, 49152, v9
  v_add_u32 v18, 98304, v9
  v_add_u32 v19, 147456, v9
  s_mul_i32 s40, s30, 450560
  s_mul_i32 s32, s29, 5120
  s_add_u32 s40, s40, s32
  s_add_u32 s40, s40, 9011200
  s_mul_i32 s41, s28, 196608
  s_mul_i32 s32, s30, 11264
  s_add_u32 s41, s41, s32
  s_add_u32 s41, s41, 2621440
  v_add_u32 v14, s31, v9
  s_waitcnt lgkmcnt(0)
  s_mov_b32 s20, s52
  s_mov_b32 s21, s53
  s_mov_b32 s8, s4
  s_mov_b32 s9, s5
  s_mov_b32 s24, s50
  s_mov_b32 s25, s51
  s_add_u32 m0, s31, 0
  s_add_u32 s32, s40, 0
  buffer_load_dwordx4 v9, s[20:23], s32 offen lds
  s_add_u32 m0, s31, 1024
  s_add_u32 s32, s40, 1024
  buffer_load_dwordx4 v9, s[20:23], s32 offen lds
  s_add_u32 m0, s31, 2048
  s_add_u32 s32, s40, 2048
  buffer_load_dwordx4 v9, s[20:23], s32 offen lds
  s_add_u32 m0, s31, 3072
  s_add_u32 s32, s40, 3072
  buffer_load_dwordx4 v9, s[20:23], s32 offen lds
  s_add_u32 m0, s31, 4096
  s_add_u32 s32, s40, 4096
  buffer_load_dwordx4 v9, s[20:23], s32 offen lds
  s_add_u32 s40, s40, 40960
  buffer_load_dwordx4 v[64:67], v16, s[20:23], s41 offen
  buffer_load_dwordx4 v[68:71], v17, s[20:23], s41 offen
  buffer_load_dwordx4 v[72:75], v18, s[20:23], s41 offen
  buffer_load_dwordx4 v[76:79], v19, s[20:23], s41 offen
  s_add_u32 s41, s41, 1024
  s_add_u32 m0, s31, 5120
  s_add_u32 s32, s40, 0
  buffer_load_dwordx4 v9, s[20:23], s32 offen lds
  s_add_u32 m0, s31, 6144
  s_add_u32 s32, s40, 1024
  buffer_load_dwordx4 v9, s[20:23], s32 offen lds
  s_add_u32 m0, s31, 7168
  s_add_u32 s32, s40, 2048
  buffer_load_dwordx4 v9, s[20:23], s32 offen lds
  s_add_u32 m0, s31, 8192
  s_add_u32 s32, s40, 3072
  buffer_load_dwordx4 v9, s[20:23], s32 offen lds
  s_add_u32 m0, s31, 9216
  s_add_u32 s32, s40, 4096
  buffer_load_dwordx4 v9, s[20:23], s32 offen lds
  s_add_u32 s40, s40, 40960
  buffer_load_dwordx4 v[80:83], v16, s[20:23], s41 offen
  buffer_load_dwordx4 v[84:87], v17, s[20:23], s41 offen
  buffer_load_dwordx4 v[88:91], v18, s[20:23], s41 offen
  buffer_load_dwordx4 v[92:95], v19, s[20:23], s41 offen
  s_add_u32 s41, s41, 1024
  s_add_u32 m0, s31, 10240
  s_add_u32 s32, s40, 0
  buffer_load_dwordx4 v9, s[20:23], s32 offen lds
  s_add_u32 m0, s31, 11264
  s_add_u32 s32, s40, 1024
  buffer_load_dwordx4 v9, s[20:23], s32 offen lds
  s_add_u32 m0, s31, 12288
  s_add_u32 s32, s40, 2048
  buffer_load_dwordx4 v9, s[20:23], s32 offen lds
  s_add_u32 m0, s31, 13312
  s_add_u32 s32, s40, 3072
  buffer_load_dwordx4 v9, s[20:23], s32 offen lds
  s_add_u32 m0, s31, 14336
  s_add_u32 s32, s40, 4096
  buffer_load_dwordx4 v9, s[20:23], s32 offen lds
  s_add_u32 s40, s40, 40960
  buffer_load_dwordx4 v[96:99], v16, s[20:23], s41 offen
  buffer_load_dwordx4 v[100:103], v17, s[20:23], s41 offen
  buffer_load_dwordx4 v[104:107], v18, s[20:23], s41 offen
  buffer_load_dwordx4 v[108:111], v19, s[20:23], s41 offen
  s_add_u32 s41, s41, 1024
  s_waitcnt vmcnt(22)
  ds_read_b128 v[20:23], v14 offset:0
  ds_read_b128 v[24:27], v14 offset:1024
  ds_read_b128 v[28:31], v14 offset:2048
  ds_read_b128 v[32:35], v14 offset:3072
  ds_read_b128 v[36:39], v14 offset:4096
  s_waitcnt vmcnt(13)
  s_waitcnt lgkmcnt(0)
  v_mfma_f32_16x16x32_bf16 v[176:179], v[20:23], v[64:67], 0
  ds_read_b128 v[40:43], v14 offset:5120
  ds_read_b128 v[44:47], v14 offset:6144
  v_mfma_f32_16x16x32_bf16 v[180:183], v[20:23], v[68:71], 0
  ds_read_b128 v[48:51], v14 offset:7168
  v_mfma_f32_16x16x32_bf16 v[184:187], v[20:23], v[72:75], 0
  ds_read_b128 v[52:55], v14 offset:8192
  v_mfma_f32_16x16x32_bf16 v[188:191], v[20:23], v[76:79], 0
  ds_read_b128 v[56:59], v14 offset:9216
  v_mfma_f32_16x16x32_bf16 v[204:207], v[24:27], v[76:79], 0
  s_add_u32 m0, s31, 15360
  s_add_u32 s32, s40, 0
  buffer_load_dwordx4 v9, s[20:23], s32 offen lds
  v_mfma_f32_16x16x32_bf16 v[200:203], v[24:27], v[72:75], 0
  s_add_u32 m0, s31, 16384
  s_add_u32 s32, s40, 1024
  buffer_load_dwordx4 v9, s[20:23], s32 offen lds
  v_mfma_f32_16x16x32_bf16 v[196:199], v[24:27], v[68:71], 0
  s_add_u32 m0, s31, 17408
  s_add_u32 s32, s40, 2048
  buffer_load_dwordx4 v9, s[20:23], s32 offen lds
  s_add_u32 m0, s31, 18432
  s_add_u32 s32, s40, 3072
  buffer_load_dwordx4 v9, s[20:23], s32 offen lds
  v_mfma_f32_16x16x32_bf16 v[192:195], v[24:27], v[64:67], 0
  s_add_u32 m0, s31, 19456
  s_add_u32 s32, s40, 4096
  buffer_load_dwordx4 v9, s[20:23], s32 offen lds
  s_add_u32 s40, s40, 40960
  v_mfma_f32_16x16x32_bf16 v[208:211], v[28:31], v[64:67], 0
  buffer_load_dwordx4 v[112:115], v16, s[20:23], s41 offen
  v_mfma_f32_16x16x32_bf16 v[212:215], v[28:31], v[68:71], 0
  buffer_load_dwordx4 v[116:119], v17, s[20:23], s41 offen
  v_mfma_f32_16x16x32_bf16 v[216:219], v[28:31], v[72:75], 0
  buffer_load_dwordx4 v[120:123], v18, s[20:23], s41 offen
  v_mfma_f32_16x16x32_bf16 v[220:223], v[28:31], v[76:79], 0
  buffer_load_dwordx4 v[124:127], v19, s[20:23], s41 offen
  s_add_u32 s41, s41, 1024
  v_mfma_f32_16x16x32_bf16 v[236:239], v[32:35], v[76:79], 0
  buffer_load_dwordx4 v[128:131], v16, s[20:23], s41 offen
  v_mfma_f32_16x16x32_bf16 v[232:235], v[32:35], v[72:75], 0
  buffer_load_dwordx4 v[132:135], v17, s[20:23], s41 offen
  buffer_load_dwordx4 v[136:139], v18, s[20:23], s41 offen
  v_mfma_f32_16x16x32_bf16 v[228:231], v[32:35], v[68:71], 0
  buffer_load_dwordx4 v[140:143], v19, s[20:23], s41 offen
  s_add_u32 s41, s41, 1024
  v_mfma_f32_16x16x32_bf16 v[224:227], v[32:35], v[64:67], 0
  s_add_u32 m0, s31, 0
  s_add_u32 s32, s40, 0
  buffer_load_dwordx4 v9, s[20:23], s32 offen lds
  v_mfma_f32_16x16x32_bf16 v[240:243], v[36:39], v[64:67], 0
  s_add_u32 m0, s31, 1024
  s_add_u32 s32, s40, 1024
  buffer_load_dwordx4 v9, s[20:23], s32 offen lds
  v_mfma_f32_16x16x32_bf16 v[244:247], v[36:39], v[68:71], 0
  s_add_u32 m0, s31, 2048
  s_add_u32 s32, s40, 2048
  buffer_load_dwordx4 v9, s[20:23], s32 offen lds
  v_mfma_f32_16x16x32_bf16 v[248:251], v[36:39], v[72:75], 0
  s_add_u32 m0, s31, 3072
  s_add_u32 s32, s40, 3072
  buffer_load_dwordx4 v9, s[20:23], s32 offen lds
  v_mfma_f32_16x16x32_bf16 v[252:255], v[36:39], v[76:79], 0
  s_add_u32 m0, s31, 4096
  s_add_u32 s32, s40, 4096
  buffer_load_dwordx4 v9, s[20:23], s32 offen lds
  s_add_u32 s40, s40, 40960
  s_waitcnt vmcnt(22)
  s_waitcnt lgkmcnt(0)
  v_mfma_f32_16x16x32_bf16 v[176:179], v[40:43], v[80:83], v[176:179]
  ds_read_b128 v[20:23], v14 offset:10240
  v_mfma_f32_16x16x32_bf16 v[180:183], v[40:43], v[84:87], v[180:183]
  ds_read_b128 v[24:27], v14 offset:11264
  v_mfma_f32_16x16x32_bf16 v[184:187], v[40:43], v[88:91], v[184:187]
  ds_read_b128 v[28:31], v14 offset:12288
  v_mfma_f32_16x16x32_bf16 v[188:191], v[40:43], v[92:95], v[188:191]
  ds_read_b128 v[32:35], v14 offset:13312
  v_mfma_f32_16x16x32_bf16 v[204:207], v[44:47], v[92:95], v[204:207]
  ds_read_b128 v[36:39], v14 offset:14336
  v_mfma_f32_16x16x32_bf16 v[200:203], v[44:47], v[88:91], v[200:203]
  buffer_load_dwordx4 v[144:147], v16, s[20:23], s41 offen
  v_mfma_f32_16x16x32_bf16 v[196:199], v[44:47], v[84:87], v[196:199]
  buffer_load_dwordx4 v[148:151], v17, s[20:23], s41 offen
  v_mfma_f32_16x16x32_bf16 v[192:195], v[44:47], v[80:83], v[192:195]
  buffer_load_dwordx4 v[152:155], v18, s[20:23], s41 offen
  v_mfma_f32_16x16x32_bf16 v[208:211], v[48:51], v[80:83], v[208:211]
  buffer_load_dwordx4 v[156:159], v19, s[20:23], s41 offen
  s_add_u32 s41, s41, 1024
  v_mfma_f32_16x16x32_bf16 v[212:215], v[48:51], v[84:87], v[212:215]
  v_mfma_f32_16x16x32_bf16 v[216:219], v[48:51], v[88:91], v[216:219]
  s_add_u32 m0, s31, 5120
  s_add_u32 s32, s40, 0
  buffer_load_dwordx4 v9, s[20:23], s32 offen lds
  v_mfma_f32_16x16x32_bf16 v[220:223], v[48:51], v[92:95], v[220:223]
  s_add_u32 m0, s31, 6144
  s_add_u32 s32, s40, 1024
  buffer_load_dwordx4 v9, s[20:23], s32 offen lds
  v_mfma_f32_16x16x32_bf16 v[236:239], v[52:55], v[92:95], v[236:239]
  s_add_u32 m0, s31, 7168
  s_add_u32 s32, s40, 2048
  buffer_load_dwordx4 v9, s[20:23], s32 offen lds
  v_mfma_f32_16x16x32_bf16 v[232:235], v[52:55], v[88:91], v[232:235]
  s_add_u32 m0, s31, 8192
  s_add_u32 s32, s40, 3072
  buffer_load_dwordx4 v9, s[20:23], s32 offen lds
  v_mfma_f32_16x16x32_bf16 v[228:231], v[52:55], v[84:87], v[228:231]
  s_add_u32 m0, s31, 9216
  s_add_u32 s32, s40, 4096
  buffer_load_dwordx4 v9, s[20:23], s32 offen lds
  s_add_u32 s40, s40, 40960
  v_mfma_f32_16x16x32_bf16 v[224:227], v[52:55], v[80:83], v[224:227]
  buffer_load_dwordx4 v[64:67], v16, s[20:23], s41 offen
  v_mfma_f32_16x16x32_bf16 v[240:243], v[56:59], v[80:83], v[240:243]
  buffer_load_dwordx4 v[68:71], v17, s[20:23], s41 offen
  v_mfma_f32_16x16x32_bf16 v[244:247], v[56:59], v[84:87], v[244:247]
  buffer_load_dwordx4 v[72:75], v18, s[20:23], s41 offen
  v_mfma_f32_16x16x32_bf16 v[248:251], v[56:59], v[88:91], v[248:251]
  buffer_load_dwordx4 v[76:79], v19, s[20:23], s41 offen
  s_add_u32 s41, s41, 1024
  v_mfma_f32_16x16x32_bf16 v[252:255], v[56:59], v[92:95], v[252:255]
  s_waitcnt vmcnt(26)
  s_waitcnt lgkmcnt(0)
  v_mfma_f32_16x16x32_bf16 v[176:179], v[20:23], v[96:99], v[176:179]
  ds_read_b128 v[40:43], v14 offset:15360
  v_mfma_f32_16x16x32_bf16 v[180:183], v[20:23], v[100:103], v[180:183]
  ds_read_b128 v[44:47], v14 offset:16384
  v_mfma_f32_16x16x32_bf16 v[184:187], v[20:23], v[104:107], v[184:187]
  ds_read_b128 v[48:51], v14 offset:17408
  v_mfma_f32_16x16x32_bf16 v[188:191], v[20:23], v[108:111], v[188:191]
  v_mfma_f32_16x16x32_bf16 v[204:207], v[24:27], v[108:111], v[204:207]
  ds_read_b128 v[52:55], v14 offset:18432
  v_mfma_f32_16x16x32_bf16 v[200:203], v[24:27], v[104:107], v[200:203]
  ds_read_b128 v[56:59], v14 offset:19456
  v_mfma_f32_16x16x32_bf16 v[196:199], v[24:27], v[100:103], v[196:199]
  v_mfma_f32_16x16x32_bf16 v[192:195], v[24:27], v[96:99], v[192:195]
  s_add_u32 m0, s31, 10240
  s_add_u32 s32, s40, 0
  buffer_load_dwordx4 v9, s[20:23], s32 offen lds
  v_mfma_f32_16x16x32_bf16 v[208:211], v[28:31], v[96:99], v[208:211]
  s_add_u32 m0, s31, 11264
  s_add_u32 s32, s40, 1024
  buffer_load_dwordx4 v9, s[20:23], s32 offen lds
  v_mfma_f32_16x16x32_bf16 v[212:215], v[28:31], v[100:103], v[212:215]
  v_mfma_f32_16x16x32_bf16 v[216:219], v[28:31], v[104:107], v[216:219]
  s_add_u32 m0, s31, 12288
  s_add_u32 s32, s40, 2048
  buffer_load_dwordx4 v9, s[20:23], s32 offen lds
  v_mfma_f32_16x16x32_bf16 v[220:223], v[28:31], v[108:111], v[220:223]
  s_add_u32 m0, s31, 13312
  s_add_u32 s32, s40, 3072
  buffer_load_dwordx4 v9, s[20:23], s32 offen lds
  v_mfma_f32_16x16x32_bf16 v[236:239], v[32:35], v[108:111], v[236:239]
  s_add_u32 m0, s31, 14336
  s_add_u32 s32, s40, 4096
  buffer_load_dwordx4 v9, s[20:23], s32 offen lds
  s_add_u32 s40, s40, 40960
  v_mfma_f32_16x16x32_bf16 v[232:235], v[32:35], v[104:107], v[232:235]
  v_mfma_f32_16x16x32_bf16 v[228:231], v[32:35], v[100:103], v[228:231]
  buffer_load_dwordx4 v[80:83], v16, s[20:23], s41 offen
  v_mfma_f32_16x16x32_bf16 v[224:227], v[32:35], v[96:99], v[224:227]
  buffer_load_dwordx4 v[84:87], v17, s[20:23], s41 offen
  v_mfma_f32_16x16x32_bf16 v[240:243], v[36:39], v[96:99], v[240:243]
  v_mfma_f32_16x16x32_bf16 v[244:247], v[36:39], v[100:103], v[244:247]
  buffer_load_dwordx4 v[88:91], v18, s[20:23], s41 offen
  v_mfma_f32_16x16x32_bf16 v[248:251], v[36:39], v[104:107], v[248:251]
  buffer_load_dwordx4 v[92:95], v19, s[20:23], s41 offen
  s_add_u32 s41, s41, 1024
  v_mfma_f32_16x16x32_bf16 v[252:255], v[36:39], v[108:111], v[252:255]
  s_waitcnt vmcnt(22)
  s_waitcnt lgkmcnt(0)
  v_mfma_f32_16x16x32_bf16 v[176:179], v[40:43], v[112:115], v[176:179]
  ds_read_b128 v[20:23], v14 offset:0
  v_mfma_f32_16x16x32_bf16 v[180:183], v[40:43], v[116:119], v[180:183]
  ds_read_b128 v[24:27], v14 offset:1024
  v_mfma_f32_16x16x32_bf16 v[184:187], v[40:43], v[120:123], v[184:187]
  ds_read_b128 v[28:31], v14 offset:2048
  v_mfma_f32_16x16x32_bf16 v[188:191], v[40:43], v[124:127], v[188:191]
  v_mfma_f32_16x16x32_bf16 v[204:207], v[44:47], v[124:127], v[204:207]
  ds_read_b128 v[32:35], v14 offset:3072
  v_mfma_f32_16x16x32_bf16 v[200:203], v[44:47], v[120:123], v[200:203]
  ds_read_b128 v[36:39], v14 offset:4096
  v_mfma_f32_16x16x32_bf16 v[196:199], v[44:47], v[116:119], v[196:199]
  v_mfma_f32_16x16x32_bf16 v[192:195], v[44:47], v[112:115], v[192:195]
  s_add_u32 m0, s31, 15360
  s_add_u32 s32, s40, 0
  buffer_load_dwordx4 v9, s[20:23], s32 offen lds
  v_mfma_f32_16x16x32_bf16 v[208:211], v[48:51], v[112:115], v[208:211]
  s_add_u32 m0, s31, 16384
  s_add_u32 s32, s40, 1024
  buffer_load_dwordx4 v9, s[20:23], s32 offen lds
  v_mfma_f32_16x16x32_bf16 v[212:215], v[48:51], v[116:119], v[212:215]
  v_mfma_f32_16x16x32_bf16 v[216:219], v[48:51], v[120:123], v[216:219]
  s_add_u32 m0, s31, 17408
  s_add_u32 s32, s40, 2048
  buffer_load_dwordx4 v9, s[20:23], s32 offen lds
  v_mfma_f32_16x16x32_bf16 v[220:223], v[48:51], v[124:127], v[220:223]
  s_add_u32 m0, s31, 18432
  s_add_u32 s32, s40, 3072
  buffer_load_dwordx4 v9, s[20:23], s32 offen lds
  v_mfma_f32_16x16x32_bf16 v[236:239], v[52:55], v[124:127], v[236:239]
  s_add_u32 m0, s31, 19456
  s_add_u32 s32, s40, 4096
  buffer_load_dwordx4 v9, s[20:23], s32 offen lds
  s_add_u32 s40, s40, 40960
  v_mfma_f32_16x16x32_bf16 v[232:235], v[52:55], v[120:123], v[232:235]
  v_mfma_f32_16x16x32_bf16 v[228:231], v[52:55], v[116:119], v[228:231]
  buffer_load_dwordx4 v[96:99], v16, s[20:23], s41 offen
  v_mfma_f32_16x16x32_bf16 v[224:227], v[52:55], v[112:115], v[224:227]
  buffer_load_dwordx4 v[100:103], v17, s[20:23], s41 offen
  v_mfma_f32_16x16x32_bf16 v[240:243], v[56:59], v[112:115], v[240:243]
  v_mfma_f32_16x16x32_bf16 v[244:247], v[56:59], v[116:119], v[244:247]
  buffer_load_dwordx4 v[104:107], v18, s[20:23], s41 offen
  v_mfma_f32_16x16x32_bf16 v[248:251], v[56:59], v[120:123], v[248:251]
  buffer_load_dwordx4 v[108:111], v19, s[20:23], s41 offen
  s_add_u32 s41, s41, 1024
  v_mfma_f32_16x16x32_bf16 v[252:255], v[56:59], v[124:127], v[252:255]
  s_waitcnt vmcnt(22)
  s_waitcnt lgkmcnt(0)
  v_mfma_f32_16x16x32_bf16 v[176:179], v[20:23], v[128:131], v[176:179]
  ds_read_b128 v[40:43], v14 offset:5120
  v_mfma_f32_16x16x32_bf16 v[180:183], v[20:23], v[132:135], v[180:183]
  ds_read_b128 v[44:47], v14 offset:6144
  v_mfma_f32_16x16x32_bf16 v[184:187], v[20:23], v[136:139], v[184:187]
  ds_read_b128 v[48:51], v14 offset:7168
  v_mfma_f32_16x16x32_bf16 v[188:191], v[20:23], v[140:143], v[188:191]
  v_mfma_f32_16x16x32_bf16 v[204:207], v[24:27], v[140:143], v[204:207]
  ds_read_b128 v[52:55], v14 offset:8192
  v_mfma_f32_16x16x32_bf16 v[200:203], v[24:27], v[136:139], v[200:203]
  ds_read_b128 v[56:59], v14 offset:9216
  v_mfma_f32_16x16x32_bf16 v[196:199], v[24:27], v[132:135], v[196:199]
  v_mfma_f32_16x16x32_bf16 v[192:195], v[24:27], v[128:131], v[192:195]
  s_add_u32 m0, s31, 0
  s_add_u32 s32, s40, 0
  buffer_load_dwordx4 v9, s[20:23], s32 offen lds
  v_mfma_f32_16x16x32_bf16 v[208:211], v[28:31], v[128:131], v[208:211]
  s_add_u32 m0, s31, 1024
  s_add_u32 s32, s40, 1024
  buffer_load_dwordx4 v9, s[20:23], s32 offen lds
  v_mfma_f32_16x16x32_bf16 v[212:215], v[28:31], v[132:135], v[212:215]
  v_mfma_f32_16x16x32_bf16 v[216:219], v[28:31], v[136:139], v[216:219]
  s_add_u32 m0, s31, 2048
  s_add_u32 s32, s40, 2048
  buffer_load_dwordx4 v9, s[20:23], s32 offen lds
  v_mfma_f32_16x16x32_bf16 v[220:223], v[28:31], v[140:143], v[220:223]
  s_add_u32 m0, s31, 3072
  s_add_u32 s32, s40, 3072
  buffer_load_dwordx4 v9, s[20:23], s32 offen lds
  v_mfma_f32_16x16x32_bf16 v[236:239], v[32:35], v[140:143], v[236:239]
  s_add_u32 m0, s31, 4096
  s_add_u32 s32, s40, 4096
  buffer_load_dwordx4 v9, s[20:23], s32 offen lds
  s_add_u32 s40, s40, 40960
  v_mfma_f32_16x16x32_bf16 v[232:235], v[32:35], v[136:139], v[232:235]
  v_mfma_f32_16x16x32_bf16 v[228:231], v[32:35], v[132:135], v[228:231]
  buffer_load_dwordx4 v[112:115], v16, s[20:23], s41 offen
  v_mfma_f32_16x16x32_bf16 v[224:227], v[32:35], v[128:131], v[224:227]
  buffer_load_dwordx4 v[116:119], v17, s[20:23], s41 offen
  v_mfma_f32_16x16x32_bf16 v[240:243], v[36:39], v[128:131], v[240:243]
  v_mfma_f32_16x16x32_bf16 v[244:247], v[36:39], v[132:135], v[244:247]
  buffer_load_dwordx4 v[120:123], v18, s[20:23], s41 offen
  v_mfma_f32_16x16x32_bf16 v[248:251], v[36:39], v[136:139], v[248:251]
  buffer_load_dwordx4 v[124:127], v19, s[20:23], s41 offen
  s_add_u32 s41, s41, 1024
  v_mfma_f32_16x16x32_bf16 v[252:255], v[36:39], v[140:143], v[252:255]
  s_waitcnt vmcnt(22)
  s_waitcnt lgkmcnt(0)
  v_mfma_f32_16x16x32_bf16 v[176:179], v[40:43], v[144:147], v[176:179]
  ds_read_b128 v[20:23], v14 offset:10240
  v_mfma_f32_16x16x32_bf16 v[180:183], v[40:43], v[148:151], v[180:183]
  ds_read_b128 v[24:27], v14 offset:11264
  v_mfma_f32_16x16x32_bf16 v[184:187], v[40:43], v[152:155], v[184:187]
  ds_read_b128 v[28:31], v14 offset:12288
  v_mfma_f32_16x16x32_bf16 v[188:191], v[40:43], v[156:159], v[188:191]
  v_mfma_f32_16x16x32_bf16 v[204:207], v[44:47], v[156:159], v[204:207]
  ds_read_b128 v[32:35], v14 offset:13312
  v_mfma_f32_16x16x32_bf16 v[200:203], v[44:47], v[152:155], v[200:203]
  ds_read_b128 v[36:39], v14 offset:14336
  v_mfma_f32_16x16x32_bf16 v[196:199], v[44:47], v[148:151], v[196:199]
  v_mfma_f32_16x16x32_bf16 v[192:195], v[44:47], v[144:147], v[192:195]
  s_add_u32 m0, s31, 5120
  s_add_u32 s32, s40, 0
  buffer_load_dwordx4 v9, s[20:23], s32 offen lds
  v_mfma_f32_16x16x32_bf16 v[208:211], v[48:51], v[144:147], v[208:211]
  s_add_u32 m0, s31, 6144
  s_add_u32 s32, s40, 1024
  buffer_load_dwordx4 v9, s[20:23], s32 offen lds
  v_mfma_f32_16x16x32_bf16 v[212:215], v[48:51], v[148:151], v[212:215]
  v_mfma_f32_16x16x32_bf16 v[216:219], v[48:51], v[152:155], v[216:219]
  s_add_u32 m0, s31, 7168
  s_add_u32 s32, s40, 2048
  buffer_load_dwordx4 v9, s[20:23], s32 offen lds
  v_mfma_f32_16x16x32_bf16 v[220:223], v[48:51], v[156:159], v[220:223]
  s_add_u32 m0, s31, 8192
  s_add_u32 s32, s40, 3072
  buffer_load_dwordx4 v9, s[20:23], s32 offen lds
  v_mfma_f32_16x16x32_bf16 v[236:239], v[52:55], v[156:159], v[236:239]
  s_add_u32 m0, s31, 9216
  s_add_u32 s32, s40, 4096
  buffer_load_dwordx4 v9, s[20:23], s32 offen lds
  s_add_u32 s40, s40, 40960
  v_mfma_f32_16x16x32_bf16 v[232:235], v[52:55], v[152:155], v[232:235]
  v_mfma_f32_16x16x32_bf16 v[228:231], v[52:55], v[148:151], v[228:231]
  buffer_load_dwordx4 v[128:131], v16, s[20:23], s41 offen
  v_mfma_f32_16x16x32_bf16 v[224:227], v[52:55], v[144:147], v[224:227]
  buffer_load_dwordx4 v[132:135], v17, s[20:23], s41 offen
  v_mfma_f32_16x16x32_bf16 v[240:243], v[56:59], v[144:147], v[240:243]
  v_mfma_f32_16x16x32_bf16 v[244:247], v[56:59], v[148:151], v[244:247]
  buffer_load_dwordx4 v[136:139], v18, s[20:23], s41 offen
  v_mfma_f32_16x16x32_bf16 v[248:251], v[56:59], v[152:155], v[248:251]
  buffer_load_dwordx4 v[140:143], v19, s[20:23], s41 offen
  s_add_u32 s41, s41, 1024
  v_mfma_f32_16x16x32_bf16 v[252:255], v[56:59], v[156:159], v[252:255]
  s_waitcnt vmcnt(22)
  s_waitcnt lgkmcnt(0)
  v_mfma_f32_16x16x32_bf16 v[176:179], v[20:23], v[64:67], v[176:179]
  ds_read_b128 v[40:43], v14 offset:15360
  v_mfma_f32_16x16x32_bf16 v[180:183], v[20:23], v[68:71], v[180:183]
  v_mfma_f32_16x16x32_bf16 v[184:187], v[20:23], v[72:75], v[184:187]
  ds_read_b128 v[44:47], v14 offset:16384
  v_mfma_f32_16x16x32_bf16 v[188:191], v[20:23], v[76:79], v[188:191]
  v_mfma_f32_16x16x32_bf16 v[204:207], v[24:27], v[76:79], v[204:207]
  ds_read_b128 v[48:51], v14 offset:17408
  v_mfma_f32_16x16x32_bf16 v[200:203], v[24:27], v[72:75], v[200:203]
  v_mfma_f32_16x16x32_bf16 v[196:199], v[24:27], v[68:71], v[196:199]
  ds_read_b128 v[52:55], v14 offset:18432
  v_mfma_f32_16x16x32_bf16 v[192:195], v[24:27], v[64:67], v[192:195]
  v_mfma_f32_16x16x32_bf16 v[208:211], v[28:31], v[64:67], v[208:211]
  ds_read_b128 v[56:59], v14 offset:19456
  v_mfma_f32_16x16x32_bf16 v[212:215], v[28:31], v[68:71], v[212:215]
  v_mfma_f32_16x16x32_bf16 v[216:219], v[28:31], v[72:75], v[216:219]
  s_add_u32 m0, s31, 10240
  s_add_u32 s32, s40, 0
  buffer_load_dwordx4 v9, s[20:23], s32 offen lds
  v_mfma_f32_16x16x32_bf16 v[220:223], v[28:31], v[76:79], v[220:223]
  v_mfma_f32_16x16x32_bf16 v[236:239], v[32:35], v[76:79], v[236:239]
  s_add_u32 m0, s31, 11264
  s_add_u32 s32, s40, 1024
  buffer_load_dwordx4 v9, s[20:23], s32 offen lds
  v_mfma_f32_16x16x32_bf16 v[232:235], v[32:35], v[72:75], v[232:235]
  v_mfma_f32_16x16x32_bf16 v[228:231], v[32:35], v[68:71], v[228:231]
  s_add_u32 m0, s31, 12288
  s_add_u32 s32, s40, 2048
  buffer_load_dwordx4 v9, s[20:23], s32 offen lds
  v_mfma_f32_16x16x32_bf16 v[224:227], v[32:35], v[64:67], v[224:227]
  v_mfma_f32_16x16x32_bf16 v[240:243], v[36:39], v[64:67], v[240:243]
  s_add_u32 m0, s31, 13312
  s_add_u32 s32, s40, 3072
  buffer_load_dwordx4 v9, s[20:23], s32 offen lds
  v_mfma_f32_16x16x32_bf16 v[244:247], v[36:39], v[68:71], v[244:247]
  v_mfma_f32_16x16x32_bf16 v[248:251], v[36:39], v[72:75], v[248:251]
  s_add_u32 m0, s31, 14336
  s_add_u32 s32, s40, 4096
  buffer_load_dwordx4 v9, s[20:23], s32 offen lds
  s_add_u32 s40, s40, 40960
  v_mfma_f32_16x16x32_bf16 v[252:255], v[36:39], v[76:79], v[252:255]
  s_waitcnt vmcnt(18)
  s_waitcnt lgkmcnt(0)
  v_mfma_f32_16x16x32_bf16 v[176:179], v[40:43], v[80:83], v[176:179]
  ds_read_b128 v[20:23], v14 offset:0
  v_mfma_f32_16x16x32_bf16 v[180:183], v[40:43], v[84:87], v[180:183]
  v_mfma_f32_16x16x32_bf16 v[184:187], v[40:43], v[88:91], v[184:187]
  v_mfma_f32_16x16x32_bf16 v[188:191], v[40:43], v[92:95], v[188:191]
  v_mfma_f32_16x16x32_bf16 v[204:207], v[44:47], v[92:95], v[204:207]
  ds_read_b128 v[24:27], v14 offset:1024
  v_mfma_f32_16x16x32_bf16 v[200:203], v[44:47], v[88:91], v[200:203]
  v_mfma_f32_16x16x32_bf16 v[196:199], v[44:47], v[84:87], v[196:199]
  v_mfma_f32_16x16x32_bf16 v[192:195], v[44:47], v[80:83], v[192:195]
  v_mfma_f32_16x16x32_bf16 v[208:211], v[48:51], v[80:83], v[208:211]
  ds_read_b128 v[28:31], v14 offset:2048
  v_mfma_f32_16x16x32_bf16 v[212:215], v[48:51], v[84:87], v[212:215]
  v_mfma_f32_16x16x32_bf16 v[216:219], v[48:51], v[88:91], v[216:219]
  v_mfma_f32_16x16x32_bf16 v[220:223], v[48:51], v[92:95], v[220:223]
  v_mfma_f32_16x16x32_bf16 v[236:239], v[52:55], v[92:95], v[236:239]
  ds_read_b128 v[32:35], v14 offset:3072
  v_mfma_f32_16x16x32_bf16 v[232:235], v[52:55], v[88:91], v[232:235]
  v_mfma_f32_16x16x32_bf16 v[228:231], v[52:55], v[84:87], v[228:231]
  v_mfma_f32_16x16x32_bf16 v[224:227], v[52:55], v[80:83], v[224:227]
  v_mfma_f32_16x16x32_bf16 v[240:243], v[56:59], v[80:83], v[240:243]
  ds_read_b128 v[36:39], v14 offset:4096
  v_mfma_f32_16x16x32_bf16 v[244:247], v[56:59], v[84:87], v[244:247]
  v_mfma_f32_16x16x32_bf16 v[248:251], v[56:59], v[88:91], v[248:251]
  v_mfma_f32_16x16x32_bf16 v[252:255], v[56:59], v[92:95], v[252:255]
  s_waitcnt vmcnt(9)
  s_waitcnt lgkmcnt(0)
  v_mfma_f32_16x16x32_bf16 v[176:179], v[20:23], v[96:99], v[176:179]
  ds_read_b128 v[40:43], v14 offset:5120
  v_mfma_f32_16x16x32_bf16 v[180:183], v[20:23], v[100:103], v[180:183]
  v_mfma_f32_16x16x32_bf16 v[184:187], v[20:23], v[104:107], v[184:187]
  v_mfma_f32_16x16x32_bf16 v[188:191], v[20:23], v[108:111], v[188:191]
  v_mfma_f32_16x16x32_bf16 v[204:207], v[24:27], v[108:111], v[204:207]
  ds_read_b128 v[44:47], v14 offset:6144
  v_mfma_f32_16x16x32_bf16 v[200:203], v[24:27], v[104:107], v[200:203]
  v_mfma_f32_16x16x32_bf16 v[196:199], v[24:27], v[100:103], v[196:199]
  v_mfma_f32_16x16x32_bf16 v[192:195], v[24:27], v[96:99], v[192:195]
  v_mfma_f32_16x16x32_bf16 v[208:211], v[28:31], v[96:99], v[208:211]
  ds_read_b128 v[48:51], v14 offset:7168
  v_mfma_f32_16x16x32_bf16 v[212:215], v[28:31], v[100:103], v[212:215]
  v_mfma_f32_16x16x32_bf16 v[216:219], v[28:31], v[104:107], v[216:219]
  v_mfma_f32_16x16x32_bf16 v[220:223], v[28:31], v[108:111], v[220:223]
  v_mfma_f32_16x16x32_bf16 v[236:239], v[32:35], v[108:111], v[236:239]
  ds_read_b128 v[52:55], v14 offset:8192
  v_mfma_f32_16x16x32_bf16 v[232:235], v[32:35], v[104:107], v[232:235]
  v_mfma_f32_16x16x32_bf16 v[228:231], v[32:35], v[100:103], v[228:231]
  v_mfma_f32_16x16x32_bf16 v[224:227], v[32:35], v[96:99], v[224:227]
  v_mfma_f32_16x16x32_bf16 v[240:243], v[36:39], v[96:99], v[240:243]
  ds_read_b128 v[56:59], v14 offset:9216
  v_mfma_f32_16x16x32_bf16 v[244:247], v[36:39], v[100:103], v[244:247]
  v_mfma_f32_16x16x32_bf16 v[248:251], v[36:39], v[104:107], v[248:251]
  v_mfma_f32_16x16x32_bf16 v[252:255], v[36:39], v[108:111], v[252:255]
  s_waitcnt vmcnt(0)
  s_waitcnt lgkmcnt(0)
  v_mfma_f32_16x16x32_bf16 v[176:179], v[40:43], v[112:115], v[176:179]
  ds_read_b128 v[20:23], v14 offset:10240
  v_mfma_f32_16x16x32_bf16 v[180:183], v[40:43], v[116:119], v[180:183]
  v_mfma_f32_16x16x32_bf16 v[184:187], v[40:43], v[120:123], v[184:187]
  v_mfma_f32_16x16x32_bf16 v[188:191], v[40:43], v[124:127], v[188:191]
  v_mfma_f32_16x16x32_bf16 v[204:207], v[44:47], v[124:127], v[204:207]
  ds_read_b128 v[24:27], v14 offset:11264
  v_mfma_f32_16x16x32_bf16 v[200:203], v[44:47], v[120:123], v[200:203]
  v_mfma_f32_16x16x32_bf16 v[196:199], v[44:47], v[116:119], v[196:199]
  v_mfma_f32_16x16x32_bf16 v[192:195], v[44:47], v[112:115], v[192:195]
  v_mfma_f32_16x16x32_bf16 v[208:211], v[48:51], v[112:115], v[208:211]
  ds_read_b128 v[28:31], v14 offset:12288
  v_mfma_f32_16x16x32_bf16 v[212:215], v[48:51], v[116:119], v[212:215]
  v_mfma_f32_16x16x32_bf16 v[216:219], v[48:51], v[120:123], v[216:219]
  v_mfma_f32_16x16x32_bf16 v[220:223], v[48:51], v[124:127], v[220:223]
  v_mfma_f32_16x16x32_bf16 v[236:239], v[52:55], v[124:127], v[236:239]
  ds_read_b128 v[32:35], v14 offset:13312
  v_mfma_f32_16x16x32_bf16 v[232:235], v[52:55], v[120:123], v[232:235]
  v_mfma_f32_16x16x32_bf16 v[228:231], v[52:55], v[116:119], v[228:231]
  v_mfma_f32_16x16x32_bf16 v[224:227], v[52:55], v[112:115], v[224:227]
  v_mfma_f32_16x16x32_bf16 v[240:243], v[56:59], v[112:115], v[240:243]
  ds_read_b128 v[36:39], v14 offset:14336
  v_mfma_f32_16x16x32_bf16 v[244:247], v[56:59], v[116:119], v[244:247]
  v_mfma_f32_16x16x32_bf16 v[248:251], v[56:59], v[120:123], v[248:251]
  v_mfma_f32_16x16x32_bf16 v[252:255], v[56:59], v[124:127], v[252:255]
  s_waitcnt lgkmcnt(0)
  v_mfma_f32_16x16x32_bf16 v[176:179], v[20:23], v[128:131], v[176:179]
  v_mfma_f32_16x16x32_bf16 v[180:183], v[20:23], v[132:135], v[180:183]
  v_mfma_f32_16x16x32_bf16 v[184:187], v[20:23], v[136:139], v[184:187]
  v_mfma_f32_16x16x32_bf16 v[188:191], v[20:23], v[140:143], v[188:191]
  v_mfma_f32_16x16x32_bf16 v[204:207], v[24:27], v[140:143], v[204:207]
  v_mfma_f32_16x16x32_bf16 v[200:203], v[24:27], v[136:139], v[200:203]
  v_mfma_f32_16x16x32_bf16 v[196:199], v[24:27], v[132:135], v[196:199]
  v_mfma_f32_16x16x32_bf16 v[192:195], v[24:27], v[128:131], v[192:195]
  v_mfma_f32_16x16x32_bf16 v[208:211], v[28:31], v[128:131], v[208:211]
  v_mfma_f32_16x16x32_bf16 v[212:215], v[28:31], v[132:135], v[212:215]
  v_mfma_f32_16x16x32_bf16 v[216:219], v[28:31], v[136:139], v[216:219]
  v_mfma_f32_16x16x32_bf16 v[220:223], v[28:31], v[140:143], v[220:223]
  v_mfma_f32_16x16x32_bf16 v[236:239], v[32:35], v[140:143], v[236:239]
  v_mfma_f32_16x16x32_bf16 v[232:235], v[32:35], v[136:139], v[232:235]
  v_mfma_f32_16x16x32_bf16 v[228:231], v[32:35], v[132:135], v[228:231]
  v_mfma_f32_16x16x32_bf16 v[224:227], v[32:35], v[128:131], v[224:227]
  v_mfma_f32_16x16x32_bf16 v[240:243], v[36:39], v[128:131], v[240:243]
  v_mfma_f32_16x16x32_bf16 v[244:247], v[36:39], v[132:135], v[244:247]
  v_mfma_f32_16x16x32_bf16 v[248:251], v[36:39], v[136:139], v[248:251]
  v_mfma_f32_16x16x32_bf16 v[252:255], v[36:39], v[140:143], v[252:255]
L_k2_R:
  s_lshl_b32 s32, s28, 6
  s_lshl_b32 s33, s30, 4
  s_add_u32 s32, s32, s33
  v_add_u32 v10, s32, v2
  v_mul_u32_u24 v10, 1280, v10
  v_lshlrev_b32 v4, 3, v3
  v_add_u32 v10, v10, v4
  s_lshr_b32 s35, s42, 2
  s_mul_i32 s34, s29, 160
  s_mul_i32 s36, s35, 96
  s_add_u32 s34, s34, s36
  buffer_load_dwordx2 v[150:151], v10, s[8:11], s34 offen offset:0
  buffer_load_dwordx2 v[152:153], v10, s[8:11], s34 offen offset:32
  buffer_load_dwordx2 v[154:155], v10, s[8:11], s34 offen offset:64
  s_waitcnt lgkmcnt(0)
  v_add_u32 v12, s31, v9
  s_nop 4
  ds_write_b128 v12, v[176:179] offset:0
  ds_write_b128 v12, v[192:195] offset:1024
  ds_write_b128 v12, v[208:211] offset:2048
  ds_write_b128 v12, v[224:227] offset:3072
  ds_write_b128 v12, v[240:243] offset:4096
  ds_write_b128 v12, v[180:183] offset:5120
  ds_write_b128 v12, v[196:199] offset:6144
  ds_write_b128 v12, v[212:215] offset:7168
  ds_write_b128 v12, v[228:231] offset:8192
  ds_write_b128 v12, v[244:247] offset:9216
  s_waitcnt lgkmcnt(4)
  ds_write_b128 v12, v[184:187] offset:10240
  ds_write_b128 v12, v[200:203] offset:11264
  ds_write_b128 v12, v[216:219] offset:12288
  ds_write_b128 v12, v[232:235] offset:13312
  ds_write_b128 v12, v[248:251] offset:14336
  ds_write_b128 v12, v[188:191] offset:15360
  ds_write_b128 v12, v[204:207] offset:16384
  ds_write_b128 v12, v[220:223] offset:17408
  ds_write_b128 v12, v[236:239] offset:18432
  ds_write_b128 v12, v[252:255] offset:19456
  s_mul_i32 s32, s30, 5120
  s_mul_i32 s36, s35, 3072
  s_add_u32 s32, s32, s36
  v_add_u32 v4, s32, v9
  v_add_u32 v5, 61440, v4
  v_add_u32 v6, 122880, v4
  s_waitcnt lgkmcnt(0)
  s_barrier
  ds_read_b128 v[20:23], v4 offset:0
  ds_read_b128 v[24:27], v4 offset:20480
  ds_read_b128 v[28:31], v4 offset:40960
  ds_read_b128 v[32:35], v5 offset:0
  ds_read_b128 v[36:39], v5 offset:20480
  ds_read_b128 v[40:43], v5 offset:40960
  ds_read_b128 v[44:47], v6 offset:0
  ds_read_b128 v[48:51], v6 offset:20480
  s_waitcnt lgkmcnt(2)
  ds_read_b128 v[52:55], v4 offset:1024
  ds_read_b128 v[56:59], v4 offset:21504
  ds_read_b128 v[60:63], v4 offset:41984
  ds_read_b128 v[64:67], v5 offset:1024
  ds_read_b128 v[68:71], v5 offset:21504
  ds_read_b128 v[72:75], v5 offset:41984
  ds_read_b128 v[76:79], v6 offset:1024
  ds_read_b128 v[80:83], v6 offset:21504
  s_waitcnt vmcnt(0) lgkmcnt(8)
  s_cmp_eq_u32 s35, 0
  s_cbranch_scc0 L_k2_h1
  v_pk_add_f32 v[20:21], v[20:21], v[24:25]
  v_pk_add_f32 v[28:29], v[28:29], v[32:33]
  v_pk_add_f32 v[36:37], v[36:37], v[40:41]
  v_pk_add_f32 v[44:45], v[44:45], v[48:49]
  v_pk_add_f32 v[22:23], v[22:23], v[26:27]
  v_pk_add_f32 v[30:31], v[30:31], v[34:35]
  v_pk_add_f32 v[38:39], v[38:39], v[42:43]
  v_pk_add_f32 v[46:47], v[46:47], v[50:51]
  v_lshlrev_b32 v24, 16, v150
  v_and_b32 v25, 0xffff0000, v150
  v_lshlrev_b32 v26, 16, v151
  v_and_b32 v27, 0xffff0000, v151
  v_pk_add_f32 v[20:21], v[20:21], v[28:29]
  v_pk_add_f32 v[36:37], v[36:37], v[44:45]
  v_pk_add_f32 v[22:23], v[22:23], v[30:31]
  v_pk_add_f32 v[38:39], v[38:39], v[46:47]
  v_pk_add_f32 v[36:37], v[36:37], v[24:25]
  v_pk_add_f32 v[38:39], v[38:39], v[26:27]
  v_pk_add_f32 v[20:21], v[20:21], v[36:37]
  v_pk_add_f32 v[22:23], v[22:23], v[38:39]
  v_cvt_pk_bf16_f32 v20, v20, v21
  v_cvt_pk_bf16_f32 v21, v22, v23
  buffer_store_dwordx2 v[20:21], v10, s[24:27], s34 offen offset:0
  s_waitcnt lgkmcnt(2)
  ds_read_b128 v[84:87], v4 offset:2048
  ds_read_b128 v[88:91], v4 offset:22528
  ds_read_b128 v[92:95], v4 offset:43008
  ds_read_b128 v[96:99], v5 offset:2048
  ds_read_b128 v[100:103], v5 offset:22528
  ds_read_b128 v[104:107], v5 offset:43008
  ds_read_b128 v[108:111], v6 offset:2048
  ds_read_b128 v[112:115], v6 offset:22528
  s_waitcnt lgkmcnt(8)
  v_pk_add_f32 v[52:53], v[52:53], v[56:57]
  v_pk_add_f32 v[60:61], v[60:61], v[64:65]
  v_pk_add_f32 v[68:69], v[68:69], v[72:73]
  v_pk_add_f32 v[76:77], v[76:77], v[80:81]
  v_pk_add_f32 v[54:55], v[54:55], v[58:59]
  v_pk_add_f32 v[62:63], v[62:63], v[66:67]
  v_pk_add_f32 v[70:71], v[70:71], v[74:75]
  v_pk_add_f32 v[78:79], v[78:79], v[82:83]
  v_lshlrev_b32 v56, 16, v152
  v_and_b32 v57, 0xffff0000, v152
  v_lshlrev_b32 v58, 16, v153
  v_and_b32 v59, 0xffff0000, v153
  v_pk_add_f32 v[52:53], v[52:53], v[60:61]
  v_pk_add_f32 v[68:69], v[68:69], v[76:77]
  v_pk_add_f32 v[54:55], v[54:55], v[62:63]
  v_pk_add_f32 v[70:71], v[70:71], v[78:79]
  v_pk_add_f32 v[68:69], v[68:69], v[56:57]
  v_pk_add_f32 v[70:71], v[70:71], v[58:59]
  v_pk_add_f32 v[52:53], v[52:53], v[68:69]
  v_pk_add_f32 v[54:55], v[54:55], v[70:71]
  v_cvt_pk_bf16_f32 v52, v52, v53
  v_cvt_pk_bf16_f32 v53, v54, v55
  buffer_store_dwordx2 v[52:53], v10, s[24:27], s34 offen offset:32
  s_waitcnt lgkmcnt(0)
  v_pk_add_f32 v[84:85], v[84:85], v[88:89]
  v_pk_add_f32 v[92:93], v[92:93], v[96:97]
  v_pk_add_f32 v[100:101], v[100:101], v[104:105]
  v_pk_add_f32 v[108:109], v[108:109], v[112:113]
  v_pk_add_f32 v[86:87], v[86:87], v[90:91]
  v_pk_add_f32 v[94:95], v[94:95], v[98:99]
  v_pk_add_f32 v[102:103], v[102:103], v[106:107]
  v_pk_add_f32 v[110:111], v[110:111], v[114:115]
  v_lshlrev_b32 v88, 16, v154
  v_and_b32 v89, 0xffff0000, v154
  v_lshlrev_b32 v90, 16, v155
  v_and_b32 v91, 0xffff0000, v155
  v_pk_add_f32 v[84:85], v[84:85], v[92:93]
  v_pk_add_f32 v[100:101], v[100:101], v[108:109]
  v_pk_add_f32 v[86:87], v[86:87], v[94:95]
  v_pk_add_f32 v[102:103], v[102:103], v[110:111]
  v_pk_add_f32 v[100:101], v[100:101], v[88:89]
  v_pk_add_f32 v[102:103], v[102:103], v[90:91]
  v_pk_add_f32 v[84:85], v[84:85], v[100:101]
  v_pk_add_f32 v[86:87], v[86:87], v[102:103]
  v_cvt_pk_bf16_f32 v84, v84, v85
  v_cvt_pk_bf16_f32 v85, v86, v87
  buffer_store_dwordx2 v[84:85], v10, s[24:27], s34 offen offset:64
  s_branch L_k2_fin
L_k2_h1:
  v_pk_add_f32 v[20:21], v[20:21], v[24:25]
  v_pk_add_f32 v[28:29], v[28:29], v[32:33]
  v_pk_add_f32 v[36:37], v[36:37], v[40:41]
  v_pk_add_f32 v[44:45], v[44:45], v[48:49]
  v_pk_add_f32 v[22:23], v[22:23], v[26:27]
  v_pk_add_f32 v[30:31], v[30:31], v[34:35]
  v_pk_add_f32 v[38:39], v[38:39], v[42:43]
  v_pk_add_f32 v[46:47], v[46:47], v[50:51]
  v_lshlrev_b32 v24, 16, v150
  v_and_b32 v25, 0xffff0000, v150
  v_lshlrev_b32 v26, 16, v151
  v_and_b32 v27, 0xffff0000, v151
  v_pk_add_f32 v[20:21], v[20:21], v[28:29]
  v_pk_add_f32 v[36:37], v[36:37], v[44:45]
  v_pk_add_f32 v[22:23], v[22:23], v[30:31]
  v_pk_add_f32 v[38:39], v[38:39], v[46:47]
  v_pk_add_f32 v[36:37], v[36:37], v[24:25]
  v_pk_add_f32 v[38:39], v[38:39], v[26:27]
  v_pk_add_f32 v[20:21], v[20:21], v[36:37]
  v_pk_add_f32 v[22:23], v[22:23], v[38:39]
  v_cvt_pk_bf16_f32 v20, v20, v21
  v_cvt_pk_bf16_f32 v21, v22, v23
  buffer_store_dwordx2 v[20:21], v10, s[24:27], s34 offen offset:0
  s_waitcnt lgkmcnt(0)
  v_pk_add_f32 v[52:53], v[52:53], v[56:57]
  v_pk_add_f32 v[60:61], v[60:61], v[64:65]
  v_pk_add_f32 v[68:69], v[68:69], v[72:73]
  v_pk_add_f32 v[76:77], v[76:77], v[80:81]
  v_pk_add_f32 v[54:55], v[54:55], v[58:59]
  v_pk_add_f32 v[62:63], v[62:63], v[66:67]
  v_pk_add_f32 v[70:71], v[70:71], v[74:75]
  v_pk_add_f32 v[78:79], v[78:79], v[82:83]
  v_lshlrev_b32 v56, 16, v152
  v_and_b32 v57, 0xffff0000, v152
  v_lshlrev_b32 v58, 16, v153
  v_and_b32 v59, 0xffff0000, v153
  v_pk_add_f32 v[52:53], v[52:53], v[60:61]
  v_pk_add_f32 v[68:69], v[68:69], v[76:77]
  v_pk_add_f32 v[54:55], v[54:55], v[62:63]
  v_pk_add_f32 v[70:71], v[70:71], v[78:79]
  v_pk_add_f32 v[68:69], v[68:69], v[56:57]
  v_pk_add_f32 v[70:71], v[70:71], v[58:59]
  v_pk_add_f32 v[52:53], v[52:53], v[68:69]
  v_pk_add_f32 v[54:55], v[54:55], v[70:71]
  v_cvt_pk_bf16_f32 v52, v52, v53
  v_cvt_pk_bf16_f32 v53, v54, v55
  buffer_store_dwordx2 v[52:53], v10, s[24:27], s34 offen offset:32
L_k2_fin:
L_k2_end:
  s_endpgm
.section .rodata,"a"
.p2align 6
.amdhsa_kernel k1_kernel
  .amdhsa_next_free_vgpr 256
  .amdhsa_next_free_sgpr 96
  .amdhsa_accum_offset 256
  .amdhsa_group_segment_fixed_size 0
  .amdhsa_kernarg_size 80
  .amdhsa_user_sgpr_count 2
  .amdhsa_user_sgpr_kernarg_segment_ptr 1
  .amdhsa_system_sgpr_workgroup_id_x 1
.end_amdhsa_kernel

.section .rodata,"a"
.p2align 6
.amdhsa_kernel k2_kernel
  .amdhsa_next_free_vgpr 256
  .amdhsa_next_free_sgpr 96
  .amdhsa_accum_offset 256
  .amdhsa_group_segment_fixed_size 0
  .amdhsa_kernarg_size 80
  .amdhsa_user_sgpr_count 2
  .amdhsa_user_sgpr_kernarg_segment_ptr 1
  .amdhsa_system_sgpr_workgroup_id_x 1
.end_amdhsa_kernel
```
